```python
import torch

def _softmax(x, axis=-1):
    return torch.softmax(x, dim=axis)
def _gelu(x):
    return torch.nn.functional.gelu(x, approximate="tanh")
def _silu(x):
    return torch.nn.functional.silu(x)
def _sigmoid(x):
    return torch.sigmoid(x)
def _layernorm(x, axis=-1, eps=1e-5):
    m = x.mean(dim=axis, keepdim=True)
    v = x.var(dim=axis, keepdim=True, unbiased=False)
    return (x - m) / torch.sqrt(v + eps)
def _scatter_add(tgt, idx, src, axis=0):
    return tgt.clone().index_add_(axis, idx, src)
def _segment_sum(src, seg, n):
    out = torch.zeros((n,) + src.shape[1:], dtype=src.dtype)
    return out.index_add_(0, seg, src)
def _pad(x, pw):
    flat = tuple(v for pair in reversed(pw) for v in pair)
    return torch.nn.functional.pad(x, flat)

kernel_name = 'gather_scatter__molecular_angular_gemnet__graph'

def setup_inputs():

    _w = (lambda a: (lambda t: t.to(torch.bfloat16) if t.is_floating_point() else t)(torch.as_tensor(a)))
    N, deg, De, L = 50000, 16, 16, 3
    E = N * deg
    T = E * deg
    NR = 8
    dist = torch.rand(E).to(float)
    angle = (torch.rand(T) * torch.pi).to(float)
    centers = torch.linspace(0.0, 1.0, NR).to(float)
    ang_freq = torch.arange(1, L + 1).to(float)
    return {
        "m": _w((lambda *s: torch.randn(*s, dtype=torch.bfloat16) * 0.05)(E, De)),
        "idx_in": _w((lambda lo, hi, *s: torch.randint(lo, hi, s))(0, E, T).to(torch.int64)),
        "idx_out": _w((lambda lo, hi, *s: torch.randint(lo, hi, s))(0, E, T).to(torch.int64)),
        "dist": _w(dist),
        "angle": _w(angle),
        "centers": _w(centers),
        "ang_freq": _w(ang_freq),
        "w_rbf": _w((lambda *s: torch.randn(*s, dtype=torch.bfloat16) * 0.2)(NR, De)),
        "w_sbf": _w((lambda *s: torch.randn(*s, dtype=torch.bfloat16) * 0.2)(NR * L, De)),
        "w_down": _w((lambda *s: torch.randn(*s, dtype=torch.bfloat16) * 0.2)(De, De)),
        "w_up": _w((lambda *s: torch.randn(*s, dtype=torch.bfloat16) * 0.2)(De, De)),
    }

def reference(m, idx_in, idx_out, dist, angle, centers, ang_freq, w_rbf, w_sbf, w_down, w_up):
    E, De = m.shape[0], m.shape[1]
    NR = centers.shape[0]
    L = ang_freq.shape[0]
    rbf = torch.exp(-10.0 * (dist[:, None] - centers[None, :]) ** 2)
    cbf = torch.cos(ang_freq[None, :] * angle[:, None])
    rbf_t = rbf[idx_out]
    sbf = torch.reshape(rbf_t[:, :, None] * cbf[:, None, :], (-1, NR * L))
    x = (m[idx_in] @ w_down) * (sbf @ w_sbf)
    agg = _segment_sum(x, idx_out, E)
    return m + (agg @ w_up) * (rbf @ w_rbf)
```

```asm
; @launch kernel=bin_kernel grid=(256,1,1) block=(1024,1,1) lds=163200
; @launch kernel=acc_kernel grid=(256,1,1) block=(512,1,1) lds=162784
.amdgcn_target "amdgcn-amd-amdhsa--gfx950"
.text
.globl bin_kernel
.p2align 8
.type bin_kernel,@function
bin_kernel:
    s_cmp_ge_u32 s2, 256
    s_cbranch_scc1 Lk1_end
    s_load_dwordx4 s[4:7], s[0:1], 8
    s_load_dwordx2 s[8:9], s[0:1], 32
    s_load_dwordx4 s[76:79], s[0:1], 96
    s_load_dwordx2 s[12:13], s[0:1], 0
    s_load_dwordx8 s[16:23], s[0:1], 56
    s_cmp_ge_u32 s2, 16
    s_cbranch_scc1 Lcpfa
    s_getpc_b64 s[84:85]
Lcpba:
    v_lshlrev_b32 v124, 7, v0
    v_mov_b32 v125, 0
    v_cmp_gt_u32 vcc, Lk2_end-Lcpba, v124
    v_lshl_add_u64 v[124:125], v[124:125], 0, s[84:85]
    s_and_b64 exec, exec, vcc
    s_cbranch_execz Lcpea
    global_load_dword v124, v[124:125], off
Lcpea:
    s_mov_b64 exec, -1
Lcpfa:
    v_lshlrev_b32 v1, 4, v0
    v_lshlrev_b32 v2, 3, v0
    v_mov_b32 v3, 1
    v_mov_b32 v12, 6
    v_lshrrev_b32 v4, 6, v0
    s_nop 0
    v_readfirstlane_b32 s69, v4
    v_mov_b32 v4, 0
    v_lshlrev_b32 v5, 2, v0
    ds_write_b32 v5, v4 offset:0
    ds_write_b32 v5, v4 offset:4224
    s_mov_b32 s64, 1374390
    s_mov_b32 s65, 21400
    s_mov_b32 s66, -3125
    s_mov_b32 s67, 0xffff0000
    s_mov_b32 s74, 0x80008000
    s_mov_b32 s75, 0xff000
    s_mul_i32 s14, s2, 53
    s_add_u32 s15, s14, 53
    s_lshr_b32 s14, s14, 2
    s_lshr_b32 s15, s15, 2
    s_sub_u32 s68, s15, s14
    s_lshl_b32 s68, s68, 6
    s_lshl_b32 s15, s2, 6
    s_sub_u32 s14, s14, s15
    s_add_u32 s3, s14, 196608
    s_lshl_b32 s14, s2, 14
    s_lshl_b32 s15, s2, 13
    v_cmp_gt_u32 s[70:71], s68, v0
    v_and_b32 v13, 63, v0
    v_lshlrev_b32 v27, 4, v13
    s_lshl_b32 s73, s2, 4
    s_or_b32 s73, s73, s69
    s_waitcnt lgkmcnt(0)
    s_add_u32 s24, s4, s14
    s_addc_u32 s25, s5, 0
    s_mov_b32 s26, 0
    s_mov_b32 s27, 0x20000
    s_add_u32 s28, s6, s14
    s_addc_u32 s29, s7, 0
    s_mov_b32 s30, 0
    s_mov_b32 s31, 0x20000
    s_add_u32 s32, s8, s15
    s_addc_u32 s33, s9, 0
    s_mov_b32 s34, 0
    s_mov_b32 s35, 0x20000
    s_sub_u32 s26, 51200000, s14
    s_sub_u32 s30, 51200000, s14
    s_sub_u32 s34, 25600000, s15
    s_cmp_lg_u32 s73, 0
    s_cbranch_scc1 Lk1_main
    s_mov_b32 s44, s18
    s_mov_b32 s45, s19
    s_mov_b32 s46, 768
    s_mov_b32 s47, 0x20000
    s_mov_b32 s48, s20
    s_mov_b32 s49, s21
    s_mov_b32 s50, 512
    s_mov_b32 s51, 0x20000
    s_mov_b32 s52, s22
    s_mov_b32 s53, s23
    s_mov_b32 s54, 512
    s_mov_b32 s55, 0x20000
    s_mov_b32 s56, s16
    s_mov_b32 s57, s17
    s_mov_b32 s58, 256
    s_mov_b32 s59, 0x20000
    s_mov_b32 s60, s12
    s_mov_b32 s61, s13
    s_mov_b32 s62, 25600000
    s_mov_b32 s63, 0x20000
    buffer_load_dwordx4 v[76:79], v27, s[44:47], 0 offen
    buffer_load_dwordx4 v[80:83], v27, s[48:51], 0 offen
    buffer_load_dwordx4 v[84:87], v27, s[52:55], 0 offen
    buffer_load_dwordx4 v[88:91], v27, s[56:59], 0 offen
    v_mul_u32_u24 v4, 99984, v13
    s_mov_b32 s68, 0
    buffer_load_dwordx4 v[92:95], v4, s[60:63], s68 offen
    s_mov_b32 s68, 6398976
    buffer_load_dwordx4 v[96:99], v4, s[60:63], s68 offen
    s_mov_b32 s68, 12797952
    buffer_load_dwordx4 v[100:103], v4, s[60:63], s68 offen
    s_mov_b32 s68, 19196928
    buffer_load_dwordx4 v[104:107], v4, s[60:63], s68 offen
Lk1_main:
    s_mov_b32 s68, 0
    buffer_load_dwordx4 v[52:55], v1, s[28:31], s68 offen nt
    buffer_load_dwordx4 v[28:31], v1, s[24:27], s68 offen nt
    s_mov_b32 s68, 0
    buffer_load_dwordx2 v[14:15], v2, s[32:35], s68 offen nt
    s_mov_b32 s68, 4194304
    buffer_load_dwordx4 v[56:59], v1, s[28:31], s68 offen nt
    buffer_load_dwordx4 v[32:35], v1, s[24:27], s68 offen nt
    s_mov_b32 s68, 2097152
    buffer_load_dwordx2 v[16:17], v2, s[32:35], s68 offen nt
    s_lshl_b32 s14, s2, 1
    s_mul_i32 s15, s14, 158976
    s_add_u32 s15, s15, 12288
    s_add_u32 s36, s78, s15
    s_addc_u32 s37, s79, 0
    s_mov_b32 s38, 0
    s_mov_b32 s39, 0x20000
    s_add_u32 s15, s15, 158976
    s_add_u32 s80, s78, s15
    s_addc_u32 s81, s79, 0
    s_mov_b32 s82, 0
    s_mov_b32 s83, 0x20000
    s_lshl_b32 s15, s14, 12
    s_add_u32 s15, s15, 82837504
    s_add_u32 s40, s78, s15
    s_addc_u32 s41, s79, 0
    s_mov_b32 s42, 8192
    s_mov_b32 s43, 0x20000
    s_cmp_lg_u32 s73, 0
    s_barrier
    s_cbranch_scc1 Lk1_noprep
    s_waitcnt vmcnt(6)
    ds_write_b128 v27, v[76:79] offset:8320
    ds_write_b128 v27, v[80:83] offset:9344
    ds_write_b128 v27, v[84:87] offset:10368
    ds_write_b128 v27, v[88:91] offset:11392
    v_mov_b32 v4, 0
    v_dot2_f32_bf16 v4, v92, v92, v4
    v_dot2_f32_bf16 v4, v93, v93, v4
    v_dot2_f32_bf16 v4, v94, v94, v4
    v_dot2_f32_bf16 v4, v95, v95, v4
    v_dot2_f32_bf16 v4, v96, v96, v4
    v_dot2_f32_bf16 v4, v97, v97, v4
    v_dot2_f32_bf16 v4, v98, v98, v4
    v_dot2_f32_bf16 v4, v99, v99, v4
    v_dot2_f32_bf16 v4, v100, v100, v4
    v_dot2_f32_bf16 v4, v101, v101, v4
    v_dot2_f32_bf16 v4, v102, v102, v4
    v_dot2_f32_bf16 v4, v103, v103, v4
    v_dot2_f32_bf16 v4, v104, v104, v4
    v_dot2_f32_bf16 v4, v105, v105, v4
    v_dot2_f32_bf16 v4, v106, v106, v4
    v_dot2_f32_bf16 v4, v107, v107, v4
    s_nop 2
    v_add_f32_dpp v4, v4, v4 row_shr:1 row_mask:0xf bank_mask:0xf
    s_nop 1
    v_add_f32_dpp v4, v4, v4 row_shr:2 row_mask:0xf bank_mask:0xf
    s_nop 1
    v_add_f32_dpp v4, v4, v4 row_shr:4 row_mask:0xf bank_mask:0xf
    s_nop 1
    v_add_f32_dpp v4, v4, v4 row_shr:8 row_mask:0xf bank_mask:0xf
    s_nop 1
    v_add_f32_dpp v4, v4, v4 row_bcast:15 row_mask:0xa bank_mask:0xf
    s_nop 1
    v_add_f32_dpp v4, v4, v4 row_bcast:31 row_mask:0xc bank_mask:0xf
    s_nop 0
    v_readlane_b32 s14, v4, 63
    v_bfe_u32 v5, v13, 3, 2
    v_and_b32 v6, 3, v13
    v_lshl_or_b32 v5, v5, 2, v6
    v_lshlrev_b32 v5, 1, v5
    v_bfe_u32 v7, v13, 2, 1
    v_lshrrev_b32 v8, 5, v13
    s_waitcnt lgkmcnt(0)
    ds_read_u16 v76, v5 offset:8320
    ds_read_u16 v77, v5 offset:8352
    ds_read_u16 v78, v5 offset:8384
    ds_read_u16 v79, v5 offset:8416
    ds_read_u16 v80, v5 offset:8448
    ds_read_u16 v81, v5 offset:8480
    ds_read_u16 v82, v5 offset:8512
    ds_read_u16 v83, v5 offset:8544
    s_waitcnt lgkmcnt(0)
    ds_read_u16 v84, v5 offset:8576
    ds_read_u16 v85, v5 offset:8608
    ds_read_u16 v86, v5 offset:8640
    ds_read_u16 v87, v5 offset:8672
    ds_read_u16 v88, v5 offset:8704
    ds_read_u16 v89, v5 offset:8736
    ds_read_u16 v90, v5 offset:8768
    ds_read_u16 v91, v5 offset:8800
    s_waitcnt lgkmcnt(0)
    ds_read_u16 v92, v5 offset:8832
    ds_read_u16 v93, v5 offset:8864
    ds_read_u16 v94, v5 offset:8896
    ds_read_u16 v95, v5 offset:8928
    ds_read_u16 v96, v5 offset:8960
    ds_read_u16 v97, v5 offset:8992
    ds_read_u16 v98, v5 offset:9024
    ds_read_u16 v99, v5 offset:9056
    s_waitcnt lgkmcnt(0)
    ds_read_u16 v100, v5 offset:9344
    ds_read_u16 v101, v5 offset:9376
    ds_read_u16 v102, v5 offset:9408
    ds_read_u16 v103, v5 offset:9440
    ds_read_u16 v104, v5 offset:9472
    ds_read_u16 v105, v5 offset:9504
    ds_read_u16 v106, v5 offset:9536
    ds_read_u16 v107, v5 offset:9568
    s_waitcnt lgkmcnt(0)
    ds_read_u16 v108, v5 offset:9600
    ds_read_u16 v109, v5 offset:9632
    ds_read_u16 v110, v5 offset:9664
    ds_read_u16 v111, v5 offset:9696
    ds_read_u16 v112, v5 offset:9728
    ds_read_u16 v113, v5 offset:9760
    ds_read_u16 v114, v5 offset:9792
    ds_read_u16 v115, v5 offset:9824
    s_waitcnt lgkmcnt(0)
    v_lshl_add_u32 v9, v8, 8, v5
    ds_read_u16 v116, v9 offset:9344
    ds_read_u16 v117, v9 offset:9376
    ds_read_u16 v118, v9 offset:9408
    ds_read_u16 v119, v9 offset:9440
    ds_read_u16 v120, v9 offset:9472
    ds_read_u16 v121, v9 offset:9504
    ds_read_u16 v122, v9 offset:9536
    ds_read_u16 v123, v9 offset:9568
    s_waitcnt lgkmcnt(0)
    v_lshlrev_b32 v76, 16, v76
    v_lshlrev_b32 v77, 16, v77
    v_lshlrev_b32 v78, 16, v78
    v_lshlrev_b32 v79, 16, v79
    v_lshlrev_b32 v80, 16, v80
    v_lshlrev_b32 v81, 16, v81
    v_lshlrev_b32 v82, 16, v82
    v_lshlrev_b32 v83, 16, v83
    v_lshlrev_b32 v84, 16, v84
    v_lshlrev_b32 v85, 16, v85
    v_lshlrev_b32 v86, 16, v86
    v_lshlrev_b32 v87, 16, v87
    v_lshlrev_b32 v88, 16, v88
    v_lshlrev_b32 v89, 16, v89
    v_lshlrev_b32 v90, 16, v90
    v_lshlrev_b32 v91, 16, v91
    v_lshlrev_b32 v92, 16, v92
    v_lshlrev_b32 v93, 16, v93
    v_lshlrev_b32 v94, 16, v94
    v_lshlrev_b32 v95, 16, v95
    v_lshlrev_b32 v96, 16, v96
    v_lshlrev_b32 v97, 16, v97
    v_lshlrev_b32 v98, 16, v98
    v_lshlrev_b32 v99, 16, v99
    v_lshlrev_b32 v100, 16, v100
    v_lshlrev_b32 v101, 16, v101
    v_lshlrev_b32 v102, 16, v102
    v_lshlrev_b32 v103, 16, v103
    v_lshlrev_b32 v104, 16, v104
    v_lshlrev_b32 v105, 16, v105
    v_lshlrev_b32 v106, 16, v106
    v_lshlrev_b32 v107, 16, v107
    v_lshlrev_b32 v108, 16, v108
    v_lshlrev_b32 v109, 16, v109
    v_lshlrev_b32 v110, 16, v110
    v_lshlrev_b32 v111, 16, v111
    v_lshlrev_b32 v112, 16, v112
    v_lshlrev_b32 v113, 16, v113
    v_lshlrev_b32 v114, 16, v114
    v_lshlrev_b32 v115, 16, v115
    v_lshlrev_b32 v116, 16, v116
    v_lshlrev_b32 v117, 16, v117
    v_lshlrev_b32 v118, 16, v118
    v_lshlrev_b32 v119, 16, v119
    v_lshlrev_b32 v120, 16, v120
    v_lshlrev_b32 v121, 16, v121
    v_lshlrev_b32 v122, 16, v122
    v_lshlrev_b32 v123, 16, v123
    v_mul_f32 v9, v76, v76
    v_fmac_f32 v9, v77, v77
    v_fmac_f32 v9, v78, v78
    v_fmac_f32 v9, v79, v79
    v_fmac_f32 v9, v80, v80
    v_fmac_f32 v9, v81, v81
    v_fmac_f32 v9, v82, v82
    v_fmac_f32 v9, v83, v83
    v_fmac_f32 v9, v84, v84
    v_fmac_f32 v9, v85, v85
    v_fmac_f32 v9, v86, v86
    v_fmac_f32 v9, v87, v87
    v_fmac_f32 v9, v88, v88
    v_fmac_f32 v9, v89, v89
    v_fmac_f32 v9, v90, v90
    v_fmac_f32 v9, v91, v91
    v_fmac_f32 v9, v92, v92
    v_fmac_f32 v9, v93, v93
    v_fmac_f32 v9, v94, v94
    v_fmac_f32 v9, v95, v95
    v_fmac_f32 v9, v96, v96
    v_fmac_f32 v9, v97, v97
    v_fmac_f32 v9, v98, v98
    v_fmac_f32 v9, v99, v99
    v_mul_f32 v10, v100, v100
    v_fmac_f32 v10, v101, v101
    v_fmac_f32 v10, v102, v102
    v_fmac_f32 v10, v103, v103
    v_fmac_f32 v10, v104, v104
    v_fmac_f32 v10, v105, v105
    v_fmac_f32 v10, v106, v106
    v_fmac_f32 v10, v107, v107
    v_fmac_f32 v10, v108, v108
    v_fmac_f32 v10, v109, v109
    v_fmac_f32 v10, v110, v110
    v_fmac_f32 v10, v111, v111
    v_fmac_f32 v10, v112, v112
    v_fmac_f32 v10, v113, v113
    v_fmac_f32 v10, v114, v114
    v_fmac_f32 v10, v115, v115
    v_log_f32 v9, v9
    v_log_f32 v10, v10
    v_log_f32 v11, s14
    v_add_f32 v10, v10, v9
    v_add_f32 v10, v10, v11
    v_mov_b32 v11, 0x4162d544
    v_fmac_f32 v11, -0.5, v10
    v_floor_f32 v11, v11
    v_mul_f32 v9, 0.5, v9
    v_floor_f32 v9, v9
    s_mov_b32 s14, 0x42200000
    v_med3_f32 v11, v11, -s14, s14
    v_med3_f32 v9, -v9, -s14, s14
    v_cvt_i32_f32 v11, v11
    v_cvt_i32_f32 v9, v9
    v_sub_u32 v10, v11, v9
    v_subrev_u32 v10, 16, v10
    v_readlane_b32 s48, v11, 0
    v_readlane_b32 s49, v11, 1
    v_readlane_b32 s50, v11, 2
    v_readlane_b32 s51, v11, 3
    v_readlane_b32 s52, v11, 8
    v_readlane_b32 s53, v11, 9
    v_readlane_b32 s54, v11, 10
    v_readlane_b32 s55, v11, 11
    v_readlane_b32 s56, v11, 16
    v_readlane_b32 s57, v11, 17
    v_readlane_b32 s58, v11, 18
    v_readlane_b32 s59, v11, 19
    v_readlane_b32 s60, v11, 24
    v_readlane_b32 s61, v11, 25
    v_readlane_b32 s62, v11, 26
    v_readlane_b32 s63, v11, 27
    s_add_u32 s44, s78, 85983232
    s_addc_u32 s45, s79, 0
    s_mov_b32 s46, 8192
    s_mov_b32 s47, 0x20000
    v_xor_b32 v4, v7, v8
    v_subrev_u32 v4, 1, v4
    v_subrev_u32 v6, 1, v7
    v_sub_u32 v7, 0, v7
    v_ldexp_f32 v76, v76, v9
    v_ldexp_f32 v77, v77, v9
    v_add_f32 v77, v77, v77
    v_ldexp_f32 v78, v78, v9
    v_ldexp_f32 v79, v79, v9
    v_ldexp_f32 v80, v80, v9
    v_add_f32 v80, v80, v80
    v_ldexp_f32 v81, v81, v9
    v_ldexp_f32 v82, v82, v9
    v_ldexp_f32 v83, v83, v9
    v_add_f32 v83, v83, v83
    v_ldexp_f32 v84, v84, v9
    v_ldexp_f32 v85, v85, v9
    v_ldexp_f32 v86, v86, v9
    v_add_f32 v86, v86, v86
    v_ldexp_f32 v87, v87, v9
    v_ldexp_f32 v88, v88, v9
    v_ldexp_f32 v89, v89, v9
    v_add_f32 v89, v89, v89
    v_ldexp_f32 v90, v90, v9
    v_ldexp_f32 v91, v91, v9
    v_ldexp_f32 v92, v92, v9
    v_add_f32 v92, v92, v92
    v_ldexp_f32 v93, v93, v9
    v_ldexp_f32 v94, v94, v9
    v_ldexp_f32 v95, v95, v9
    v_add_f32 v95, v95, v95
    v_ldexp_f32 v96, v96, v9
    v_ldexp_f32 v97, v97, v9
    v_ldexp_f32 v98, v98, v9
    v_add_f32 v98, v98, v98
    v_ldexp_f32 v99, v99, v9
    v_ldexp_f32 v116, v116, v10
    v_ldexp_f32 v117, v117, v10
    v_ldexp_f32 v118, v118, v10
    v_ldexp_f32 v119, v119, v10
    v_ldexp_f32 v120, v120, v10
    v_ldexp_f32 v121, v121, v10
    v_ldexp_f32 v122, v122, v10
    v_ldexp_f32 v123, v123, v10
    v_cvt_pk_f16_f32 v100, v76, v79
    v_and_b32 v100, v100, v4
    v_cvt_pk_f16_f32 v101, v82, v85
    v_and_b32 v101, v101, v4
    v_cvt_pk_f16_f32 v102, v88, v91
    v_and_b32 v102, v102, v4
    v_cvt_pk_f16_f32 v103, v94, v97
    v_and_b32 v103, v103, v4
    buffer_store_dwordx4 v[100:103], v27, s[44:47], 0 offen offset:0
    v_cvt_pk_f16_f32 v104, v77, v80
    v_and_b32 v104, v104, v4
    v_cvt_pk_f16_f32 v105, v83, v86
    v_and_b32 v105, v105, v4
    v_cvt_pk_f16_f32 v106, v89, v92
    v_and_b32 v106, v106, v4
    v_cvt_pk_f16_f32 v107, v95, v98
    v_and_b32 v107, v107, v4
    buffer_store_dwordx4 v[104:107], v27, s[44:47], 0 offen offset:1024
    v_cvt_pk_f16_f32 v108, v78, v81
    v_and_b32 v108, v108, v4
    v_cvt_pk_f16_f32 v109, v84, v87
    v_and_b32 v109, v109, v4
    v_cvt_pk_f16_f32 v110, v90, v93
    v_and_b32 v110, v110, v4
    v_cvt_pk_f16_f32 v111, v96, v99
    v_and_b32 v111, v111, v4
    buffer_store_dwordx4 v[108:111], v27, s[44:47], 0 offen offset:2048
    v_cvt_pk_bf16_f32 v116, v116, v117
    v_cvt_pk_bf16_f32 v117, v118, v119
    v_cvt_pk_bf16_f32 v118, v120, v121
    v_cvt_pk_bf16_f32 v119, v122, v123
    v_and_b32 v112, v116, v6
    v_and_b32 v120, v116, v7
    v_and_b32 v113, v117, v6
    v_and_b32 v121, v117, v7
    v_and_b32 v114, v118, v6
    v_and_b32 v122, v118, v7
    v_and_b32 v115, v119, v6
    v_and_b32 v123, v119, v7
    v_add_u32 v11, 4096, v27
    buffer_store_dwordx4 v[112:115], v27, s[44:47], 0 offen offset:3072
    buffer_store_dwordx4 v[120:123], v11, s[44:47], 0 offen
    v_bfe_u32 v5, v13, 2, 1
    v_bfe_u32 v6, v13, 3, 1
    v_lshl_or_b32 v5, v5, 1, v6
    v_and_b32 v6, 3, v13
    v_lshl_or_b32 v5, v5, 2, v6
    v_lshlrev_b32 v5, 1, v5
    v_bfe_u32 v7, v13, 4, 1
    v_xor_b32 v4, v7, v8
    v_subrev_u32 v4, 1, v4
    ds_read_u16 v76, v5 offset:10368
    ds_read_u16 v77, v5 offset:10400
    ds_read_u16 v78, v5 offset:10432
    ds_read_u16 v79, v5 offset:10464
    ds_read_u16 v80, v5 offset:10496
    ds_read_u16 v81, v5 offset:10528
    ds_read_u16 v82, v5 offset:10560
    ds_read_u16 v83, v5 offset:10592
    s_waitcnt lgkmcnt(0)
    ds_read_u16 v84, v5 offset:10624
    ds_read_u16 v85, v5 offset:10656
    ds_read_u16 v86, v5 offset:10688
    ds_read_u16 v87, v5 offset:10720
    ds_read_u16 v88, v5 offset:10752
    ds_read_u16 v89, v5 offset:10784
    ds_read_u16 v90, v5 offset:10816
    ds_read_u16 v91, v5 offset:10848
    s_waitcnt lgkmcnt(0)
    ds_read_u16 v92, v5 offset:11392
    ds_read_u16 v93, v5 offset:11424
    ds_read_u16 v94, v5 offset:11456
    ds_read_u16 v95, v5 offset:11488
    ds_read_u16 v96, v5 offset:11520
    ds_read_u16 v97, v5 offset:11552
    ds_read_u16 v98, v5 offset:11584
    ds_read_u16 v99, v5 offset:11616
    s_waitcnt lgkmcnt(0)
    v_lshlrev_b32 v76, 16, v76
    v_lshlrev_b32 v77, 16, v77
    v_lshlrev_b32 v78, 16, v78
    v_lshlrev_b32 v79, 16, v79
    v_lshlrev_b32 v80, 16, v80
    v_lshlrev_b32 v81, 16, v81
    v_lshlrev_b32 v82, 16, v82
    v_lshlrev_b32 v83, 16, v83
    v_lshlrev_b32 v84, 16, v84
    v_lshlrev_b32 v85, 16, v85
    v_lshlrev_b32 v86, 16, v86
    v_lshlrev_b32 v87, 16, v87
    v_lshlrev_b32 v88, 16, v88
    v_lshlrev_b32 v89, 16, v89
    v_lshlrev_b32 v90, 16, v90
    v_lshlrev_b32 v91, 16, v91
    v_lshlrev_b32 v92, 16, v92
    v_lshlrev_b32 v93, 16, v93
    v_lshlrev_b32 v94, 16, v94
    v_lshlrev_b32 v95, 16, v95
    v_lshlrev_b32 v96, 16, v96
    v_lshlrev_b32 v97, 16, v97
    v_lshlrev_b32 v98, 16, v98
    v_lshlrev_b32 v99, 16, v99
    v_mul_f32 v9, v92, v92
    v_fmac_f32 v9, v93, v93
    v_fmac_f32 v9, v94, v94
    v_fmac_f32 v9, v95, v95
    v_fmac_f32 v9, v96, v96
    v_fmac_f32 v9, v97, v97
    v_fmac_f32 v9, v98, v98
    v_fmac_f32 v9, v99, v99
    v_log_f32 v9, v9
    s_nop 0
    v_mul_f32 v9, 0.5, v9
    v_floor_f32 v9, v9
    v_med3_f32 v9, v9, -s14, s14
    v_cvt_i32_f32 v9, v9
    v_sub_u32 v10, 0, v9
    v_ldexp_f32 v92, v92, v10
    v_ldexp_f32 v93, v93, v10
    v_ldexp_f32 v94, v94, v10
    v_ldexp_f32 v95, v95, v10
    v_ldexp_f32 v96, v96, v10
    v_ldexp_f32 v97, v97, v10
    v_ldexp_f32 v98, v98, v10
    v_ldexp_f32 v99, v99, v10
    v_subrev_u32 v6, s48, v9
    v_ldexp_f32 v76, v76, v6
    v_subrev_u32 v6, s49, v9
    v_ldexp_f32 v77, v77, v6
    v_subrev_u32 v6, s50, v9
    v_ldexp_f32 v78, v78, v6
    v_subrev_u32 v6, s51, v9
    v_ldexp_f32 v79, v79, v6
    v_subrev_u32 v6, s52, v9
    v_ldexp_f32 v80, v80, v6
    v_subrev_u32 v6, s53, v9
    v_ldexp_f32 v81, v81, v6
    v_subrev_u32 v6, s54, v9
    v_ldexp_f32 v82, v82, v6
    v_subrev_u32 v6, s55, v9
    v_ldexp_f32 v83, v83, v6
    v_subrev_u32 v6, s56, v9
    v_ldexp_f32 v84, v84, v6
    v_subrev_u32 v6, s57, v9
    v_ldexp_f32 v85, v85, v6
    v_subrev_u32 v6, s58, v9
    v_ldexp_f32 v86, v86, v6
    v_subrev_u32 v6, s59, v9
    v_ldexp_f32 v87, v87, v6
    v_subrev_u32 v6, s60, v9
    v_ldexp_f32 v88, v88, v6
    v_subrev_u32 v6, s61, v9
    v_ldexp_f32 v89, v89, v6
    v_subrev_u32 v6, s62, v9
    v_ldexp_f32 v90, v90, v6
    v_subrev_u32 v6, s63, v9
    v_ldexp_f32 v91, v91, v6
    v_cvt_pk_bf16_f32 v76, v76, v77
    v_and_b32 v76, v76, v4
    v_cvt_pk_bf16_f32 v77, v78, v79
    v_and_b32 v77, v77, v4
    v_cvt_pk_bf16_f32 v78, v80, v81
    v_and_b32 v78, v78, v4
    v_cvt_pk_bf16_f32 v79, v82, v83
    v_and_b32 v79, v79, v4
    v_cvt_pk_bf16_f32 v80, v84, v85
    v_and_b32 v80, v80, v4
    v_cvt_pk_bf16_f32 v81, v86, v87
    v_and_b32 v81, v81, v4
    v_cvt_pk_bf16_f32 v82, v88, v89
    v_and_b32 v82, v82, v4
    v_cvt_pk_bf16_f32 v83, v90, v91
    v_and_b32 v83, v83, v4
    v_cvt_pk_f16_f32 v84, v92, v93
    v_and_b32 v84, v84, v4
    v_cvt_pk_f16_f32 v85, v94, v95
    v_and_b32 v85, v85, v4
    v_cvt_pk_f16_f32 v86, v96, v97
    v_and_b32 v86, v86, v4
    v_cvt_pk_f16_f32 v87, v98, v99
    v_and_b32 v87, v87, v4
    buffer_store_dwordx4 v[76:79], v11, s[44:47], 0 offen offset:1024
    buffer_store_dwordx4 v[80:83], v11, s[44:47], 0 offen offset:2048
    buffer_store_dwordx4 v[84:87], v11, s[44:47], 0 offen offset:3072
    s_nop 1
Lk1_noprep:
    s_mov_b32 s68, 8388608
    buffer_load_dwordx4 v[60:63], v1, s[28:31], s68 offen nt
    buffer_load_dwordx4 v[36:39], v1, s[24:27], s68 offen nt
    s_mov_b32 s68, 4194304
    buffer_load_dwordx2 v[18:19], v2, s[32:35], s68 offen nt
    s_waitcnt vmcnt(6)
    v_or_b32 v14, s74, v14
    v_or_b32 v4, 3, v52
    v_or_b32 v5, 3, v53
    v_mul_hi_u32_u24 v4, s64, v4
    v_mul_hi_u32_u24 v5, s64, v5
    v_and_b32 v6, 3, v4
    v_mad_i32_i24 v52, v4, s66, v52
    v_and_b32 v7, 3, v5
    v_mad_i32_i24 v53, v5, s66, v53
    v_add_u32 v52, v52, v6
    v_and_b32 v6, s75, v28
    v_add_u32 v53, v53, v7
    v_and_b32 v7, s75, v29
    v_mul_hi_u32_u24 v6, s65, v6
    v_mul_hi_u32_u24 v7, s65, v7
    v_lshl_add_u32 v4, v6, 8, v4
    v_lshl_or_b32 v28, v52, 20, v28
    v_lshl_add_u32 v5, v7, 8, v5
    v_lshl_or_b32 v29, v53, 20, v29
    v_lshlrev_b32 v4, 2, v4
    v_lshlrev_b32 v5, 2, v5
    ds_add_u32 v4, v3 offset:4224
    v_lshl_or_b32 v52, v14, 16, v4
    ds_add_u32 v5, v3 offset:4224
    v_and_or_b32 v53, v14, s67, v5
    v_or_b32 v15, s74, v15
    v_or_b32 v4, 3, v54
    v_or_b32 v5, 3, v55
    v_mul_hi_u32_u24 v4, s64, v4
    v_mul_hi_u32_u24 v5, s64, v5
    v_and_b32 v6, 3, v4
    v_mad_i32_i24 v54, v4, s66, v54
    v_and_b32 v7, 3, v5
    v_mad_i32_i24 v55, v5, s66, v55
    v_add_u32 v54, v54, v6
    v_and_b32 v6, s75, v30
    v_add_u32 v55, v55, v7
    v_and_b32 v7, s75, v31
    v_mul_hi_u32_u24 v6, s65, v6
    v_mul_hi_u32_u24 v7, s65, v7
    v_lshl_add_u32 v4, v6, 8, v4
    v_lshl_or_b32 v30, v54, 20, v30
    v_lshl_add_u32 v5, v7, 8, v5
    v_lshl_or_b32 v31, v55, 20, v31
    v_lshlrev_b32 v4, 2, v4
    v_lshlrev_b32 v5, 2, v5
    ds_add_u32 v4, v3 offset:4224
    v_lshl_or_b32 v54, v15, 16, v4
    ds_add_u32 v5, v3 offset:4224
    v_and_or_b32 v55, v15, s67, v5
    s_mov_b32 s68, 12582912
    buffer_load_dwordx4 v[64:67], v1, s[28:31], s68 offen nt
    buffer_load_dwordx4 v[40:43], v1, s[24:27], s68 offen nt
    s_mov_b32 s68, 6291456
    buffer_load_dwordx2 v[20:21], v2, s[32:35], s68 offen nt
    s_waitcnt vmcnt(6)
    v_or_b32 v16, s74, v16
    v_or_b32 v4, 3, v56
    v_or_b32 v5, 3, v57
    v_mul_hi_u32_u24 v4, s64, v4
    v_mul_hi_u32_u24 v5, s64, v5
    v_and_b32 v6, 3, v4
    v_mad_i32_i24 v56, v4, s66, v56
    v_and_b32 v7, 3, v5
    v_mad_i32_i24 v57, v5, s66, v57
    v_add_u32 v56, v56, v6
    v_and_b32 v6, s75, v32
    v_add_u32 v57, v57, v7
    v_and_b32 v7, s75, v33
    v_mul_hi_u32_u24 v6, s65, v6
    v_mul_hi_u32_u24 v7, s65, v7
    v_lshl_add_u32 v4, v6, 8, v4
    v_lshl_or_b32 v32, v56, 20, v32
    v_lshl_add_u32 v5, v7, 8, v5
    v_lshl_or_b32 v33, v57, 20, v33
    v_lshlrev_b32 v4, 2, v4
    v_lshlrev_b32 v5, 2, v5
    ds_add_u32 v4, v3 offset:4224
    v_lshl_or_b32 v56, v16, 16, v4
    ds_add_u32 v5, v3 offset:4224
    v_and_or_b32 v57, v16, s67, v5
    v_or_b32 v17, s74, v17
    v_or_b32 v4, 3, v58
    v_or_b32 v5, 3, v59
    v_mul_hi_u32_u24 v4, s64, v4
    v_mul_hi_u32_u24 v5, s64, v5
    v_and_b32 v6, 3, v4
    v_mad_i32_i24 v58, v4, s66, v58
    v_and_b32 v7, 3, v5
    v_mad_i32_i24 v59, v5, s66, v59
    v_add_u32 v58, v58, v6
    v_and_b32 v6, s75, v34
    v_add_u32 v59, v59, v7
    v_and_b32 v7, s75, v35
    v_mul_hi_u32_u24 v6, s65, v6
    v_mul_hi_u32_u24 v7, s65, v7
    v_lshl_add_u32 v4, v6, 8, v4
    v_lshl_or_b32 v34, v58, 20, v34
    v_lshl_add_u32 v5, v7, 8, v5
    v_lshl_or_b32 v35, v59, 20, v35
    v_lshlrev_b32 v4, 2, v4
    v_lshlrev_b32 v5, 2, v5
    ds_add_u32 v4, v3 offset:4224
    v_lshl_or_b32 v58, v17, 16, v4
    ds_add_u32 v5, v3 offset:4224
    v_and_or_b32 v59, v17, s67, v5
    s_mov_b32 s68, 16777216
    buffer_load_dwordx4 v[68:71], v1, s[28:31], s68 offen nt
    buffer_load_dwordx4 v[44:47], v1, s[24:27], s68 offen nt
    s_mov_b32 s68, 8388608
    buffer_load_dwordx2 v[14:15], v2, s[32:35], s68 offen nt
    s_waitcnt vmcnt(6)
    v_or_b32 v18, s74, v18
    v_or_b32 v4, 3, v60
    v_or_b32 v5, 3, v61
    v_mul_hi_u32_u24 v4, s64, v4
    v_mul_hi_u32_u24 v5, s64, v5
    v_and_b32 v6, 3, v4
    v_mad_i32_i24 v60, v4, s66, v60
    v_and_b32 v7, 3, v5
    v_mad_i32_i24 v61, v5, s66, v61
    v_add_u32 v60, v60, v6
    v_and_b32 v6, s75, v36
    v_add_u32 v61, v61, v7
    v_and_b32 v7, s75, v37
    v_mul_hi_u32_u24 v6, s65, v6
    v_mul_hi_u32_u24 v7, s65, v7
    v_lshl_add_u32 v4, v6, 8, v4
    v_lshl_or_b32 v36, v60, 20, v36
    v_lshl_add_u32 v5, v7, 8, v5
    v_lshl_or_b32 v37, v61, 20, v37
    v_lshlrev_b32 v4, 2, v4
    v_lshlrev_b32 v5, 2, v5
    ds_add_u32 v4, v3 offset:4224
    v_lshl_or_b32 v60, v18, 16, v4
    ds_add_u32 v5, v3 offset:4224
    v_and_or_b32 v61, v18, s67, v5
    v_or_b32 v19, s74, v19
    v_or_b32 v4, 3, v62
    v_or_b32 v5, 3, v63
    v_mul_hi_u32_u24 v4, s64, v4
    v_mul_hi_u32_u24 v5, s64, v5
    v_and_b32 v6, 3, v4
    v_mad_i32_i24 v62, v4, s66, v62
    v_and_b32 v7, 3, v5
    v_mad_i32_i24 v63, v5, s66, v63
    v_add_u32 v62, v62, v6
    v_and_b32 v6, s75, v38
    v_add_u32 v63, v63, v7
    v_and_b32 v7, s75, v39
    v_mul_hi_u32_u24 v6, s65, v6
    v_mul_hi_u32_u24 v7, s65, v7
    v_lshl_add_u32 v4, v6, 8, v4
    v_lshl_or_b32 v38, v62, 20, v38
    v_lshl_add_u32 v5, v7, 8, v5
    v_lshl_or_b32 v39, v63, 20, v39
    v_lshlrev_b32 v4, 2, v4
    v_lshlrev_b32 v5, 2, v5
    ds_add_u32 v4, v3 offset:4224
    v_lshl_or_b32 v62, v19, 16, v4
    ds_add_u32 v5, v3 offset:4224
    v_and_or_b32 v63, v19, s67, v5
    s_mov_b32 s68, 20971520
    buffer_load_dwordx4 v[72:75], v1, s[28:31], s68 offen nt
    buffer_load_dwordx4 v[48:51], v1, s[24:27], s68 offen nt
    s_mov_b32 s68, 10485760
    buffer_load_dwordx2 v[16:17], v2, s[32:35], s68 offen nt
    s_waitcnt vmcnt(6)
    v_or_b32 v20, s74, v20
    v_or_b32 v4, 3, v64
    v_or_b32 v5, 3, v65
    v_mul_hi_u32_u24 v4, s64, v4
    v_mul_hi_u32_u24 v5, s64, v5
    v_and_b32 v6, 3, v4
    v_mad_i32_i24 v64, v4, s66, v64
    v_and_b32 v7, 3, v5
    v_mad_i32_i24 v65, v5, s66, v65
    v_add_u32 v64, v64, v6
    v_and_b32 v6, s75, v40
    v_add_u32 v65, v65, v7
    v_and_b32 v7, s75, v41
    v_mul_hi_u32_u24 v6, s65, v6
    v_mul_hi_u32_u24 v7, s65, v7
    v_lshl_add_u32 v4, v6, 8, v4
    v_lshl_or_b32 v40, v64, 20, v40
    v_lshl_add_u32 v5, v7, 8, v5
    v_lshl_or_b32 v41, v65, 20, v41
    v_lshlrev_b32 v4, 2, v4
    v_lshlrev_b32 v5, 2, v5
    ds_add_u32 v4, v3 offset:4224
    v_lshl_or_b32 v64, v20, 16, v4
    ds_add_u32 v5, v3 offset:4224
    v_and_or_b32 v65, v20, s67, v5
    v_or_b32 v21, s74, v21
    v_or_b32 v4, 3, v66
    v_or_b32 v5, 3, v67
    v_mul_hi_u32_u24 v4, s64, v4
    v_mul_hi_u32_u24 v5, s64, v5
    v_and_b32 v6, 3, v4
    v_mad_i32_i24 v66, v4, s66, v66
    v_and_b32 v7, 3, v5
    v_mad_i32_i24 v67, v5, s66, v67
    v_add_u32 v66, v66, v6
    v_and_b32 v6, s75, v42
    v_add_u32 v67, v67, v7
    v_and_b32 v7, s75, v43
    v_mul_hi_u32_u24 v6, s65, v6
    v_mul_hi_u32_u24 v7, s65, v7
    v_lshl_add_u32 v4, v6, 8, v4
    v_lshl_or_b32 v42, v66, 20, v42
    v_lshl_add_u32 v5, v7, 8, v5
    v_lshl_or_b32 v43, v67, 20, v43
    v_lshlrev_b32 v4, 2, v4
    v_lshlrev_b32 v5, 2, v5
    ds_add_u32 v4, v3 offset:4224
    v_lshl_or_b32 v66, v21, 16, v4
    ds_add_u32 v5, v3 offset:4224
    v_and_or_b32 v67, v21, s67, v5
    s_mov_b32 s68, 25165824
    buffer_load_dwordx4 v[100:103], v1, s[28:31], s68 offen nt
    buffer_load_dwordx4 v[76:79], v1, s[24:27], s68 offen nt
    s_mov_b32 s68, 12582912
    buffer_load_dwordx2 v[18:19], v2, s[32:35], s68 offen nt
    s_waitcnt vmcnt(6)
    v_or_b32 v14, s74, v14
    v_or_b32 v4, 3, v68
    v_or_b32 v5, 3, v69
    v_mul_hi_u32_u24 v4, s64, v4
    v_mul_hi_u32_u24 v5, s64, v5
    v_and_b32 v6, 3, v4
    v_mad_i32_i24 v68, v4, s66, v68
    v_and_b32 v7, 3, v5
    v_mad_i32_i24 v69, v5, s66, v69
    v_add_u32 v68, v68, v6
    v_and_b32 v6, s75, v44
    v_add_u32 v69, v69, v7
    v_and_b32 v7, s75, v45
    v_mul_hi_u32_u24 v6, s65, v6
    v_mul_hi_u32_u24 v7, s65, v7
    v_lshl_add_u32 v4, v6, 8, v4
    v_lshl_or_b32 v44, v68, 20, v44
    v_lshl_add_u32 v5, v7, 8, v5
    v_lshl_or_b32 v45, v69, 20, v45
    v_lshlrev_b32 v4, 2, v4
    v_lshlrev_b32 v5, 2, v5
    ds_add_u32 v4, v3 offset:4224
    v_lshl_or_b32 v68, v14, 16, v4
    ds_add_u32 v5, v3 offset:4224
    v_and_or_b32 v69, v14, s67, v5
    v_or_b32 v15, s74, v15
    v_or_b32 v4, 3, v70
    v_or_b32 v5, 3, v71
    v_mul_hi_u32_u24 v4, s64, v4
    v_mul_hi_u32_u24 v5, s64, v5
    v_and_b32 v6, 3, v4
    v_mad_i32_i24 v70, v4, s66, v70
    v_and_b32 v7, 3, v5
    v_mad_i32_i24 v71, v5, s66, v71
    v_add_u32 v70, v70, v6
    v_and_b32 v6, s75, v46
    v_add_u32 v71, v71, v7
    v_and_b32 v7, s75, v47
    v_mul_hi_u32_u24 v6, s65, v6
    v_mul_hi_u32_u24 v7, s65, v7
    v_lshl_add_u32 v4, v6, 8, v4
    v_lshl_or_b32 v46, v70, 20, v46
    v_lshl_add_u32 v5, v7, 8, v5
    v_lshl_or_b32 v47, v71, 20, v47
    v_lshlrev_b32 v4, 2, v4
    v_lshlrev_b32 v5, 2, v5
    ds_add_u32 v4, v3 offset:4224
    v_lshl_or_b32 v70, v15, 16, v4
    ds_add_u32 v5, v3 offset:4224
    v_and_or_b32 v71, v15, s67, v5
    s_mov_b32 s68, 29360128
    buffer_load_dwordx4 v[104:107], v1, s[28:31], s68 offen nt
    buffer_load_dwordx4 v[80:83], v1, s[24:27], s68 offen nt
    s_mov_b32 s68, 14680064
    buffer_load_dwordx2 v[20:21], v2, s[32:35], s68 offen nt
    s_waitcnt vmcnt(6)
    v_or_b32 v16, s74, v16
    v_or_b32 v4, 3, v72
    v_or_b32 v5, 3, v73
    v_mul_hi_u32_u24 v4, s64, v4
    v_mul_hi_u32_u24 v5, s64, v5
    v_and_b32 v6, 3, v4
    v_mad_i32_i24 v72, v4, s66, v72
    v_and_b32 v7, 3, v5
    v_mad_i32_i24 v73, v5, s66, v73
    v_add_u32 v72, v72, v6
    v_and_b32 v6, s75, v48
    v_add_u32 v73, v73, v7
    v_and_b32 v7, s75, v49
    v_mul_hi_u32_u24 v6, s65, v6
    v_mul_hi_u32_u24 v7, s65, v7
    v_lshl_add_u32 v4, v6, 8, v4
    v_lshl_or_b32 v48, v72, 20, v48
    v_lshl_add_u32 v5, v7, 8, v5
    v_lshl_or_b32 v49, v73, 20, v49
    v_lshlrev_b32 v4, 2, v4
    v_lshlrev_b32 v5, 2, v5
    ds_add_u32 v4, v3 offset:4224
    v_lshl_or_b32 v72, v16, 16, v4
    ds_add_u32 v5, v3 offset:4224
    v_and_or_b32 v73, v16, s67, v5
    v_or_b32 v17, s74, v17
    v_or_b32 v4, 3, v74
    v_or_b32 v5, 3, v75
    v_mul_hi_u32_u24 v4, s64, v4
    v_mul_hi_u32_u24 v5, s64, v5
    v_and_b32 v6, 3, v4
    v_mad_i32_i24 v74, v4, s66, v74
    v_and_b32 v7, 3, v5
    v_mad_i32_i24 v75, v5, s66, v75
    v_add_u32 v74, v74, v6
    v_and_b32 v6, s75, v50
    v_add_u32 v75, v75, v7
    v_and_b32 v7, s75, v51
    v_mul_hi_u32_u24 v6, s65, v6
    v_mul_hi_u32_u24 v7, s65, v7
    v_lshl_add_u32 v4, v6, 8, v4
    v_lshl_or_b32 v50, v74, 20, v50
    v_lshl_add_u32 v5, v7, 8, v5
    v_lshl_or_b32 v51, v75, 20, v51
    v_lshlrev_b32 v4, 2, v4
    v_lshlrev_b32 v5, 2, v5
    ds_add_u32 v4, v3 offset:4224
    v_lshl_or_b32 v74, v17, 16, v4
    ds_add_u32 v5, v3 offset:4224
    v_and_or_b32 v75, v17, s67, v5
    v_lshlrev_b32 v10, 2, v0
    s_waitcnt lgkmcnt(0)
    s_barrier
    ds_read_b32 v4, v10 offset:4224
    s_lshl_b32 s68, s69, 2
    v_mov_b32 v8, s68
    v_and_b32 v9, 60, v10
    s_waitcnt lgkmcnt(0)
    v_add_u32 v6, 1, v4
    v_lshrrev_b32 v6, 1, v6
    v_mov_b32 v7, v6
    s_nop 1
    v_add_u32_dpp v7, v7, v7 row_shr:1 row_mask:0xf bank_mask:0xf
    s_nop 1
    v_add_u32_dpp v7, v7, v7 row_shr:2 row_mask:0xf bank_mask:0xf
    s_nop 1
    v_add_u32_dpp v7, v7, v7 row_shr:4 row_mask:0xf bank_mask:0xf
    s_nop 1
    v_add_u32_dpp v7, v7, v7 row_shr:8 row_mask:0xf bank_mask:0xf
    s_nop 1
    v_add_u32_dpp v7, v7, v7 row_bcast:15 row_mask:0xa bank_mask:0xf
    s_nop 1
    v_add_u32_dpp v7, v7, v7 row_bcast:31 row_mask:0xc bank_mask:0xf
    s_mov_b32 exec_lo, 0
    s_mov_b32 exec_hi, 0x80000000
    ds_write_b32 v8, v7 offset:4096
    s_mov_b64 exec, -1
    s_waitcnt lgkmcnt(0)
    s_barrier
    ds_read_b32 v11, v9 offset:4096
    v_and_b32 v8, 255, v0
    v_lshrrev_b32 v9, 8, v0
    v_lshlrev_b32 v9, 2, v9
    v_lshl_add_u32 v9, v8, 4, v9
    s_waitcnt lgkmcnt(0)
    v_mov_b32 v5, v11
    v_add_u32_dpp v11, v11, v11 row_shr:1 row_mask:0xf bank_mask:0xf
    s_nop 1
    v_add_u32_dpp v11, v11, v11 row_shr:2 row_mask:0xf bank_mask:0xf
    s_nop 1
    v_add_u32_dpp v11, v11, v11 row_shr:4 row_mask:0xf bank_mask:0xf
    s_nop 1
    v_add_u32_dpp v11, v11, v11 row_shr:8 row_mask:0xf bank_mask:0xf
    v_sub_u32 v5, v11, v5
    v_readlane_b32 s68, v11, 15
    v_readlane_b32 s72, v5, s69
    s_mul_i32 s38, s68, 12
    s_nop 0
    v_add_u32 v7, s72, v7
    v_sub_u32 v6, v7, v6
    s_movk_i32 s68, 8320
    v_mad_u32_u24 v6, v6, 12, s68
    ds_write_b32 v10, v6 offset:4224
    v_lshl_or_b32 v5, v4, 16, v7
    v_mul_u32_u24 v7, 12, v7
    v_mov_b32 v6, 0
    v_and_b32 v4, 1, v4
    s_and_b32 s68, s2, 7
    s_lshl1_add_u32 s68, s68, 3136
    v_lshrrev_b32 v8, 8, v0
    v_lshl_add_u32 v8, v8, 4, s68
    v_lshlrev_b32 v8, 8, v8
    v_cmpx_eq_u32 vcc, 1, v4
    ds_write_b16 v7, v6 offset:8312
    ds_write_b32 v7, v8 offset:8316
    s_mov_b64 exec, -1
    s_movk_i32 s68, 0
    buffer_store_dword v5, v9, s[40:43], s68 offen
    s_waitcnt lgkmcnt(0)
    s_barrier
    v_and_b32 v22, 0xffff, v52
    ds_add_rtn_u32 v22, v22, v12 offset:4224
    v_and_b32 v23, 0xffff, v53
    ds_add_rtn_u32 v23, v23, v12 offset:4224
    v_and_b32 v24, 0xffff, v54
    ds_add_rtn_u32 v24, v24, v12 offset:4224
    v_and_b32 v25, 0xffff, v55
    ds_add_rtn_u32 v25, v25, v12 offset:4224
    v_and_b32 v26, 0xffff, v56
    ds_add_rtn_u32 v26, v26, v12 offset:4224
    v_and_b32 v27, 0xffff, v57
    ds_add_rtn_u32 v27, v27, v12 offset:4224
    s_waitcnt lgkmcnt(3)
    v_and_b32 v8, 2, v22
    v_add_u32 v22, v22, v8
    v_mad_i32_i24 v8, v8, -5, v22
    ds_write_b32 v22, v28
    ds_write_b16_d16_hi v8, v52 offset:6
    v_and_b32 v9, 2, v23
    v_add_u32 v23, v23, v9
    v_mad_i32_i24 v9, v9, -5, v23
    ds_write_b32 v23, v29
    ds_write_b16_d16_hi v9, v53 offset:6
    v_and_b32 v8, 2, v24
    v_add_u32 v24, v24, v8
    v_mad_i32_i24 v8, v8, -5, v24
    ds_write_b32 v24, v30
    ds_write_b16_d16_hi v8, v54 offset:6
    s_mov_b32 s68, 33554432
    buffer_load_dwordx4 v[108:111], v1, s[28:31], s68 offen nt
    buffer_load_dwordx4 v[84:87], v1, s[24:27], s68 offen nt
    s_mov_b32 s68, 16777216
    buffer_load_dwordx2 v[14:15], v2, s[32:35], s68 offen nt
    v_and_b32 v22, 0xffff, v58
    ds_add_rtn_u32 v22, v22, v12 offset:4224
    v_and_b32 v23, 0xffff, v59
    ds_add_rtn_u32 v23, v23, v12 offset:4224
    v_and_b32 v24, 0xffff, v60
    ds_add_rtn_u32 v24, v24, v12 offset:4224
    s_waitcnt lgkmcnt(9)
    v_and_b32 v8, 2, v25
    v_add_u32 v25, v25, v8
    v_mad_i32_i24 v8, v8, -5, v25
    ds_write_b32 v25, v31
    ds_write_b16_d16_hi v8, v55 offset:6
    v_and_b32 v9, 2, v26
    v_add_u32 v26, v26, v9
    v_mad_i32_i24 v9, v9, -5, v26
    ds_write_b32 v26, v32
    ds_write_b16_d16_hi v9, v56 offset:6
    v_and_b32 v8, 2, v27
    v_add_u32 v27, v27, v8
    v_mad_i32_i24 v8, v8, -5, v27
    ds_write_b32 v27, v33
    ds_write_b16_d16_hi v8, v57 offset:6
    s_mov_b32 s68, 37748736
    buffer_load_dwordx4 v[112:115], v1, s[28:31], s68 offen nt
    buffer_load_dwordx4 v[88:91], v1, s[24:27], s68 offen nt
    s_mov_b32 s68, 18874368
    buffer_load_dwordx2 v[16:17], v2, s[32:35], s68 offen nt
    v_and_b32 v25, 0xffff, v61
    ds_add_rtn_u32 v25, v25, v12 offset:4224
    v_and_b32 v26, 0xffff, v62
    ds_add_rtn_u32 v26, v26, v12 offset:4224
    v_and_b32 v27, 0xffff, v63
    ds_add_rtn_u32 v27, v27, v12 offset:4224
    s_waitcnt lgkmcnt(9)
    v_and_b32 v8, 2, v22
    v_add_u32 v22, v22, v8
    v_mad_i32_i24 v8, v8, -5, v22
    ds_write_b32 v22, v34
    ds_write_b16_d16_hi v8, v58 offset:6
    v_and_b32 v9, 2, v23
    v_add_u32 v23, v23, v9
    v_mad_i32_i24 v9, v9, -5, v23
    ds_write_b32 v23, v35
    ds_write_b16_d16_hi v9, v59 offset:6
    v_and_b32 v8, 2, v24
    v_add_u32 v24, v24, v8
    v_mad_i32_i24 v8, v8, -5, v24
    ds_write_b32 v24, v36
    ds_write_b16_d16_hi v8, v60 offset:6
    s_mov_b32 s68, 41943040
    buffer_load_dwordx4 v[116:119], v1, s[28:31], s68 offen nt
    buffer_load_dwordx4 v[92:95], v1, s[24:27], s68 offen nt
    s_mov_b32 s68, 20971520
    buffer_load_dwordx2 v[28:29], v2, s[32:35], s68 offen nt
    v_and_b32 v22, 0xffff, v64
    ds_add_rtn_u32 v22, v22, v12 offset:4224
    v_and_b32 v23, 0xffff, v65
    ds_add_rtn_u32 v23, v23, v12 offset:4224
    v_and_b32 v24, 0xffff, v66
    ds_add_rtn_u32 v24, v24, v12 offset:4224
    s_waitcnt lgkmcnt(9)
    v_and_b32 v8, 2, v25
    v_add_u32 v25, v25, v8
    v_mad_i32_i24 v8, v8, -5, v25
    ds_write_b32 v25, v37
    ds_write_b16_d16_hi v8, v61 offset:6
    v_and_b32 v9, 2, v26
    v_add_u32 v26, v26, v9
    v_mad_i32_i24 v9, v9, -5, v26
    ds_write_b32 v26, v38
    ds_write_b16_d16_hi v9, v62 offset:6
    v_and_b32 v8, 2, v27
    v_add_u32 v27, v27, v8
    v_mad_i32_i24 v8, v8, -5, v27
    ds_write_b32 v27, v39
    ds_write_b16_d16_hi v8, v63 offset:6
    s_mov_b32 s68, 46137344
    buffer_load_dwordx4 v[120:123], v1, s[28:31], s68 offen nt
    buffer_load_dwordx4 v[96:99], v1, s[24:27], s68 offen nt
    s_mov_b32 s68, 23068672
    buffer_load_dwordx2 v[52:53], v2, s[32:35], s68 offen nt
    v_and_b32 v25, 0xffff, v67
    ds_add_rtn_u32 v25, v25, v12 offset:4224
    v_and_b32 v26, 0xffff, v68
    ds_add_rtn_u32 v26, v26, v12 offset:4224
    v_and_b32 v27, 0xffff, v69
    ds_add_rtn_u32 v27, v27, v12 offset:4224
    s_waitcnt lgkmcnt(9)
    v_and_b32 v8, 2, v22
    v_add_u32 v22, v22, v8
    v_mad_i32_i24 v8, v8, -5, v22
    ds_write_b32 v22, v40
    ds_write_b16_d16_hi v8, v64 offset:6
    v_and_b32 v9, 2, v23
    v_add_u32 v23, v23, v9
    v_mad_i32_i24 v9, v9, -5, v23
    ds_write_b32 v23, v41
    ds_write_b16_d16_hi v9, v65 offset:6
    v_and_b32 v8, 2, v24
    v_add_u32 v24, v24, v8
    v_mad_i32_i24 v8, v8, -5, v24
    ds_write_b32 v24, v42
    ds_write_b16_d16_hi v8, v66 offset:6
    v_lshlrev_b32 v10, 2, v0
    v_lshlrev_b32 v11, 1, v0
    s_lshl_b32 s68, s3, 8
    s_mov_b64 exec, s[70:71]
    buffer_load_dword v125, v10, s[28:31], s68 offen nt
    buffer_load_dword v124, v10, s[24:27], s68 offen nt
    s_lshl_b32 s68, s3, 7
    buffer_load_ushort v13, v11, s[32:35], s68 offen nt
    s_mov_b64 exec, -1
    s_waitcnt vmcnt(19)
    v_or_b32 v18, s74, v18
    v_or_b32 v4, 3, v100
    v_or_b32 v5, 3, v101
    v_mul_hi_u32_u24 v4, s64, v4
    v_mul_hi_u32_u24 v5, s64, v5
    v_and_b32 v6, 3, v4
    v_mad_i32_i24 v100, v4, s66, v100
    v_and_b32 v7, 3, v5
    v_mad_i32_i24 v101, v5, s66, v101
    v_add_u32 v100, v100, v6
    v_and_b32 v6, s75, v76
    v_add_u32 v101, v101, v7
    v_and_b32 v7, s75, v77
    v_mul_hi_u32_u24 v6, s65, v6
    v_mul_hi_u32_u24 v7, s65, v7
    v_lshl_add_u32 v4, v6, 8, v4
    v_lshl_or_b32 v76, v100, 20, v76
    v_lshl_add_u32 v5, v7, 8, v5
    v_lshl_or_b32 v77, v101, 20, v77
    v_lshlrev_b32 v4, 2, v4
    v_lshlrev_b32 v5, 2, v5
    ds_add_u32 v4, v3 offset:0
    v_lshl_or_b32 v100, v18, 16, v4
    ds_add_u32 v5, v3 offset:0
    v_and_or_b32 v101, v18, s67, v5
    v_or_b32 v19, s74, v19
    v_or_b32 v4, 3, v102
    v_or_b32 v5, 3, v103
    v_mul_hi_u32_u24 v4, s64, v4
    v_mul_hi_u32_u24 v5, s64, v5
    v_and_b32 v6, 3, v4
    v_mad_i32_i24 v102, v4, s66, v102
    v_and_b32 v7, 3, v5
    v_mad_i32_i24 v103, v5, s66, v103
    v_add_u32 v102, v102, v6
    v_and_b32 v6, s75, v78
    v_add_u32 v103, v103, v7
    v_and_b32 v7, s75, v79
    v_mul_hi_u32_u24 v6, s65, v6
    v_mul_hi_u32_u24 v7, s65, v7
    v_lshl_add_u32 v4, v6, 8, v4
    v_lshl_or_b32 v78, v102, 20, v78
    v_lshl_add_u32 v5, v7, 8, v5
    v_lshl_or_b32 v79, v103, 20, v79
    v_lshlrev_b32 v4, 2, v4
    v_lshlrev_b32 v5, 2, v5
    ds_add_u32 v4, v3 offset:0
    v_lshl_or_b32 v102, v19, 16, v4
    ds_add_u32 v5, v3 offset:0
    v_and_or_b32 v103, v19, s67, v5
    v_and_b32 v22, 0xffff, v70
    ds_add_rtn_u32 v22, v22, v12 offset:4224
    v_and_b32 v23, 0xffff, v71
    ds_add_rtn_u32 v23, v23, v12 offset:4224
    v_and_b32 v24, 0xffff, v72
    ds_add_rtn_u32 v24, v24, v12 offset:4224
    s_waitcnt lgkmcnt(13)
    v_and_b32 v8, 2, v25
    v_add_u32 v25, v25, v8
    v_mad_i32_i24 v8, v8, -5, v25
    ds_write_b32 v25, v43
    ds_write_b16_d16_hi v8, v67 offset:6
    v_and_b32 v9, 2, v26
    v_add_u32 v26, v26, v9
    v_mad_i32_i24 v9, v9, -5, v26
    ds_write_b32 v26, v44
    ds_write_b16_d16_hi v9, v68 offset:6
    v_and_b32 v8, 2, v27
    v_add_u32 v27, v27, v8
    v_mad_i32_i24 v8, v8, -5, v27
    ds_write_b32 v27, v45
    ds_write_b16_d16_hi v8, v69 offset:6
    s_waitcnt vmcnt(16)
    v_or_b32 v20, s74, v20
    v_or_b32 v4, 3, v104
    v_or_b32 v5, 3, v105
    v_mul_hi_u32_u24 v4, s64, v4
    v_mul_hi_u32_u24 v5, s64, v5
    v_and_b32 v6, 3, v4
    v_mad_i32_i24 v104, v4, s66, v104
    v_and_b32 v7, 3, v5
    v_mad_i32_i24 v105, v5, s66, v105
    v_add_u32 v104, v104, v6
    v_and_b32 v6, s75, v80
    v_add_u32 v105, v105, v7
    v_and_b32 v7, s75, v81
    v_mul_hi_u32_u24 v6, s65, v6
    v_mul_hi_u32_u24 v7, s65, v7
    v_lshl_add_u32 v4, v6, 8, v4
    v_lshl_or_b32 v80, v104, 20, v80
    v_lshl_add_u32 v5, v7, 8, v5
    v_lshl_or_b32 v81, v105, 20, v81
    v_lshlrev_b32 v4, 2, v4
    v_lshlrev_b32 v5, 2, v5
    ds_add_u32 v4, v3 offset:0
    v_lshl_or_b32 v104, v20, 16, v4
    ds_add_u32 v5, v3 offset:0
    v_and_or_b32 v105, v20, s67, v5
    v_or_b32 v21, s74, v21
    v_or_b32 v4, 3, v106
    v_or_b32 v5, 3, v107
    v_mul_hi_u32_u24 v4, s64, v4
    v_mul_hi_u32_u24 v5, s64, v5
    v_and_b32 v6, 3, v4
    v_mad_i32_i24 v106, v4, s66, v106
    v_and_b32 v7, 3, v5
    v_mad_i32_i24 v107, v5, s66, v107
    v_add_u32 v106, v106, v6
    v_and_b32 v6, s75, v82
    v_add_u32 v107, v107, v7
    v_and_b32 v7, s75, v83
    v_mul_hi_u32_u24 v6, s65, v6
    v_mul_hi_u32_u24 v7, s65, v7
    v_lshl_add_u32 v4, v6, 8, v4
    v_lshl_or_b32 v82, v106, 20, v82
    v_lshl_add_u32 v5, v7, 8, v5
    v_lshl_or_b32 v83, v107, 20, v83
    v_lshlrev_b32 v4, 2, v4
    v_lshlrev_b32 v5, 2, v5
    ds_add_u32 v4, v3 offset:0
    v_lshl_or_b32 v106, v21, 16, v4
    ds_add_u32 v5, v3 offset:0
    v_and_or_b32 v107, v21, s67, v5
    v_and_b32 v25, 0xffff, v73
    ds_add_rtn_u32 v25, v25, v12 offset:4224
    v_and_b32 v26, 0xffff, v74
    ds_add_rtn_u32 v26, v26, v12 offset:4224
    v_and_b32 v27, 0xffff, v75
    ds_add_rtn_u32 v27, v27, v12 offset:4224
    s_waitcnt lgkmcnt(13)
    v_and_b32 v8, 2, v22
    v_add_u32 v22, v22, v8
    v_mad_i32_i24 v8, v8, -5, v22
    ds_write_b32 v22, v46
    ds_write_b16_d16_hi v8, v70 offset:6
    v_and_b32 v9, 2, v23
    v_add_u32 v23, v23, v9
    v_mad_i32_i24 v9, v9, -5, v23
    ds_write_b32 v23, v47
    ds_write_b16_d16_hi v9, v71 offset:6
    v_and_b32 v8, 2, v24
    v_add_u32 v24, v24, v8
    v_mad_i32_i24 v8, v8, -5, v24
    ds_write_b32 v24, v48
    ds_write_b16_d16_hi v8, v72 offset:6
    s_waitcnt vmcnt(12)
    v_or_b32 v14, s74, v14
    v_or_b32 v4, 3, v108
    v_or_b32 v5, 3, v109
    v_mul_hi_u32_u24 v4, s64, v4
    v_mul_hi_u32_u24 v5, s64, v5
    v_and_b32 v6, 3, v4
    v_mad_i32_i24 v108, v4, s66, v108
    v_and_b32 v7, 3, v5
    v_mad_i32_i24 v109, v5, s66, v109
    v_add_u32 v108, v108, v6
    v_and_b32 v6, s75, v84
    v_add_u32 v109, v109, v7
    v_and_b32 v7, s75, v85
    v_mul_hi_u32_u24 v6, s65, v6
    v_mul_hi_u32_u24 v7, s65, v7
    v_lshl_add_u32 v4, v6, 8, v4
    v_lshl_or_b32 v84, v108, 20, v84
    v_lshl_add_u32 v5, v7, 8, v5
    v_lshl_or_b32 v85, v109, 20, v85
    v_lshlrev_b32 v4, 2, v4
    v_lshlrev_b32 v5, 2, v5
    ds_add_u32 v4, v3 offset:0
    v_lshl_or_b32 v108, v14, 16, v4
    ds_add_u32 v5, v3 offset:0
    v_and_or_b32 v109, v14, s67, v5
    v_or_b32 v15, s74, v15
    v_or_b32 v4, 3, v110
    v_or_b32 v5, 3, v111
    v_mul_hi_u32_u24 v4, s64, v4
    v_mul_hi_u32_u24 v5, s64, v5
    v_and_b32 v6, 3, v4
    v_mad_i32_i24 v110, v4, s66, v110
    v_and_b32 v7, 3, v5
    v_mad_i32_i24 v111, v5, s66, v111
    v_add_u32 v110, v110, v6
    v_and_b32 v6, s75, v86
    v_add_u32 v111, v111, v7
    v_and_b32 v7, s75, v87
    v_mul_hi_u32_u24 v6, s65, v6
    v_mul_hi_u32_u24 v7, s65, v7
    v_lshl_add_u32 v4, v6, 8, v4
    v_lshl_or_b32 v86, v110, 20, v86
    v_lshl_add_u32 v5, v7, 8, v5
    v_lshl_or_b32 v87, v111, 20, v87
    v_lshlrev_b32 v4, 2, v4
    v_lshlrev_b32 v5, 2, v5
    ds_add_u32 v4, v3 offset:0
    v_lshl_or_b32 v110, v15, 16, v4
    ds_add_u32 v5, v3 offset:0
    v_and_or_b32 v111, v15, s67, v5
    s_waitcnt lgkmcnt(10)
    v_and_b32 v8, 2, v25
    v_add_u32 v25, v25, v8
    v_mad_i32_i24 v8, v8, -5, v25
    ds_write_b32 v25, v49
    ds_write_b16_d16_hi v8, v73 offset:6
    v_and_b32 v9, 2, v26
    v_add_u32 v26, v26, v9
    v_mad_i32_i24 v9, v9, -5, v26
    ds_write_b32 v26, v50
    ds_write_b16_d16_hi v9, v74 offset:6
    v_and_b32 v8, 2, v27
    v_add_u32 v27, v27, v8
    v_mad_i32_i24 v8, v8, -5, v27
    ds_write_b32 v27, v51
    ds_write_b16_d16_hi v8, v75 offset:6
    s_waitcnt vmcnt(9)
    v_or_b32 v16, s74, v16
    v_or_b32 v4, 3, v112
    v_or_b32 v5, 3, v113
    v_mul_hi_u32_u24 v4, s64, v4
    v_mul_hi_u32_u24 v5, s64, v5
    v_and_b32 v6, 3, v4
    v_mad_i32_i24 v112, v4, s66, v112
    v_and_b32 v7, 3, v5
    v_mad_i32_i24 v113, v5, s66, v113
    v_add_u32 v112, v112, v6
    v_and_b32 v6, s75, v88
    v_add_u32 v113, v113, v7
    v_and_b32 v7, s75, v89
    v_mul_hi_u32_u24 v6, s65, v6
    v_mul_hi_u32_u24 v7, s65, v7
    v_lshl_add_u32 v4, v6, 8, v4
    v_lshl_or_b32 v88, v112, 20, v88
    v_lshl_add_u32 v5, v7, 8, v5
    v_lshl_or_b32 v89, v113, 20, v89
    v_lshlrev_b32 v4, 2, v4
    v_lshlrev_b32 v5, 2, v5
    ds_add_u32 v4, v3 offset:0
    v_lshl_or_b32 v112, v16, 16, v4
    ds_add_u32 v5, v3 offset:0
    v_and_or_b32 v113, v16, s67, v5
    v_or_b32 v17, s74, v17
    v_or_b32 v4, 3, v114
    v_or_b32 v5, 3, v115
    v_mul_hi_u32_u24 v4, s64, v4
    v_mul_hi_u32_u24 v5, s64, v5
    v_and_b32 v6, 3, v4
    v_mad_i32_i24 v114, v4, s66, v114
    v_and_b32 v7, 3, v5
    v_mad_i32_i24 v115, v5, s66, v115
    v_add_u32 v114, v114, v6
    v_and_b32 v6, s75, v90
    v_add_u32 v115, v115, v7
    v_and_b32 v7, s75, v91
    v_mul_hi_u32_u24 v6, s65, v6
    v_mul_hi_u32_u24 v7, s65, v7
    v_lshl_add_u32 v4, v6, 8, v4
    v_lshl_or_b32 v90, v114, 20, v90
    v_lshl_add_u32 v5, v7, 8, v5
    v_lshl_or_b32 v91, v115, 20, v91
    v_lshlrev_b32 v4, 2, v4
    v_lshlrev_b32 v5, 2, v5
    ds_add_u32 v4, v3 offset:0
    v_lshl_or_b32 v114, v17, 16, v4
    ds_add_u32 v5, v3 offset:0
    v_and_or_b32 v115, v17, s67, v5
    s_waitcnt vmcnt(6)
    v_or_b32 v28, s74, v28
    v_or_b32 v4, 3, v116
    v_or_b32 v5, 3, v117
    v_mul_hi_u32_u24 v4, s64, v4
    v_mul_hi_u32_u24 v5, s64, v5
    v_and_b32 v6, 3, v4
    v_mad_i32_i24 v116, v4, s66, v116
    v_and_b32 v7, 3, v5
    v_mad_i32_i24 v117, v5, s66, v117
    v_add_u32 v116, v116, v6
    v_and_b32 v6, s75, v92
    v_add_u32 v117, v117, v7
    v_and_b32 v7, s75, v93
    v_mul_hi_u32_u24 v6, s65, v6
    v_mul_hi_u32_u24 v7, s65, v7
    v_lshl_add_u32 v4, v6, 8, v4
    v_lshl_or_b32 v92, v116, 20, v92
    v_lshl_add_u32 v5, v7, 8, v5
    v_lshl_or_b32 v93, v117, 20, v93
    v_lshlrev_b32 v4, 2, v4
    v_lshlrev_b32 v5, 2, v5
    ds_add_u32 v4, v3 offset:0
    v_lshl_or_b32 v116, v28, 16, v4
    ds_add_u32 v5, v3 offset:0
    v_and_or_b32 v117, v28, s67, v5
    v_or_b32 v29, s74, v29
    v_or_b32 v4, 3, v118
    v_or_b32 v5, 3, v119
    v_mul_hi_u32_u24 v4, s64, v4
    v_mul_hi_u32_u24 v5, s64, v5
    v_and_b32 v6, 3, v4
    v_mad_i32_i24 v118, v4, s66, v118
    v_and_b32 v7, 3, v5
    v_mad_i32_i24 v119, v5, s66, v119
    v_add_u32 v118, v118, v6
    v_and_b32 v6, s75, v94
    v_add_u32 v119, v119, v7
    v_and_b32 v7, s75, v95
    v_mul_hi_u32_u24 v6, s65, v6
    v_mul_hi_u32_u24 v7, s65, v7
    v_lshl_add_u32 v4, v6, 8, v4
    v_lshl_or_b32 v94, v118, 20, v94
    v_lshl_add_u32 v5, v7, 8, v5
    v_lshl_or_b32 v95, v119, 20, v95
    v_lshlrev_b32 v4, 2, v4
    v_lshlrev_b32 v5, 2, v5
    ds_add_u32 v4, v3 offset:0
    v_lshl_or_b32 v118, v29, 16, v4
    ds_add_u32 v5, v3 offset:0
    v_and_or_b32 v119, v29, s67, v5
    s_waitcnt vmcnt(3)
    v_or_b32 v52, s74, v52
    v_or_b32 v4, 3, v120
    v_or_b32 v5, 3, v121
    v_mul_hi_u32_u24 v4, s64, v4
    v_mul_hi_u32_u24 v5, s64, v5
    v_and_b32 v6, 3, v4
    v_mad_i32_i24 v120, v4, s66, v120
    v_and_b32 v7, 3, v5
    v_mad_i32_i24 v121, v5, s66, v121
    v_add_u32 v120, v120, v6
    v_and_b32 v6, s75, v96
    v_add_u32 v121, v121, v7
    v_and_b32 v7, s75, v97
    v_mul_hi_u32_u24 v6, s65, v6
    v_mul_hi_u32_u24 v7, s65, v7
    v_lshl_add_u32 v4, v6, 8, v4
    v_lshl_or_b32 v96, v120, 20, v96
    v_lshl_add_u32 v5, v7, 8, v5
    v_lshl_or_b32 v97, v121, 20, v97
    v_lshlrev_b32 v4, 2, v4
    v_lshlrev_b32 v5, 2, v5
    ds_add_u32 v4, v3 offset:0
    v_lshl_or_b32 v120, v52, 16, v4
    ds_add_u32 v5, v3 offset:0
    v_and_or_b32 v121, v52, s67, v5
    v_or_b32 v53, s74, v53
    v_or_b32 v4, 3, v122
    v_or_b32 v5, 3, v123
    v_mul_hi_u32_u24 v4, s64, v4
    v_mul_hi_u32_u24 v5, s64, v5
    v_and_b32 v6, 3, v4
    v_mad_i32_i24 v122, v4, s66, v122
    v_and_b32 v7, 3, v5
    v_mad_i32_i24 v123, v5, s66, v123
    v_add_u32 v122, v122, v6
    v_and_b32 v6, s75, v98
    v_add_u32 v123, v123, v7
    v_and_b32 v7, s75, v99
    v_mul_hi_u32_u24 v6, s65, v6
    v_mul_hi_u32_u24 v7, s65, v7
    v_lshl_add_u32 v4, v6, 8, v4
    v_lshl_or_b32 v98, v122, 20, v98
    v_lshl_add_u32 v5, v7, 8, v5
    v_lshl_or_b32 v99, v123, 20, v99
    v_lshlrev_b32 v4, 2, v4
    v_lshlrev_b32 v5, 2, v5
    ds_add_u32 v4, v3 offset:0
    v_lshl_or_b32 v122, v53, 16, v4
    ds_add_u32 v5, v3 offset:0
    v_and_or_b32 v123, v53, s67, v5
    s_waitcnt vmcnt(0)
    s_mov_b64 exec, s[70:71]
    v_or_b32 v13, s74, v13
    v_or_b32 v4, 3, v125
    v_mul_hi_u32_u24 v4, s64, v4
    v_and_b32 v6, 3, v4
    v_mad_i32_i24 v125, v4, s66, v125
    v_add_u32 v125, v125, v6
    v_and_b32 v6, s75, v124
    v_mul_hi_u32_u24 v6, s65, v6
    v_lshl_add_u32 v4, v6, 8, v4
    v_lshl_or_b32 v124, v125, 20, v124
    v_lshlrev_b32 v4, 2, v4
    ds_add_u32 v4, v3 offset:0
    v_lshl_or_b32 v125, v13, 16, v4
    s_mov_b64 exec, -1
    v_lshlrev_b32 v10, 2, v0
    s_waitcnt lgkmcnt(0)
    s_barrier
    ds_read_b32 v4, v10 offset:0
    v_add_u32 v22, 0x10000, v1
    v_add_u32 v23, 0x20000, v1
    ds_read_b128 v[28:31], v1 offset:8320
    ds_read_b128 v[32:35], v1 offset:24704
    ds_read_b128 v[36:39], v1 offset:41088
    ds_read_b128 v[40:43], v1 offset:57472
    ds_read_b128 v[44:47], v22 offset:8320
    ds_read_b128 v[48:51], v22 offset:24704
    ds_read_b128 v[52:55], v22 offset:41088
    ds_read_b128 v[56:59], v22 offset:57472
    ds_read_b128 v[60:63], v23 offset:8320
    ds_read_b128 v[64:67], v23 offset:24704
    s_lshl_b32 s68, s69, 2
    v_mov_b32 v8, s68
    v_and_b32 v9, 60, v10
    s_waitcnt lgkmcnt(10)
    v_add_u32 v6, 1, v4
    v_lshrrev_b32 v6, 1, v6
    v_mov_b32 v7, v6
    s_nop 1
    v_add_u32_dpp v7, v7, v7 row_shr:1 row_mask:0xf bank_mask:0xf
    s_nop 1
    v_add_u32_dpp v7, v7, v7 row_shr:2 row_mask:0xf bank_mask:0xf
    s_nop 1
    v_add_u32_dpp v7, v7, v7 row_shr:4 row_mask:0xf bank_mask:0xf
    s_nop 1
    v_add_u32_dpp v7, v7, v7 row_shr:8 row_mask:0xf bank_mask:0xf
    s_nop 1
    v_add_u32_dpp v7, v7, v7 row_bcast:15 row_mask:0xa bank_mask:0xf
    s_nop 1
    v_add_u32_dpp v7, v7, v7 row_bcast:31 row_mask:0xc bank_mask:0xf
    s_mov_b32 exec_lo, 0
    s_mov_b32 exec_hi, 0x80000000
    ds_write_b32 v8, v7 offset:4096
    s_mov_b64 exec, -1
    s_waitcnt lgkmcnt(0)
    s_barrier
    ds_read_b32 v11, v9 offset:4096
    s_mov_b32 s68, 0
    buffer_store_dwordx4 v[28:31], v1, s[36:39], s68 offen sc1
    s_mov_b32 s68, 16384
    buffer_store_dwordx4 v[32:35], v1, s[36:39], s68 offen sc1
    s_mov_b32 s68, 32768
    buffer_store_dwordx4 v[36:39], v1, s[36:39], s68 offen sc1
    s_mov_b32 s68, 49152
    buffer_store_dwordx4 v[40:43], v1, s[36:39], s68 offen sc1
    v_and_b32 v8, 255, v0
    v_lshrrev_b32 v9, 8, v0
    v_lshlrev_b32 v9, 2, v9
    v_lshl_add_u32 v9, v8, 4, v9
    s_waitcnt lgkmcnt(0)
    v_mov_b32 v5, v11
    v_add_u32_dpp v11, v11, v11 row_shr:1 row_mask:0xf bank_mask:0xf
    s_nop 1
    v_add_u32_dpp v11, v11, v11 row_shr:2 row_mask:0xf bank_mask:0xf
    s_nop 1
    v_add_u32_dpp v11, v11, v11 row_shr:4 row_mask:0xf bank_mask:0xf
    s_nop 1
    v_add_u32_dpp v11, v11, v11 row_shr:8 row_mask:0xf bank_mask:0xf
    v_sub_u32 v5, v11, v5
    v_readlane_b32 s68, v11, 15
    v_readlane_b32 s72, v5, s69
    s_mul_i32 s82, s68, 12
    s_nop 0
    v_add_u32 v7, s72, v7
    v_sub_u32 v6, v7, v6
    s_movk_i32 s68, 4224
    v_mad_u32_u24 v6, v6, 12, s68
    ds_write_b32 v10, v6 offset:0
    v_lshl_or_b32 v5, v4, 16, v7
    v_mul_u32_u24 v7, 12, v7
    v_mov_b32 v6, 0
    v_and_b32 v4, 1, v4
    s_and_b32 s68, s2, 7
    s_lshl1_add_u32 s68, s68, 3137
    v_lshrrev_b32 v8, 8, v0
    v_lshl_add_u32 v8, v8, 4, s68
    v_lshlrev_b32 v8, 8, v8
    v_cmpx_eq_u32 vcc, 1, v4
    ds_write_b16 v7, v6 offset:4216
    ds_write_b32 v7, v8 offset:4220
    s_mov_b64 exec, -1
    s_movk_i32 s68, 4096
    buffer_store_dword v5, v9, s[40:43], s68 offen
    s_waitcnt lgkmcnt(0)
    s_barrier
    s_mov_b64 exec, s[70:71]
    v_and_b32 v10, 0xffff, v125
    ds_add_rtn_u32 v10, v10, v12 offset:0
    s_mov_b64 exec, -1
    v_and_b32 v22, 0xffff, v100
    ds_add_rtn_u32 v22, v22, v12 offset:0
    v_and_b32 v23, 0xffff, v101
    ds_add_rtn_u32 v23, v23, v12 offset:0
    v_and_b32 v24, 0xffff, v102
    ds_add_rtn_u32 v24, v24, v12 offset:0
    v_and_b32 v25, 0xffff, v103
    ds_add_rtn_u32 v25, v25, v12 offset:0
    v_and_b32 v26, 0xffff, v104
    ds_add_rtn_u32 v26, v26, v12 offset:0
    v_and_b32 v27, 0xffff, v105
    ds_add_rtn_u32 v27, v27, v12 offset:0
    s_waitcnt lgkmcnt(3)
    v_and_b32 v8, 2, v22
    v_add_u32 v22, v22, v8
    v_mad_i32_i24 v8, v8, -5, v22
    ds_write_b32 v22, v76
    ds_write_b16_d16_hi v8, v100 offset:6
    v_and_b32 v9, 2, v23
    v_add_u32 v23, v23, v9
    v_mad_i32_i24 v9, v9, -5, v23
    ds_write_b32 v23, v77
    ds_write_b16_d16_hi v9, v101 offset:6
    v_and_b32 v8, 2, v24
    v_add_u32 v24, v24, v8
    v_mad_i32_i24 v8, v8, -5, v24
    ds_write_b32 v24, v78
    ds_write_b16_d16_hi v8, v102 offset:6
    s_mov_b64 exec, s[70:71]
    v_and_b32 v9, 2, v10
    v_add_u32 v10, v10, v9
    v_mad_i32_i24 v9, v9, -5, v10
    ds_write_b32 v10, v124
    ds_write_b16_d16_hi v9, v125 offset:6
    s_mov_b64 exec, -1
    s_mov_b32 s68, 65536
    buffer_store_dwordx4 v[44:47], v1, s[36:39], s68 offen sc1
    v_and_b32 v22, 0xffff, v106
    ds_add_rtn_u32 v22, v22, v12 offset:0
    v_and_b32 v23, 0xffff, v107
    ds_add_rtn_u32 v23, v23, v12 offset:0
    v_and_b32 v24, 0xffff, v108
    ds_add_rtn_u32 v24, v24, v12 offset:0
    s_waitcnt lgkmcnt(11)
    v_and_b32 v8, 2, v25
    v_add_u32 v25, v25, v8
    v_mad_i32_i24 v8, v8, -5, v25
    ds_write_b32 v25, v79
    ds_write_b16_d16_hi v8, v103 offset:6
    v_and_b32 v9, 2, v26
    v_add_u32 v26, v26, v9
    v_mad_i32_i24 v9, v9, -5, v26
    ds_write_b32 v26, v80
    ds_write_b16_d16_hi v9, v104 offset:6
    v_and_b32 v8, 2, v27
    v_add_u32 v27, v27, v8
    v_mad_i32_i24 v8, v8, -5, v27
    ds_write_b32 v27, v81
    ds_write_b16_d16_hi v8, v105 offset:6
    s_mov_b32 s68, 81920
    buffer_store_dwordx4 v[48:51], v1, s[36:39], s68 offen sc1
    v_and_b32 v25, 0xffff, v109
    ds_add_rtn_u32 v25, v25, v12 offset:0
    v_and_b32 v26, 0xffff, v110
    ds_add_rtn_u32 v26, v26, v12 offset:0
    v_and_b32 v27, 0xffff, v111
    ds_add_rtn_u32 v27, v27, v12 offset:0
    s_waitcnt lgkmcnt(9)
    v_and_b32 v8, 2, v22
    v_add_u32 v22, v22, v8
    v_mad_i32_i24 v8, v8, -5, v22
    ds_write_b32 v22, v82
    ds_write_b16_d16_hi v8, v106 offset:6
    v_and_b32 v9, 2, v23
    v_add_u32 v23, v23, v9
    v_mad_i32_i24 v9, v9, -5, v23
    ds_write_b32 v23, v83
    ds_write_b16_d16_hi v9, v107 offset:6
    v_and_b32 v8, 2, v24
    v_add_u32 v24, v24, v8
    v_mad_i32_i24 v8, v8, -5, v24
    ds_write_b32 v24, v84
    ds_write_b16_d16_hi v8, v108 offset:6
    s_mov_b32 s68, 98304
    buffer_store_dwordx4 v[52:55], v1, s[36:39], s68 offen sc1
    v_and_b32 v22, 0xffff, v112
    ds_add_rtn_u32 v22, v22, v12 offset:0
    v_and_b32 v23, 0xffff, v113
    ds_add_rtn_u32 v23, v23, v12 offset:0
    v_and_b32 v24, 0xffff, v114
    ds_add_rtn_u32 v24, v24, v12 offset:0
    s_waitcnt lgkmcnt(9)
    v_and_b32 v8, 2, v25
    v_add_u32 v25, v25, v8
    v_mad_i32_i24 v8, v8, -5, v25
    ds_write_b32 v25, v85
    ds_write_b16_d16_hi v8, v109 offset:6
    v_and_b32 v9, 2, v26
    v_add_u32 v26, v26, v9
    v_mad_i32_i24 v9, v9, -5, v26
    ds_write_b32 v26, v86
    ds_write_b16_d16_hi v9, v110 offset:6
    v_and_b32 v8, 2, v27
    v_add_u32 v27, v27, v8
    v_mad_i32_i24 v8, v8, -5, v27
    ds_write_b32 v27, v87
    ds_write_b16_d16_hi v8, v111 offset:6
    s_mov_b32 s68, 114688
    buffer_store_dwordx4 v[56:59], v1, s[36:39], s68 offen sc1
    v_and_b32 v25, 0xffff, v115
    ds_add_rtn_u32 v25, v25, v12 offset:0
    v_and_b32 v26, 0xffff, v116
    ds_add_rtn_u32 v26, v26, v12 offset:0
    v_and_b32 v27, 0xffff, v117
    ds_add_rtn_u32 v27, v27, v12 offset:0
    s_waitcnt lgkmcnt(9)
    v_and_b32 v8, 2, v22
    v_add_u32 v22, v22, v8
    v_mad_i32_i24 v8, v8, -5, v22
    ds_write_b32 v22, v88
    ds_write_b16_d16_hi v8, v112 offset:6
    v_and_b32 v9, 2, v23
    v_add_u32 v23, v23, v9
    v_mad_i32_i24 v9, v9, -5, v23
    ds_write_b32 v23, v89
    ds_write_b16_d16_hi v9, v113 offset:6
    v_and_b32 v8, 2, v24
    v_add_u32 v24, v24, v8
    v_mad_i32_i24 v8, v8, -5, v24
    ds_write_b32 v24, v90
    ds_write_b16_d16_hi v8, v114 offset:6
    s_mov_b32 s68, 131072
    buffer_store_dwordx4 v[60:63], v1, s[36:39], s68 offen sc1
    v_and_b32 v22, 0xffff, v118
    ds_add_rtn_u32 v22, v22, v12 offset:0
    v_and_b32 v23, 0xffff, v119
    ds_add_rtn_u32 v23, v23, v12 offset:0
    v_and_b32 v24, 0xffff, v120
    ds_add_rtn_u32 v24, v24, v12 offset:0
    s_waitcnt lgkmcnt(9)
    v_and_b32 v8, 2, v25
    v_add_u32 v25, v25, v8
    v_mad_i32_i24 v8, v8, -5, v25
    ds_write_b32 v25, v91
    ds_write_b16_d16_hi v8, v115 offset:6
    v_and_b32 v9, 2, v26
    v_add_u32 v26, v26, v9
    v_mad_i32_i24 v9, v9, -5, v26
    ds_write_b32 v26, v92
    ds_write_b16_d16_hi v9, v116 offset:6
    v_and_b32 v8, 2, v27
    v_add_u32 v27, v27, v8
    v_mad_i32_i24 v8, v8, -5, v27
    ds_write_b32 v27, v93
    ds_write_b16_d16_hi v8, v117 offset:6
    s_mov_b32 s68, 147456
    buffer_store_dwordx4 v[64:67], v1, s[36:39], s68 offen sc1
    v_and_b32 v25, 0xffff, v121
    ds_add_rtn_u32 v25, v25, v12 offset:0
    v_and_b32 v26, 0xffff, v122
    ds_add_rtn_u32 v26, v26, v12 offset:0
    v_and_b32 v27, 0xffff, v123
    ds_add_rtn_u32 v27, v27, v12 offset:0
    s_waitcnt lgkmcnt(9)
    v_and_b32 v8, 2, v22
    v_add_u32 v22, v22, v8
    v_mad_i32_i24 v8, v8, -5, v22
    ds_write_b32 v22, v94
    ds_write_b16_d16_hi v8, v118 offset:6
    v_and_b32 v9, 2, v23
    v_add_u32 v23, v23, v9
    v_mad_i32_i24 v9, v9, -5, v23
    ds_write_b32 v23, v95
    ds_write_b16_d16_hi v9, v119 offset:6
    v_and_b32 v8, 2, v24
    v_add_u32 v24, v24, v8
    v_mad_i32_i24 v8, v8, -5, v24
    ds_write_b32 v24, v96
    ds_write_b16_d16_hi v8, v120 offset:6
    s_waitcnt lgkmcnt(6)
    v_and_b32 v8, 2, v25
    v_add_u32 v25, v25, v8
    v_mad_i32_i24 v8, v8, -5, v25
    ds_write_b32 v25, v97
    ds_write_b16_d16_hi v8, v121 offset:6
    v_and_b32 v9, 2, v26
    v_add_u32 v26, v26, v9
    v_mad_i32_i24 v9, v9, -5, v26
    ds_write_b32 v26, v98
    ds_write_b16_d16_hi v9, v122 offset:6
    v_and_b32 v8, 2, v27
    v_add_u32 v27, v27, v8
    v_mad_i32_i24 v8, v8, -5, v27
    ds_write_b32 v27, v99
    ds_write_b16_d16_hi v8, v123 offset:6
    s_waitcnt lgkmcnt(0)
    s_barrier
    v_add_u32 v22, 0x10000, v1
    v_add_u32 v23, 0x20000, v1
    ds_read_b128 v[76:79], v1 offset:4224
    ds_read_b128 v[80:83], v1 offset:20608
    ds_read_b128 v[84:87], v1 offset:36992
    ds_read_b128 v[88:91], v1 offset:53376
    ds_read_b128 v[92:95], v22 offset:4224
    ds_read_b128 v[96:99], v22 offset:20608
    ds_read_b128 v[100:103], v22 offset:36992
    ds_read_b128 v[104:107], v22 offset:53376
    ds_read_b128 v[108:111], v23 offset:4224
    ds_read_b128 v[112:115], v23 offset:20608
    s_mov_b32 s68, 0
    s_waitcnt lgkmcnt(9)
    buffer_store_dwordx4 v[76:79], v1, s[80:83], s68 offen sc1
    s_mov_b32 s68, 16384
    s_waitcnt lgkmcnt(8)
    buffer_store_dwordx4 v[80:83], v1, s[80:83], s68 offen sc1
    s_mov_b32 s68, 32768
    s_waitcnt lgkmcnt(7)
    buffer_store_dwordx4 v[84:87], v1, s[80:83], s68 offen sc1
    s_mov_b32 s68, 49152
    s_waitcnt lgkmcnt(6)
    buffer_store_dwordx4 v[88:91], v1, s[80:83], s68 offen sc1
    s_mov_b32 s68, 65536
    s_waitcnt lgkmcnt(5)
    buffer_store_dwordx4 v[92:95], v1, s[80:83], s68 offen sc1
    s_mov_b32 s68, 81920
    s_waitcnt lgkmcnt(4)
    buffer_store_dwordx4 v[96:99], v1, s[80:83], s68 offen sc1
    s_mov_b32 s68, 98304
    s_waitcnt lgkmcnt(3)
    buffer_store_dwordx4 v[100:103], v1, s[80:83], s68 offen sc1
    s_mov_b32 s68, 114688
    s_waitcnt lgkmcnt(2)
    buffer_store_dwordx4 v[104:107], v1, s[80:83], s68 offen sc1
    s_mov_b32 s68, 131072
    s_waitcnt lgkmcnt(1)
    buffer_store_dwordx4 v[108:111], v1, s[80:83], s68 offen sc1
    s_mov_b32 s68, 147456
    s_waitcnt lgkmcnt(0)
    buffer_store_dwordx4 v[112:115], v1, s[80:83], s68 offen sc1
Lk1_end:
    s_endpgm

.globl acc_kernel
.p2align 8
.type acc_kernel,@function
acc_kernel:
    s_cmp_ge_u32 s2, 256
    s_cbranch_scc1 Lk2_end
    s_load_dwordx2 s[4:5], s[0:1], 0
    s_load_dwordx2 s[6:7], s[0:1], 24
    s_load_dwordx2 s[8:9], s[0:1], 40
    s_load_dwordx2 s[10:11], s[0:1], 88
    s_load_dwordx4 s[12:15], s[0:1], 96
    v_lshrrev_b32 v3, 6, v0
    v_and_b32 v1, 63, v0
    v_readfirstlane_b32 s48, v3
    s_and_b32 s49, s2, 7
    s_lshl_b32 s49, s49, 5
    s_lshr_b32 s50, s2, 3
    s_add_u32 s49, s49, s50
    s_mov_b32 s52, 0x3f000080
    s_mov_b32 s53, 0x80008000
    s_mov_b32 s54, 0xfffff
    s_mov_b32 s55, 0xffff0000
    s_mov_b32 s56, 0xfff0
    s_mov_b32 s73, 0x07060302
    s_mov_b32 s58, 0
    s_mul_i32 s57, s49, 3125
    s_add_u32 s59, s57, 3125
    s_andn2_b32 s57, s57, 3
    s_andn2_b32 s59, s59, 3
    s_sub_u32 s59, s59, s57
    s_sub_u32 s50, s59, 3072
    v_cmp_gt_u32 s[60:61], s50, v0
    v_lshrrev_b32 v237, 5, v1
    v_lshlrev_b32 v237, 4, v237
    v_mov_b32 v239, v237
    v_mov_b32 v236, 0
    v_mov_b32 v238, 0
    s_waitcnt lgkmcnt(0)
    s_load_dwordx4 s[96:99], s[8:9], 0
    s_mov_b32 s24, s14
    s_mov_b32 s25, s15
    s_mov_b32 s26, 268435456
    s_mov_b32 s27, 0x20000
    v_lshlrev_b32 v168, 12, v0
    s_lshl_b32 s50, s49, 4
    s_add_u32 s50, s50, 82837504
    buffer_load_dwordx4 v[156:159], v168, s[24:27], s50 offen
    s_lshr_b32 s50, s2, 3
    s_and_b32 s51, s50, 1
    s_mul_i32 s51, s51, 160
    s_add_u32 s51, s51, 4720
    s_and_b32 s90, s2, 7
    s_mul_i32 s51, s51, s90
    s_lshl_b32 s90, s48, 6
    s_add_u32 s90, s90, s50
    s_mul_i32 s90, s90, 158976
    s_add_u32 s90, s90, s51
    s_add_u32 s90, s90, 12288
    s_cmp_lt_u32 s50, 44
    s_cselect_b32 s90, s90, 268435456
    v_min_u32 v253, 38, v1
    v_lshlrev_b32 v253, 7, v253
    buffer_load_dword v246, v253, s[24:27], s90 offen
    s_add_u32 s90, s90, 5087232
    s_cmp_lt_u32 s50, 12
    s_cselect_b32 s90, s90, 268435456
    buffer_load_dword v253, v253, s[24:27], s90 offen
    s_lshl_b32 s50, s57, 1
    s_lshl_b32 s51, s57, 5
    s_add_u32 s28, s6, s50
    s_addc_u32 s29, s7, 0
    s_mov_b32 s30, 0
    s_mov_b32 s31, 0x20000
    s_mov_b32 s16, s4
    s_mov_b32 s17, s5
    s_or_b32 s17, s17, 0x200000
    s_mov_b32 s18, 800000
    s_mov_b32 s19, 0x20000
    s_mov_b32 s20, s4
    s_mov_b32 s21, s5
    s_mov_b32 s22, 25600000
    s_mov_b32 s23, 0x20000
    s_add_u32 s32, s4, s51
    s_addc_u32 s33, s5, 0
    s_mov_b32 s34, 0
    s_mov_b32 s35, 0x20000
    s_add_u32 s36, s10, s51
    s_addc_u32 s37, s11, 0
    s_mov_b32 s38, 0
    s_mov_b32 s39, 0x20000
    s_lshl_b32 s30, s59, 1
    s_lshl_b32 s34, s59, 5
    s_lshl_b32 s38, s59, 5
    s_waitcnt lgkmcnt(0)
    s_lshl_b32 s40, s96, 16
    s_and_b32 s41, s96, 0xffff0000
    s_lshl_b32 s42, s97, 16
    s_and_b32 s43, s97, 0xffff0000
    s_lshl_b32 s44, s98, 16
    s_and_b32 s45, s98, 0xffff0000
    s_lshl_b32 s46, s99, 16
    s_and_b32 s47, s99, 0xffff0000
    s_mov_b32 s69, 0x40731710
    v_mov_b32 v224, s69
    v_mul_f32 v216, s40, v224
    v_mul_f32 v217, s41, v224
    v_mul_f32 v218, s42, v224
    v_mul_f32 v219, s43, v224
    v_mul_f32 v220, s44, v224
    v_mul_f32 v221, s45, v224
    v_mul_f32 v222, s46, v224
    v_mul_f32 v223, s47, v224
    v_readfirstlane_b32 s40, v216
    v_readfirstlane_b32 s41, v217
    v_readfirstlane_b32 s42, v218
    v_readfirstlane_b32 s43, v219
    v_readfirstlane_b32 s44, v220
    v_readfirstlane_b32 s45, v221
    v_readfirstlane_b32 s46, v222
    v_readfirstlane_b32 s47, v223
    v_mov_b32 v96, 0
    v_bfrev_b32 v100, 1
    v_mov_b32 v97, 0
    v_bfrev_b32 v101, 1
    v_mov_b32 v98, 0
    v_bfrev_b32 v102, 1
    v_mov_b32 v99, 0
    v_bfrev_b32 v103, 1
    v_lshlrev_b32 v104, 4, v0
    v_lshlrev_b32 v105, 3, v0
    s_mul_i32 s70, s48, 1088
    v_lshl_add_u32 v106, v1, 4, s70
    ds_write_b64 v105, v[96:97] offset:21504
    ds_write_b128 v106, v[100:103] offset:12800
    ds_write_b128 v106, v[100:103] offset:12864
    s_movk_i32 s50, 400
    v_cmpx_gt_u32 vcc, s50, v0
    ds_write_b128 v104, v[96:99] offset:0
    ds_write_b128 v104, v[96:99] offset:6400
    s_mov_b64 exec, -1
    v_mov_b32 v249, 1
    v_mov_b32 v250, 4
    v_mul_u32_u24 v251, 12, v1
    s_lshl_b32 s50, s48, 9
    v_lshl_add_u32 v252, v1, 3, s50
    s_lshl_b32 s50, s2, 3
    s_add_u32 s50, s50, s48
    s_mul_i32 s50, s50, 25
    v_min_u32 v254, 24, v1
    v_add_lshl_u32 v254, v254, s50, 7
    s_movk_i32 s50, 1024
    v_mov_b32 v107, 13248
    v_mad_u32_u24 v107, v0, v107, s50
    s_waitcnt vmcnt(2)
    v_add_u32 v184, 0x10000, v156
    v_bfe_u32 v160, v156, 16, 1
    v_lshrrev_b32 v184, 17, v184
    v_and_b32 v156, 0xffff, v156
    v_lshl_or_b32 v160, v160, 20, v184
    v_add_u32 v185, 0x10000, v157
    v_bfe_u32 v161, v157, 16, 1
    v_lshrrev_b32 v185, 17, v185
    v_and_b32 v157, 0xffff, v157
    v_lshl_or_b32 v161, v161, 20, v185
    v_add_u32 v186, 0x10000, v158
    v_bfe_u32 v162, v158, 16, 1
    v_lshrrev_b32 v186, 17, v186
    v_and_b32 v158, 0xffff, v158
    v_lshl_or_b32 v162, v162, 20, v186
    v_add_u32 v187, 0x10000, v159
    v_bfe_u32 v163, v159, 16, 1
    v_lshrrev_b32 v187, 17, v187
    v_and_b32 v159, 0xffff, v159
    v_lshl_or_b32 v163, v163, 20, v187
    v_add_u32_dpp v160, v160, v160 row_shr:1 row_mask:0xf bank_mask:0xf
    v_add_u32_dpp v161, v161, v161 row_shr:1 row_mask:0xf bank_mask:0xf
    v_add_u32_dpp v162, v162, v162 row_shr:1 row_mask:0xf bank_mask:0xf
    v_add_u32_dpp v163, v163, v163 row_shr:1 row_mask:0xf bank_mask:0xf
    v_add_u32_dpp v160, v160, v160 row_shr:2 row_mask:0xf bank_mask:0xf
    v_add_u32_dpp v161, v161, v161 row_shr:2 row_mask:0xf bank_mask:0xf
    v_add_u32_dpp v162, v162, v162 row_shr:2 row_mask:0xf bank_mask:0xf
    v_add_u32_dpp v163, v163, v163 row_shr:2 row_mask:0xf bank_mask:0xf
    v_add_u32_dpp v160, v160, v160 row_shr:4 row_mask:0xf bank_mask:0xf
    v_add_u32_dpp v161, v161, v161 row_shr:4 row_mask:0xf bank_mask:0xf
    v_add_u32_dpp v162, v162, v162 row_shr:4 row_mask:0xf bank_mask:0xf
    v_add_u32_dpp v163, v163, v163 row_shr:4 row_mask:0xf bank_mask:0xf
    v_add_u32_dpp v160, v160, v160 row_shr:8 row_mask:0xf bank_mask:0xf
    v_add_u32_dpp v161, v161, v161 row_shr:8 row_mask:0xf bank_mask:0xf
    v_add_u32_dpp v162, v162, v162 row_shr:8 row_mask:0xf bank_mask:0xf
    v_add_u32_dpp v163, v163, v163 row_shr:8 row_mask:0xf bank_mask:0xf
    v_add_u32_dpp v160, v160, v160 row_bcast:15 row_mask:0xa bank_mask:0xf
    v_add_u32_dpp v161, v161, v161 row_bcast:15 row_mask:0xa bank_mask:0xf
    v_add_u32_dpp v162, v162, v162 row_bcast:15 row_mask:0xa bank_mask:0xf
    v_add_u32_dpp v163, v163, v163 row_bcast:15 row_mask:0xa bank_mask:0xf
    v_add_u32_dpp v160, v160, v160 row_bcast:31 row_mask:0xc bank_mask:0xf
    v_add_u32_dpp v161, v161, v161 row_bcast:31 row_mask:0xc bank_mask:0xf
    v_add_u32_dpp v162, v162, v162 row_bcast:31 row_mask:0xc bank_mask:0xf
    v_add_u32_dpp v163, v163, v163 row_bcast:31 row_mask:0xc bank_mask:0xf
    s_movk_i32 s51, 960
    v_lshrrev_b32 v188, 20, v160
    v_and_b32 v160, 0xfffff, v160
    v_add_u32 v164, v156, v107
    v_sub_u32 v188, v160, v188
    v_sub_u32 v164, v164, v160
    v_add_u32 v188, v188, v160
    v_mul_u32_u24 v164, 12, v164
    v_subrev_u32 v104, 640, v160
    v_cmpx_lt_u32 vcc, 320, v104
    v_mov_b32 v188, 0x1000000
    s_mov_b64 exec, -1
    v_lshrrev_b32 v189, 20, v161
    v_and_b32 v161, 0xfffff, v161
    v_add_u32 v165, v157, v107
    v_sub_u32 v189, v161, v189
    v_sub_u32 v165, v165, v161
    v_add_u32 v189, v189, v161
    v_mul_u32_u24 v165, 12, v165
    v_subrev_u32 v104, 640, v161
    v_cmpx_lt_u32 vcc, 320, v104
    v_mov_b32 v189, 0x1000000
    s_mov_b64 exec, -1
    v_lshrrev_b32 v190, 20, v162
    v_and_b32 v162, 0xfffff, v162
    v_add_u32 v166, v158, v107
    v_sub_u32 v190, v162, v190
    v_sub_u32 v166, v166, v162
    v_add_u32 v190, v190, v162
    v_mul_u32_u24 v166, 12, v166
    v_subrev_u32 v104, 640, v162
    v_cmpx_lt_u32 vcc, 320, v104
    v_mov_b32 v190, 0x1000000
    s_mov_b64 exec, -1
    v_lshrrev_b32 v191, 20, v163
    v_and_b32 v163, 0xfffff, v163
    v_add_u32 v167, v159, v107
    v_sub_u32 v191, v163, v191
    v_sub_u32 v167, v167, v163
    v_add_u32 v191, v191, v163
    v_mul_u32_u24 v167, 12, v167
    v_subrev_u32 v104, 640, v163
    v_cmpx_lt_u32 vcc, 320, v104
    v_mov_b32 v191, 0x1000000
    s_mov_b64 exec, -1
    s_nop 1
    v_readlane_b32 s80, v160, 63
    v_readlane_b32 s81, v161, 63
    v_readlane_b32 s82, v162, 63
    v_readlane_b32 s83, v163, 63
    s_lshl_b32 s50, s48, 4
    v_mov_b32 v104, s50
    s_mov_b32 exec_lo, 0
    s_mov_b32 exec_hi, 0x80000000
    ds_write_b128 v104, v[188:191] offset:25600
    s_mov_b64 exec, -1
    s_lshl_b32 s50, s48, 9
    v_subrev_u32 v104, 1, v160
    v_lshlrev_b32 v105, v104, v249
    v_lshrrev_b32 v104, 5, v104
    v_lshl_add_u32 v104, v104, 2, s50
    v_cmpx_ge_u32 vcc, s51, v160
    v_cmpx_ne_u32 vcc, 0, v184
    s_nop 1
    v_mbcnt_lo_u32_b32 v106, vcc_lo, 0
    v_mbcnt_hi_u32_b32 v106, vcc_hi, v106
    v_lshl_add_u32 v106, v106, 2, s70
    ds_or_b32 v104, v105 offset:21504
    ds_write_b32 v106, v164 offset:12800
    s_mov_b64 exec, -1
    v_subrev_u32 v104, 1, v161
    v_lshlrev_b32 v105, v104, v249
    v_lshrrev_b32 v104, 5, v104
    v_lshl_add_u32 v104, v104, 2, s50
    v_cmpx_ge_u32 vcc, s51, v161
    v_cmpx_ne_u32 vcc, 0, v185
    s_nop 1
    v_mbcnt_lo_u32_b32 v106, vcc_lo, 0
    v_mbcnt_hi_u32_b32 v106, vcc_hi, v106
    v_lshl_add_u32 v106, v106, 2, s70
    ds_or_b32 v104, v105 offset:21632
    ds_write_b32 v106, v165 offset:13072
    s_mov_b64 exec, -1
    v_subrev_u32 v104, 1, v162
    v_lshlrev_b32 v105, v104, v249
    v_lshrrev_b32 v104, 5, v104
    v_lshl_add_u32 v104, v104, 2, s50
    v_cmpx_ge_u32 vcc, s51, v162
    v_cmpx_ne_u32 vcc, 0, v186
    s_nop 1
    v_mbcnt_lo_u32_b32 v106, vcc_lo, 0
    v_mbcnt_hi_u32_b32 v106, vcc_hi, v106
    v_lshl_add_u32 v106, v106, 2, s70
    ds_or_b32 v104, v105 offset:21760
    ds_write_b32 v106, v166 offset:13344
    s_mov_b64 exec, -1
    v_subrev_u32 v104, 1, v163
    v_lshlrev_b32 v105, v104, v249
    v_lshrrev_b32 v104, 5, v104
    v_lshl_add_u32 v104, v104, 2, s50
    v_cmpx_ge_u32 vcc, s51, v163
    v_cmpx_ne_u32 vcc, 0, v187
    s_nop 1
    v_mbcnt_lo_u32_b32 v106, vcc_lo, 0
    v_mbcnt_hi_u32_b32 v106, vcc_hi, v106
    v_lshl_add_u32 v106, v106, 2, s70
    ds_or_b32 v104, v105 offset:21888
    ds_write_b32 v106, v167 offset:13616
    s_mov_b64 exec, -1
    v_and_b32 v104, 7, v0
    v_lshlrev_b32 v104, 4, v104
    s_waitcnt lgkmcnt(0)
    s_barrier
    ds_read_b128 v[188:191], v104 offset:25600
    s_mov_b32 s64, 0
    s_waitcnt lgkmcnt(0)
    v_add_u32_dpp v188, v188, v188 row_shr:1 row_mask:0xf bank_mask:0xf
    v_add_u32_dpp v189, v189, v189 row_shr:1 row_mask:0xf bank_mask:0xf
    v_add_u32_dpp v190, v190, v190 row_shr:1 row_mask:0xf bank_mask:0xf
    v_add_u32_dpp v191, v191, v191 row_shr:1 row_mask:0xf bank_mask:0xf
    v_add_u32_dpp v188, v188, v188 row_shr:2 row_mask:0xf bank_mask:0xf
    v_add_u32_dpp v189, v189, v189 row_shr:2 row_mask:0xf bank_mask:0xf
    v_add_u32_dpp v190, v190, v190 row_shr:2 row_mask:0xf bank_mask:0xf
    v_add_u32_dpp v191, v191, v191 row_shr:2 row_mask:0xf bank_mask:0xf
    v_add_u32_dpp v188, v188, v188 row_shr:4 row_mask:0xf bank_mask:0xf
    v_add_u32_dpp v189, v189, v189 row_shr:4 row_mask:0xf bank_mask:0xf
    v_add_u32_dpp v190, v190, v190 row_shr:4 row_mask:0xf bank_mask:0xf
    v_add_u32_dpp v191, v191, v191 row_shr:4 row_mask:0xf bank_mask:0xf
    v_readlane_b32 s65, v188, 7
    v_readlane_b32 s66, v189, 7
    v_readlane_b32 s67, v190, 7
    v_readlane_b32 s68, v191, 7
    s_add_u32 s66, s66, s65
    s_add_u32 s67, s67, s66
    s_add_u32 s68, s68, s67
    s_cmp_gt_u32 s68, 52224
    s_cbranch_scc1 Lk2_fb
    s_cmp_ge_u32 s66, 29696
    s_cbranch_scc1 Lk2_fb
    s_lshl_b32 s50, s48, 9
    v_lshl_add_u32 v255, v1, 2, s50
    ds_read_b32 v255, v255 offset:21504
    s_lshl_b32 s50, s48, 9
    v_lshl_add_u32 v248, v1, 2, s50
    ds_read_b32 v248, v248 offset:21760
    s_mov_b32 s71, 0
    s_waitcnt lgkmcnt(0)
    s_mul_i32 s70, s48, 1088
    v_readlane_b32 s74, v255, 0
    v_readlane_b32 s75, v255, 1
    s_bcnt1_i32_b64 s50, s[74:75]
    v_mbcnt_lo_u32_b32 v244, s74, 0
    v_mbcnt_hi_u32_b32 v244, s75, v244
    v_lshl_add_u32 v244, v244, 2, s70
    s_lshl2_add_u32 s70, s50, s70
    ds_read_b32 v244, v244 offset:12800
    v_readlane_b32 s74, v255, 2
    v_readlane_b32 s75, v255, 3
    s_bcnt1_i32_b64 s50, s[74:75]
    v_mbcnt_lo_u32_b32 v245, s74, 0
    v_mbcnt_hi_u32_b32 v245, s75, v245
    v_lshl_add_u32 v245, v245, 2, s70
    s_lshl2_add_u32 s70, s50, s70
    ds_read_b32 v245, v245 offset:12800
    s_movk_i32 s51, 0
    s_waitcnt lgkmcnt(1)
    v_add_u32 v244, v244, v251
    buffer_load_dwordx3 v[96:98], v244, s[24:27], s51 offen
    v_readlane_b32 s74, v255, 4
    v_readlane_b32 s75, v255, 5
    s_bcnt1_i32_b64 s50, s[74:75]
    v_mbcnt_lo_u32_b32 v244, s74, 0
    v_mbcnt_hi_u32_b32 v244, s75, v244
    v_lshl_add_u32 v244, v244, 2, s70
    s_lshl2_add_u32 s70, s50, s70
    ds_read_b32 v244, v244 offset:12800
    s_movk_i32 s51, 768
    s_waitcnt lgkmcnt(1)
    v_add_u32 v245, v245, v251
    buffer_load_dwordx3 v[100:102], v245, s[24:27], s51 offen
    v_readlane_b32 s74, v255, 6
    v_readlane_b32 s75, v255, 7
    s_bcnt1_i32_b64 s50, s[74:75]
    v_mbcnt_lo_u32_b32 v245, s74, 0
    v_mbcnt_hi_u32_b32 v245, s75, v245
    v_lshl_add_u32 v245, v245, 2, s70
    s_lshl2_add_u32 s70, s50, s70
    ds_read_b32 v245, v245 offset:12800
    s_movk_i32 s51, 1536
    s_waitcnt lgkmcnt(1)
    v_add_u32 v244, v244, v251
    buffer_load_dwordx3 v[104:106], v244, s[24:27], s51 offen
    v_readlane_b32 s74, v255, 8
    v_readlane_b32 s75, v255, 9
    s_bcnt1_i32_b64 s50, s[74:75]
    v_mbcnt_lo_u32_b32 v244, s74, 0
    v_mbcnt_hi_u32_b32 v244, s75, v244
    v_lshl_add_u32 v244, v244, 2, s70
    s_lshl2_add_u32 s70, s50, s70
    ds_read_b32 v244, v244 offset:12800
    s_movk_i32 s51, 2304
    s_waitcnt lgkmcnt(1)
    v_add_u32 v245, v245, v251
    buffer_load_dwordx3 v[108:110], v245, s[24:27], s51 offen
    v_readlane_b32 s74, v255, 10
    v_readlane_b32 s75, v255, 11
    s_bcnt1_i32_b64 s50, s[74:75]
    v_mbcnt_lo_u32_b32 v245, s74, 0
    v_mbcnt_hi_u32_b32 v245, s75, v245
    v_lshl_add_u32 v245, v245, 2, s70
    s_lshl2_add_u32 s70, s50, s70
    ds_read_b32 v245, v245 offset:12800
    s_movk_i32 s51, 3072
    s_waitcnt lgkmcnt(1)
    v_add_u32 v244, v244, v251
    buffer_load_dwordx3 v[112:114], v244, s[24:27], s51 offen
    s_waitcnt vmcnt(4)
    v_lshrrev_b32 v246, 6, v96
    v_lshrrev_b32 v247, 6, v98
    v_and_b32 v246, 0x3ffc, v246
    v_and_b32 v247, 0x3ffc, v247
    ds_add_rtn_u32 v246, v246, v250 offset:0
    ds_add_rtn_u32 v247, v247, v250 offset:0
    v_readlane_b32 s74, v255, 12
    v_readlane_b32 s75, v255, 13
    s_bcnt1_i32_b64 s50, s[74:75]
    v_mbcnt_lo_u32_b32 v244, s74, 0
    v_mbcnt_hi_u32_b32 v244, s75, v244
    v_lshl_add_u32 v244, v244, 2, s70
    s_lshl2_add_u32 s70, s50, s70
    ds_read_b32 v244, v244 offset:12800
    s_movk_i32 s51, 3840
    s_waitcnt lgkmcnt(3)
    v_add_u32 v245, v245, v251
    buffer_load_dwordx3 v[116:118], v245, s[24:27], s51 offen
    s_waitcnt vmcnt(4)
    v_lshrrev_b32 v236, 6, v100
    v_lshrrev_b32 v238, 6, v102
    v_and_b32 v236, 0x3ffc, v236
    v_and_b32 v238, 0x3ffc, v238
    ds_add_rtn_u32 v236, v236, v250 offset:0
    ds_add_rtn_u32 v238, v238, v250 offset:0
    s_waitcnt lgkmcnt(3)
    v_lshl_or_b32 v99, v97, 16, v247
    v_and_or_b32 v97, v97, s55, v246
    v_readlane_b32 s74, v255, 14
    v_readlane_b32 s75, v255, 15
    s_bcnt1_i32_b64 s50, s[74:75]
    v_mbcnt_lo_u32_b32 v245, s74, 0
    v_mbcnt_hi_u32_b32 v245, s75, v245
    v_lshl_add_u32 v245, v245, 2, s70
    s_lshl2_add_u32 s70, s50, s70
    ds_read_b32 v245, v245 offset:12800
    s_movk_i32 s51, 4608
    s_waitcnt lgkmcnt(3)
    v_add_u32 v244, v244, v251
    buffer_load_dwordx3 v[120:122], v244, s[24:27], s51 offen
    s_waitcnt vmcnt(4)
    v_lshrrev_b32 v246, 6, v104
    v_lshrrev_b32 v247, 6, v106
    v_and_b32 v246, 0x3ffc, v246
    v_and_b32 v247, 0x3ffc, v247
    ds_add_rtn_u32 v246, v246, v250 offset:0
    ds_add_rtn_u32 v247, v247, v250 offset:0
    s_waitcnt lgkmcnt(3)
    v_lshl_or_b32 v103, v101, 16, v238
    v_and_or_b32 v101, v101, s55, v236
    v_readlane_b32 s74, v255, 16
    v_readlane_b32 s75, v255, 17
    s_bcnt1_i32_b64 s50, s[74:75]
    v_mbcnt_lo_u32_b32 v244, s74, 0
    v_mbcnt_hi_u32_b32 v244, s75, v244
    v_lshl_add_u32 v244, v244, 2, s70
    s_lshl2_add_u32 s70, s50, s70
    ds_read_b32 v244, v244 offset:12800
    s_movk_i32 s51, 5376
    s_waitcnt lgkmcnt(3)
    v_add_u32 v245, v245, v251
    buffer_load_dwordx3 v[124:126], v245, s[24:27], s51 offen
    s_waitcnt vmcnt(4)
    v_lshrrev_b32 v236, 6, v108
    v_lshrrev_b32 v238, 6, v110
    v_and_b32 v236, 0x3ffc, v236
    v_and_b32 v238, 0x3ffc, v238
    ds_add_rtn_u32 v236, v236, v250 offset:0
    ds_add_rtn_u32 v238, v238, v250 offset:0
    s_waitcnt lgkmcnt(3)
    v_lshl_or_b32 v107, v105, 16, v247
    v_and_or_b32 v105, v105, s55, v246
    v_readlane_b32 s74, v255, 18
    v_readlane_b32 s75, v255, 19
    s_bcnt1_i32_b64 s50, s[74:75]
    v_mbcnt_lo_u32_b32 v245, s74, 0
    v_mbcnt_hi_u32_b32 v245, s75, v245
    v_lshl_add_u32 v245, v245, 2, s70
    s_lshl2_add_u32 s70, s50, s70
    ds_read_b32 v245, v245 offset:12800
    s_movk_i32 s51, 6144
    s_waitcnt lgkmcnt(3)
    v_add_u32 v244, v244, v251
    buffer_load_dwordx3 v[128:130], v244, s[24:27], s51 offen
    s_waitcnt vmcnt(4)
    v_lshrrev_b32 v246, 6, v112
    v_lshrrev_b32 v247, 6, v114
    v_and_b32 v246, 0x3ffc, v246
    v_and_b32 v247, 0x3ffc, v247
    ds_add_rtn_u32 v246, v246, v250 offset:0
    ds_add_rtn_u32 v247, v247, v250 offset:0
    s_waitcnt lgkmcnt(3)
    v_lshl_or_b32 v111, v109, 16, v238
    v_and_or_b32 v109, v109, s55, v236
    v_readlane_b32 s74, v255, 20
    v_readlane_b32 s75, v255, 21
    s_bcnt1_i32_b64 s50, s[74:75]
    v_mbcnt_lo_u32_b32 v244, s74, 0
    v_mbcnt_hi_u32_b32 v244, s75, v244
    v_lshl_add_u32 v244, v244, 2, s70
    s_lshl2_add_u32 s70, s50, s70
    ds_read_b32 v244, v244 offset:12800
    s_movk_i32 s51, 6912
    s_waitcnt lgkmcnt(3)
    v_add_u32 v245, v245, v251
    buffer_load_dwordx3 v[132:134], v245, s[24:27], s51 offen
    s_waitcnt vmcnt(4)
    v_lshrrev_b32 v236, 6, v116
    v_lshrrev_b32 v238, 6, v118
    v_and_b32 v236, 0x3ffc, v236
    v_and_b32 v238, 0x3ffc, v238
    ds_add_rtn_u32 v236, v236, v250 offset:0
    ds_add_rtn_u32 v238, v238, v250 offset:0
    s_waitcnt lgkmcnt(3)
    v_lshl_or_b32 v115, v113, 16, v247
    v_and_or_b32 v113, v113, s55, v246
    v_readlane_b32 s74, v255, 22
    v_readlane_b32 s75, v255, 23
    s_bcnt1_i32_b64 s50, s[74:75]
    v_mbcnt_lo_u32_b32 v245, s74, 0
    v_mbcnt_hi_u32_b32 v245, s75, v245
    v_lshl_add_u32 v245, v245, 2, s70
    s_lshl2_add_u32 s70, s50, s70
    ds_read_b32 v245, v245 offset:12800
    s_movk_i32 s51, 7680
    s_waitcnt lgkmcnt(3)
    v_add_u32 v244, v244, v251
    buffer_load_dwordx3 v[136:138], v244, s[24:27], s51 offen
    s_waitcnt vmcnt(4)
    v_lshrrev_b32 v246, 6, v120
    v_lshrrev_b32 v247, 6, v122
    v_and_b32 v246, 0x3ffc, v246
    v_and_b32 v247, 0x3ffc, v247
    ds_add_rtn_u32 v246, v246, v250 offset:0
    ds_add_rtn_u32 v247, v247, v250 offset:0
    s_waitcnt lgkmcnt(3)
    v_lshl_or_b32 v119, v117, 16, v238
    v_and_or_b32 v117, v117, s55, v236
    v_readlane_b32 s74, v255, 24
    v_readlane_b32 s75, v255, 25
    s_bcnt1_i32_b64 s50, s[74:75]
    v_mbcnt_lo_u32_b32 v244, s74, 0
    v_mbcnt_hi_u32_b32 v244, s75, v244
    v_lshl_add_u32 v244, v244, 2, s70
    s_lshl2_add_u32 s70, s50, s70
    ds_read_b32 v244, v244 offset:12800
    s_movk_i32 s51, 8448
    s_waitcnt lgkmcnt(3)
    v_add_u32 v245, v245, v251
    buffer_load_dwordx3 v[140:142], v245, s[24:27], s51 offen
    s_waitcnt vmcnt(4)
    v_lshrrev_b32 v236, 6, v124
    v_lshrrev_b32 v238, 6, v126
    v_and_b32 v236, 0x3ffc, v236
    v_and_b32 v238, 0x3ffc, v238
    ds_add_rtn_u32 v236, v236, v250 offset:0
    ds_add_rtn_u32 v238, v238, v250 offset:0
    s_waitcnt lgkmcnt(3)
    v_lshl_or_b32 v123, v121, 16, v247
    v_and_or_b32 v121, v121, s55, v246
    s_movk_i32 s51, 9216
    s_waitcnt lgkmcnt(2)
    v_add_u32 v244, v244, v251
    buffer_load_dwordx3 v[144:146], v244, s[24:27], s51 offen
    s_cmp_le_u32 s80, 832
    s_cbranch_scc1 Lg0
    v_readlane_b32 s74, v255, 26
    v_readlane_b32 s75, v255, 27
    s_bcnt1_i32_b64 s50, s[74:75]
    v_mbcnt_lo_u32_b32 v245, s74, 0
    v_mbcnt_hi_u32_b32 v245, s75, v245
    v_lshl_add_u32 v245, v245, 2, s70
    s_lshl2_add_u32 s70, s50, s70
    ds_read_b32 v245, v245 offset:12800
    s_movk_i32 s51, 9984
    s_waitcnt lgkmcnt(0)
    v_add_u32 v245, v245, v251
    buffer_load_dwordx3 v[148:150], v245, s[24:27], s51 offen
    s_cmp_le_u32 s80, 896
    s_cbranch_scc1 Lg0
    v_readlane_b32 s74, v255, 28
    v_readlane_b32 s75, v255, 29
    s_bcnt1_i32_b64 s50, s[74:75]
    v_mbcnt_lo_u32_b32 v244, s74, 0
    v_mbcnt_hi_u32_b32 v244, s75, v244
    v_lshl_add_u32 v244, v244, 2, s70
    s_lshl2_add_u32 s70, s50, s70
    ds_read_b32 v244, v244 offset:12800
    s_movk_i32 s51, 10752
    s_waitcnt lgkmcnt(0)
    v_add_u32 v244, v244, v251
    buffer_load_dwordx3 v[152:154], v244, s[24:27], s51 offen
Lg0:
    s_nop 3
    s_mul_i32 s70, s48, 1088
    v_readlane_b32 s74, v255, 32
    v_readlane_b32 s75, v255, 33
    s_bcnt1_i32_b64 s50, s[74:75]
    v_mbcnt_lo_u32_b32 v245, s74, 0
    v_mbcnt_hi_u32_b32 v245, s75, v245
    v_lshl_add_u32 v245, v245, 2, s70
    s_lshl2_add_u32 s70, s50, s70
    ds_read_b32 v245, v245 offset:13072
    s_waitcnt vmcnt(4)
    v_lshrrev_b32 v246, 6, v128
    v_lshrrev_b32 v247, 6, v130
    v_and_b32 v246, 0x3ffc, v246
    v_and_b32 v247, 0x3ffc, v247
    ds_add_rtn_u32 v246, v246, v250 offset:0
    ds_add_rtn_u32 v247, v247, v250 offset:0
    s_waitcnt lgkmcnt(3)
    v_lshl_or_b32 v127, v125, 16, v238
    v_and_or_b32 v125, v125, s55, v236
    v_readlane_b32 s74, v255, 34
    v_readlane_b32 s75, v255, 35
    s_bcnt1_i32_b64 s50, s[74:75]
    v_mbcnt_lo_u32_b32 v244, s74, 0
    v_mbcnt_hi_u32_b32 v244, s75, v244
    v_lshl_add_u32 v244, v244, 2, s70
    s_lshl2_add_u32 s70, s50, s70
    ds_read_b32 v244, v244 offset:13072
    s_movk_i32 s51, 0
    s_waitcnt lgkmcnt(3)
    v_add_u32 v245, v245, v251
    buffer_load_dwordx3 v[156:158], v245, s[24:27], s51 offen
    s_waitcnt vmcnt(4)
    v_lshrrev_b32 v236, 6, v132
    v_lshrrev_b32 v238, 6, v134
    v_and_b32 v236, 0x3ffc, v236
    v_and_b32 v238, 0x3ffc, v238
    ds_add_rtn_u32 v236, v236, v250 offset:0
    ds_add_rtn_u32 v238, v238, v250 offset:0
    s_waitcnt lgkmcnt(3)
    v_lshl_or_b32 v131, v129, 16, v247
    v_and_or_b32 v129, v129, s55, v246
    v_readlane_b32 s74, v255, 36
    v_readlane_b32 s75, v255, 37
    s_bcnt1_i32_b64 s50, s[74:75]
    v_mbcnt_lo_u32_b32 v245, s74, 0
    v_mbcnt_hi_u32_b32 v245, s75, v245
    v_lshl_add_u32 v245, v245, 2, s70
    s_lshl2_add_u32 s70, s50, s70
    ds_read_b32 v245, v245 offset:13072
    s_movk_i32 s51, 768
    s_waitcnt lgkmcnt(3)
    v_add_u32 v244, v244, v251
    buffer_load_dwordx3 v[160:162], v244, s[24:27], s51 offen
    s_waitcnt vmcnt(4)
    v_lshrrev_b32 v246, 6, v136
    v_lshrrev_b32 v247, 6, v138
    v_and_b32 v246, 0x3ffc, v246
    v_and_b32 v247, 0x3ffc, v247
    v_cmpx_gt_i32 vcc, 0, v137
    ds_add_rtn_u32 v246, v246, v250 offset:0
    ds_add_rtn_u32 v247, v247, v250 offset:0
    s_mov_b64 exec, -1
    s_waitcnt lgkmcnt(3)
    v_lshl_or_b32 v135, v133, 16, v238
    v_and_or_b32 v133, v133, s55, v236
    v_readlane_b32 s74, v255, 38
    v_readlane_b32 s75, v255, 39
    s_bcnt1_i32_b64 s50, s[74:75]
    v_mbcnt_lo_u32_b32 v244, s74, 0
    v_mbcnt_hi_u32_b32 v244, s75, v244
    v_lshl_add_u32 v244, v244, 2, s70
    s_lshl2_add_u32 s70, s50, s70
    ds_read_b32 v244, v244 offset:13072
    s_movk_i32 s51, 1536
    s_waitcnt lgkmcnt(3)
    v_add_u32 v245, v245, v251
    buffer_load_dwordx3 v[164:166], v245, s[24:27], s51 offen
    s_waitcnt vmcnt(4)
    v_lshrrev_b32 v236, 6, v140
    v_lshrrev_b32 v238, 6, v142
    v_and_b32 v236, 0x3ffc, v236
    v_and_b32 v238, 0x3ffc, v238
    v_cmpx_gt_i32 vcc, 0, v141
    ds_add_rtn_u32 v236, v236, v250 offset:0
    ds_add_rtn_u32 v238, v238, v250 offset:0
    s_mov_b64 exec, -1
    s_waitcnt lgkmcnt(3)
    v_lshl_or_b32 v139, v137, 16, v247
    v_and_or_b32 v137, v137, s55, v246
    v_readlane_b32 s74, v255, 40
    v_readlane_b32 s75, v255, 41
    s_bcnt1_i32_b64 s50, s[74:75]
    v_mbcnt_lo_u32_b32 v245, s74, 0
    v_mbcnt_hi_u32_b32 v245, s75, v245
    v_lshl_add_u32 v245, v245, 2, s70
    s_lshl2_add_u32 s70, s50, s70
    ds_read_b32 v245, v245 offset:13072
    s_movk_i32 s51, 2304
    s_waitcnt lgkmcnt(3)
    v_add_u32 v244, v244, v251
    buffer_load_dwordx3 v[168:170], v244, s[24:27], s51 offen
    s_waitcnt vmcnt(4)
    v_lshrrev_b32 v246, 6, v144
    v_lshrrev_b32 v247, 6, v146
    v_and_b32 v246, 0x3ffc, v246
    v_and_b32 v247, 0x3ffc, v247
    v_cmpx_gt_i32 vcc, 0, v145
    ds_add_rtn_u32 v246, v246, v250 offset:0
    ds_add_rtn_u32 v247, v247, v250 offset:0
    s_mov_b64 exec, -1
    s_waitcnt lgkmcnt(3)
    v_lshl_or_b32 v143, v141, 16, v238
    v_and_or_b32 v141, v141, s55, v236
    s_waitcnt lgkmcnt(0)
    v_lshl_or_b32 v147, v145, 16, v247
    v_and_or_b32 v145, v145, s55, v246
    s_cmp_le_u32 s80, 832
    s_cbranch_scc1 Lg1
    s_waitcnt vmcnt(4)
    v_lshrrev_b32 v236, 6, v148
    v_lshrrev_b32 v238, 6, v150
    v_and_b32 v236, 0x3ffc, v236
    v_and_b32 v238, 0x3ffc, v238
    v_cmpx_gt_i32 vcc, 0, v149
    ds_add_rtn_u32 v236, v236, v250 offset:0
    ds_add_rtn_u32 v238, v238, v250 offset:0
    s_mov_b64 exec, -1
    s_waitcnt lgkmcnt(0)
    v_lshl_or_b32 v151, v149, 16, v238
    v_and_or_b32 v149, v149, s55, v236
    s_cmp_le_u32 s80, 896
    s_cbranch_scc1 Lg1
    s_waitcnt vmcnt(4)
    v_lshrrev_b32 v246, 6, v152
    v_lshrrev_b32 v247, 6, v154
    v_and_b32 v246, 0x3ffc, v246
    v_and_b32 v247, 0x3ffc, v247
    v_cmpx_gt_i32 vcc, 0, v153
    ds_add_rtn_u32 v246, v246, v250 offset:0
    ds_add_rtn_u32 v247, v247, v250 offset:0
    s_mov_b64 exec, -1
    s_waitcnt lgkmcnt(0)
    v_lshl_or_b32 v155, v153, 16, v247
    v_and_or_b32 v153, v153, s55, v246
Lg1:
    s_nop 3
    s_waitcnt lgkmcnt(0)
    s_barrier
    s_cmp_lg_u32 s48, 3
    s_cbranch_scc1 Lks0
    v_lshlrev_b32 v232, 6, v1
    ds_read_b128 v[216:219], v232 offset:0
    ds_read_b128 v[220:223], v232 offset:16
    ds_read_b128 v[224:227], v232 offset:32
    ds_read_b128 v[228:231], v232 offset:48
    s_waitcnt lgkmcnt(0)
    v_add_u32 v217, v217, v216
    v_add_u32 v218, v218, v217
    v_add_u32 v219, v219, v218
    v_add_u32 v220, v220, v219
    v_add_u32 v221, v221, v220
    v_add_u32 v222, v222, v221
    v_add_u32 v223, v223, v222
    v_add_u32 v224, v224, v223
    v_add_u32 v225, v225, v224
    v_add_u32 v226, v226, v225
    v_add_u32 v227, v227, v226
    v_add_u32 v228, v228, v227
    v_add_u32 v229, v229, v228
    v_add_u32 v230, v230, v229
    v_add_u32 v231, v231, v230
    v_mov_b32 v233, v231
    s_nop 1
    v_add_u32_dpp v233, v233, v233 row_shr:1 row_mask:0xf bank_mask:0xf
    s_nop 1
    v_add_u32_dpp v233, v233, v233 row_shr:2 row_mask:0xf bank_mask:0xf
    s_nop 1
    v_add_u32_dpp v233, v233, v233 row_shr:4 row_mask:0xf bank_mask:0xf
    s_nop 1
    v_add_u32_dpp v233, v233, v233 row_shr:8 row_mask:0xf bank_mask:0xf
    s_nop 1
    v_add_u32_dpp v233, v233, v233 row_bcast:15 row_mask:0xa bank_mask:0xf
    s_nop 1
    v_add_u32_dpp v233, v233, v233 row_bcast:31 row_mask:0xc bank_mask:0xf
    v_sub_u32 v233, v233, v231
    v_lshl_add_u32 v233, s64, 2, v233
    v_cmpx_gt_u32 vcc, 49, v1
    v_add_u32 v231, v230, v233
    v_add_u32 v230, v229, v233
    v_add_u32 v229, v228, v233
    v_add_u32 v228, v227, v233
    ds_write_b128 v232, v[228:231] offset:48
    v_add_u32 v227, v226, v233
    v_add_u32 v226, v225, v233
    v_add_u32 v225, v224, v233
    v_add_u32 v224, v223, v233
    ds_write_b128 v232, v[224:227] offset:32
    v_add_u32 v223, v222, v233
    v_add_u32 v222, v221, v233
    v_add_u32 v221, v220, v233
    v_add_u32 v220, v219, v233
    ds_write_b128 v232, v[220:223] offset:16
    v_add_u32 v219, v218, v233
    v_add_u32 v218, v217, v233
    v_add_u32 v217, v216, v233
    v_mov_b32 v216, v233
    ds_write_b128 v232, v[216:219] offset:0
    s_lshl_b32 s50, s65, 2
    v_mov_b32 v233, s50
    v_lshlrev_b32 v232, 2, v1
    s_mov_b64 exec, 0xffff
    ds_write_b32 v232, v233 offset:12544
    s_mov_b64 exec, -1
Lks0:
    s_nop 1
    v_readlane_b32 s74, v255, 42
    v_readlane_b32 s75, v255, 43
    s_bcnt1_i32_b64 s50, s[74:75]
    v_mbcnt_lo_u32_b32 v244, s74, 0
    v_mbcnt_hi_u32_b32 v244, s75, v244
    v_lshl_add_u32 v244, v244, 2, s70
    s_lshl2_add_u32 s70, s50, s70
    ds_read_b32 v244, v244 offset:13072
    s_movk_i32 s51, 3072
    s_waitcnt lgkmcnt(3)
    v_add_u32 v245, v245, v251
    buffer_load_dwordx3 v[172:174], v245, s[24:27], s51 offen
    v_readlane_b32 s74, v255, 44
    v_readlane_b32 s75, v255, 45
    s_bcnt1_i32_b64 s50, s[74:75]
    v_mbcnt_lo_u32_b32 v245, s74, 0
    v_mbcnt_hi_u32_b32 v245, s75, v245
    v_lshl_add_u32 v245, v245, 2, s70
    s_lshl2_add_u32 s70, s50, s70
    ds_read_b32 v245, v245 offset:13072
    s_movk_i32 s51, 3840
    s_waitcnt lgkmcnt(1)
    v_add_u32 v244, v244, v251
    buffer_load_dwordx3 v[176:178], v244, s[24:27], s51 offen
    s_waitcnt lgkmcnt(0)
    s_barrier
    v_lshrrev_b32 v240, 6, v96
    v_lshrrev_b32 v241, 6, v98
    v_and_b32 v240, 0x3ffc, v240
    v_and_b32 v241, 0x3ffc, v241
    ds_read_b32 v240, v240 offset:0
    ds_read_b32 v241, v241 offset:0
    v_readlane_b32 s74, v255, 46
    v_readlane_b32 s75, v255, 47
    s_bcnt1_i32_b64 s50, s[74:75]
    v_mbcnt_lo_u32_b32 v244, s74, 0
    v_mbcnt_hi_u32_b32 v244, s75, v244
    v_lshl_add_u32 v244, v244, 2, s70
    s_lshl2_add_u32 s70, s50, s70
    ds_read_b32 v244, v244 offset:13072
    v_lshrrev_b32 v242, 6, v100
    v_lshrrev_b32 v243, 6, v102
    v_and_b32 v242, 0x3ffc, v242
    v_and_b32 v243, 0x3ffc, v243
    ds_read_b32 v242, v242 offset:0
    ds_read_b32 v243, v243 offset:0
    s_waitcnt lgkmcnt(3)
    v_add_u32 v240, v240, v97
    v_add_u32 v241, v241, v99
    v_lshlrev_b32_sdwa v240, 1, v240 dst_sel:DWORD dst_unused:UNUSED_PAD src0_sel:DWORD src1_sel:WORD_0
    ds_write_b64 v240, v[96:97] offset:25856
    v_lshlrev_b32_sdwa v241, 1, v241 dst_sel:DWORD dst_unused:UNUSED_PAD src0_sel:DWORD src1_sel:WORD_0
    ds_write_b64 v241, v[98:99] offset:25856
    s_movk_i32 s51, 4608
    s_waitcnt lgkmcnt(7)
    v_add_u32 v245, v245, v251
    buffer_load_dwordx3 v[180:182], v245, s[24:27], s51 offen
    v_readlane_b32 s74, v255, 48
    v_readlane_b32 s75, v255, 49
    s_bcnt1_i32_b64 s50, s[74:75]
    v_mbcnt_lo_u32_b32 v245, s74, 0
    v_mbcnt_hi_u32_b32 v245, s75, v245
    v_lshl_add_u32 v245, v245, 2, s70
    s_lshl2_add_u32 s70, s50, s70
    ds_read_b32 v245, v245 offset:13072
    s_movk_i32 s51, 5376
    s_waitcnt lgkmcnt(5)
    v_add_u32 v244, v244, v251
    buffer_load_dwordx3 v[184:186], v244, s[24:27], s51 offen
    s_waitcnt vmcnt(7)
    v_lshrrev_b32 v236, 6, v156
    v_lshrrev_b32 v238, 6, v158
    v_and_b32 v236, 0x3ffc, v236
    v_and_b32 v238, 0x3ffc, v238
    ds_add_rtn_u32 v236, v236, v250 offset:0
    ds_add_rtn_u32 v238, v238, v250 offset:0
    s_waitcnt vmcnt(6)
    v_lshrrev_b32 v246, 6, v160
    v_lshrrev_b32 v247, 6, v162
    v_and_b32 v246, 0x3ffc, v246
    v_and_b32 v247, 0x3ffc, v247
    ds_add_rtn_u32 v246, v246, v250 offset:0
    ds_add_rtn_u32 v247, v247, v250 offset:0
    s_waitcnt lgkmcnt(2)
    v_lshl_or_b32 v159, v157, 16, v238
    v_and_or_b32 v157, v157, s55, v236
    v_readlane_b32 s74, v255, 50
    v_readlane_b32 s75, v255, 51
    s_bcnt1_i32_b64 s50, s[74:75]
    v_mbcnt_lo_u32_b32 v244, s74, 0
    v_mbcnt_hi_u32_b32 v244, s75, v244
    v_lshl_add_u32 v244, v244, 2, s70
    s_lshl2_add_u32 s70, s50, s70
    ds_read_b32 v244, v244 offset:13072
    v_lshrrev_b32 v240, 6, v104
    v_lshrrev_b32 v241, 6, v106
    v_and_b32 v240, 0x3ffc, v240
    v_and_b32 v241, 0x3ffc, v241
    ds_read_b32 v240, v240 offset:0
    ds_read_b32 v241, v241 offset:0
    s_waitcnt lgkmcnt(10)
    v_add_u32 v242, v242, v101
    v_add_u32 v243, v243, v103
    v_lshlrev_b32_sdwa v242, 1, v242 dst_sel:DWORD dst_unused:UNUSED_PAD src0_sel:DWORD src1_sel:WORD_0
    ds_write_b64 v242, v[100:101] offset:25856
    v_lshlrev_b32_sdwa v243, 1, v243 dst_sel:DWORD dst_unused:UNUSED_PAD src0_sel:DWORD src1_sel:WORD_0
    ds_write_b64 v243, v[102:103] offset:25856
    s_movk_i32 s51, 6144
    s_waitcnt lgkmcnt(9)
    v_add_u32 v245, v245, v251
    buffer_load_dwordx3 v[188:190], v245, s[24:27], s51 offen
    v_readlane_b32 s74, v255, 52
    v_readlane_b32 s75, v255, 53
    s_bcnt1_i32_b64 s50, s[74:75]
    v_mbcnt_lo_u32_b32 v245, s74, 0
    v_mbcnt_hi_u32_b32 v245, s75, v245
    v_lshl_add_u32 v245, v245, 2, s70
    s_lshl2_add_u32 s70, s50, s70
    ds_read_b32 v245, v245 offset:13072
    s_movk_i32 s51, 6912
    s_waitcnt lgkmcnt(5)
    v_add_u32 v244, v244, v251
    buffer_load_dwordx3 v[192:194], v244, s[24:27], s51 offen
    s_waitcnt vmcnt(7)
    v_lshrrev_b32 v236, 6, v164
    v_lshrrev_b32 v238, 6, v166
    v_and_b32 v236, 0x3ffc, v236
    v_and_b32 v238, 0x3ffc, v238
    ds_add_rtn_u32 v236, v236, v250 offset:0
    ds_add_rtn_u32 v238, v238, v250 offset:0
    s_waitcnt lgkmcnt(8)
    v_lshl_or_b32 v163, v161, 16, v247
    v_and_or_b32 v161, v161, s55, v246
    s_waitcnt vmcnt(6)
    v_lshrrev_b32 v246, 6, v168
    v_lshrrev_b32 v247, 6, v170
    v_and_b32 v246, 0x3ffc, v246
    v_and_b32 v247, 0x3ffc, v247
    ds_add_rtn_u32 v246, v246, v250 offset:0
    ds_add_rtn_u32 v247, v247, v250 offset:0
    s_waitcnt lgkmcnt(2)
    v_lshl_or_b32 v167, v165, 16, v238
    v_and_or_b32 v165, v165, s55, v236
    v_readlane_b32 s74, v255, 54
    v_readlane_b32 s75, v255, 55
    s_bcnt1_i32_b64 s50, s[74:75]
    v_mbcnt_lo_u32_b32 v244, s74, 0
    v_mbcnt_hi_u32_b32 v244, s75, v244
    v_lshl_add_u32 v244, v244, 2, s70
    s_lshl2_add_u32 s70, s50, s70
    ds_read_b32 v244, v244 offset:13072
    v_lshrrev_b32 v242, 6, v108
    v_lshrrev_b32 v243, 6, v110
    v_and_b32 v242, 0x3ffc, v242
    v_and_b32 v243, 0x3ffc, v243
    ds_read_b32 v242, v242 offset:0
    ds_read_b32 v243, v243 offset:0
    s_waitcnt lgkmcnt(10)
    v_add_u32 v240, v240, v105
    v_add_u32 v241, v241, v107
    v_lshlrev_b32_sdwa v240, 1, v240 dst_sel:DWORD dst_unused:UNUSED_PAD src0_sel:DWORD src1_sel:WORD_0
    ds_write_b64 v240, v[104:105] offset:25856
    v_lshlrev_b32_sdwa v241, 1, v241 dst_sel:DWORD dst_unused:UNUSED_PAD src0_sel:DWORD src1_sel:WORD_0
    ds_write_b64 v241, v[106:107] offset:25856
    s_movk_i32 s51, 7680
    s_waitcnt lgkmcnt(9)
    v_add_u32 v245, v245, v251
    buffer_load_dwordx3 v[196:198], v245, s[24:27], s51 offen
    v_readlane_b32 s74, v255, 56
    v_readlane_b32 s75, v255, 57
    s_bcnt1_i32_b64 s50, s[74:75]
    v_mbcnt_lo_u32_b32 v245, s74, 0
    v_mbcnt_hi_u32_b32 v245, s75, v245
    v_lshl_add_u32 v245, v245, 2, s70
    s_lshl2_add_u32 s70, s50, s70
    ds_read_b32 v245, v245 offset:13072
    s_movk_i32 s51, 8448
    s_waitcnt lgkmcnt(5)
    v_add_u32 v244, v244, v251
    buffer_load_dwordx3 v[200:202], v244, s[24:27], s51 offen
    s_waitcnt vmcnt(7)
    v_lshrrev_b32 v236, 6, v172
    v_lshrrev_b32 v238, 6, v174
    v_and_b32 v236, 0x3ffc, v236
    v_and_b32 v238, 0x3ffc, v238
    ds_add_rtn_u32 v236, v236, v250 offset:0
    ds_add_rtn_u32 v238, v238, v250 offset:0
    s_waitcnt lgkmcnt(8)
    v_lshl_or_b32 v171, v169, 16, v247
    v_and_or_b32 v169, v169, s55, v246
    s_waitcnt vmcnt(6)
    v_lshrrev_b32 v246, 6, v176
    v_lshrrev_b32 v247, 6, v178
    v_and_b32 v246, 0x3ffc, v246
    v_and_b32 v247, 0x3ffc, v247
    ds_add_rtn_u32 v246, v246, v250 offset:0
    ds_add_rtn_u32 v247, v247, v250 offset:0
    s_waitcnt lgkmcnt(2)
    v_lshl_or_b32 v175, v173, 16, v238
    v_and_or_b32 v173, v173, s55, v236
    v_lshrrev_b32 v240, 6, v112
    v_lshrrev_b32 v241, 6, v114
    v_and_b32 v240, 0x3ffc, v240
    v_and_b32 v241, 0x3ffc, v241
    ds_read_b32 v240, v240 offset:0
    ds_read_b32 v241, v241 offset:0
    s_waitcnt lgkmcnt(9)
    v_add_u32 v242, v242, v109
    v_add_u32 v243, v243, v111
    v_lshlrev_b32_sdwa v242, 1, v242 dst_sel:DWORD dst_unused:UNUSED_PAD src0_sel:DWORD src1_sel:WORD_0
    ds_write_b64 v242, v[108:109] offset:25856
    v_lshlrev_b32_sdwa v243, 1, v243 dst_sel:DWORD dst_unused:UNUSED_PAD src0_sel:DWORD src1_sel:WORD_0
    ds_write_b64 v243, v[110:111] offset:25856
    s_movk_i32 s51, 9216
    s_waitcnt lgkmcnt(8)
    v_add_u32 v245, v245, v251
    buffer_load_dwordx3 v[204:206], v245, s[24:27], s51 offen
    s_cmp_le_u32 s81, 832
    s_cbranch_scc1 Lg2
    v_readlane_b32 s74, v255, 58
    v_readlane_b32 s75, v255, 59
    s_bcnt1_i32_b64 s50, s[74:75]
    v_mbcnt_lo_u32_b32 v244, s74, 0
    v_mbcnt_hi_u32_b32 v244, s75, v244
    v_lshl_add_u32 v244, v244, 2, s70
    s_lshl2_add_u32 s70, s50, s70
    ds_read_b32 v244, v244 offset:13072
    s_movk_i32 s51, 9984
    s_waitcnt lgkmcnt(0)
    v_add_u32 v244, v244, v251
    buffer_load_dwordx3 v[208:210], v244, s[24:27], s51 offen
    s_cmp_le_u32 s81, 896
    s_cbranch_scc1 Lg2
    v_readlane_b32 s74, v255, 60
    v_readlane_b32 s75, v255, 61
    s_bcnt1_i32_b64 s50, s[74:75]
    v_mbcnt_lo_u32_b32 v245, s74, 0
    v_mbcnt_hi_u32_b32 v245, s75, v245
    v_lshl_add_u32 v245, v245, 2, s70
    s_lshl2_add_u32 s70, s50, s70
    ds_read_b32 v245, v245 offset:13072
    s_movk_i32 s51, 10752
    s_waitcnt lgkmcnt(0)
    v_add_u32 v245, v245, v251
    buffer_load_dwordx3 v[212:214], v245, s[24:27], s51 offen
Lg2:
    s_nop 3
    s_mul_i32 s70, s48, 1088
    v_readlane_b32 s74, v248, 0
    v_readlane_b32 s75, v248, 1
    s_bcnt1_i32_b64 s50, s[74:75]
    v_mbcnt_lo_u32_b32 v244, s74, 0
    v_mbcnt_hi_u32_b32 v244, s75, v244
    v_lshl_add_u32 v244, v244, 2, s70
    s_lshl2_add_u32 s70, s50, s70
    ds_read_b32 v244, v244 offset:13344
    s_waitcnt vmcnt(6)
    v_lshrrev_b32 v236, 6, v180
    v_lshrrev_b32 v238, 6, v182
    v_and_b32 v236, 0x3ffc, v236
    v_and_b32 v238, 0x3ffc, v238
    ds_add_rtn_u32 v236, v236, v250 offset:0
    ds_add_rtn_u32 v238, v238, v250 offset:0
    s_waitcnt lgkmcnt(7)
    v_lshl_or_b32 v179, v177, 16, v247
    v_and_or_b32 v177, v177, s55, v246
    s_waitcnt vmcnt(5)
    v_lshrrev_b32 v246, 6, v184
    v_lshrrev_b32 v247, 6, v186
    v_and_b32 v246, 0x3ffc, v246
    v_and_b32 v247, 0x3ffc, v247
    ds_add_rtn_u32 v246, v246, v250 offset:0
    ds_add_rtn_u32 v247, v247, v250 offset:0
    s_waitcnt lgkmcnt(2)
    v_lshl_or_b32 v183, v181, 16, v238
    v_and_or_b32 v181, v181, s55, v236
    v_readlane_b32 s74, v248, 2
    v_readlane_b32 s75, v248, 3
    s_bcnt1_i32_b64 s50, s[74:75]
    v_mbcnt_lo_u32_b32 v245, s74, 0
    v_mbcnt_hi_u32_b32 v245, s75, v245
    v_lshl_add_u32 v245, v245, 2, s70
    s_lshl2_add_u32 s70, s50, s70
    ds_read_b32 v245, v245 offset:13344
    v_lshrrev_b32 v242, 6, v116
    v_lshrrev_b32 v243, 6, v118
    v_and_b32 v242, 0x3ffc, v242
    v_and_b32 v243, 0x3ffc, v243
    ds_read_b32 v242, v242 offset:0
    ds_read_b32 v243, v243 offset:0
    s_waitcnt lgkmcnt(10)
    v_add_u32 v240, v240, v113
    v_add_u32 v241, v241, v115
    v_lshlrev_b32_sdwa v240, 1, v240 dst_sel:DWORD dst_unused:UNUSED_PAD src0_sel:DWORD src1_sel:WORD_0
    ds_write_b64 v240, v[112:113] offset:25856
    v_lshlrev_b32_sdwa v241, 1, v241 dst_sel:DWORD dst_unused:UNUSED_PAD src0_sel:DWORD src1_sel:WORD_0
    ds_write_b64 v241, v[114:115] offset:25856
    s_movk_i32 s51, 0
    s_waitcnt lgkmcnt(9)
    v_add_u32 v244, v244, v251
    buffer_load_dwordx3 v[96:98], v244, s[24:27], s51 offen
    s_waitcnt vmcnt(5)
    v_lshrrev_b32 v236, 6, v188
    v_lshrrev_b32 v238, 6, v190
    v_and_b32 v236, 0x3ffc, v236
    v_and_b32 v238, 0x3ffc, v238
    ds_add_rtn_u32 v236, v236, v250 offset:0
    ds_add_rtn_u32 v238, v238, v250 offset:0
    s_waitcnt lgkmcnt(7)
    v_lshl_or_b32 v187, v185, 16, v247
    v_and_or_b32 v185, v185, s55, v246
    v_readlane_b32 s74, v248, 4
    v_readlane_b32 s75, v248, 5
    s_bcnt1_i32_b64 s50, s[74:75]
    v_mbcnt_lo_u32_b32 v244, s74, 0
    v_mbcnt_hi_u32_b32 v244, s75, v244
    v_lshl_add_u32 v244, v244, 2, s70
    s_lshl2_add_u32 s70, s50, s70
    ds_read_b32 v244, v244 offset:13344
    v_lshrrev_b32 v240, 6, v120
    v_lshrrev_b32 v241, 6, v122
    v_and_b32 v240, 0x3ffc, v240
    v_and_b32 v241, 0x3ffc, v241
    ds_read_b32 v240, v240 offset:0
    ds_read_b32 v241, v241 offset:0
    s_waitcnt lgkmcnt(7)
    v_add_u32 v242, v242, v117
    v_add_u32 v243, v243, v119
    v_lshlrev_b32_sdwa v242, 1, v242 dst_sel:DWORD dst_unused:UNUSED_PAD src0_sel:DWORD src1_sel:WORD_0
    ds_write_b64 v242, v[116:117] offset:25856
    v_lshlrev_b32_sdwa v243, 1, v243 dst_sel:DWORD dst_unused:UNUSED_PAD src0_sel:DWORD src1_sel:WORD_0
    ds_write_b64 v243, v[118:119] offset:25856
    s_movk_i32 s51, 768
    s_waitcnt lgkmcnt(11)
    v_add_u32 v245, v245, v251
    buffer_load_dwordx3 v[100:102], v245, s[24:27], s51 offen
    s_waitcnt vmcnt(5)
    v_lshrrev_b32 v246, 6, v192
    v_lshrrev_b32 v247, 6, v194
    v_and_b32 v246, 0x3ffc, v246
    v_and_b32 v247, 0x3ffc, v247
    ds_add_rtn_u32 v246, v246, v250 offset:0
    ds_add_rtn_u32 v247, v247, v250 offset:0
    s_waitcnt lgkmcnt(7)
    v_lshl_or_b32 v191, v189, 16, v238
    v_and_or_b32 v189, v189, s55, v236
    v_readlane_b32 s74, v248, 6
    v_readlane_b32 s75, v248, 7
    s_bcnt1_i32_b64 s50, s[74:75]
    v_mbcnt_lo_u32_b32 v245, s74, 0
    v_mbcnt_hi_u32_b32 v245, s75, v245
    v_lshl_add_u32 v245, v245, 2, s70
    s_lshl2_add_u32 s70, s50, s70
    ds_read_b32 v245, v245 offset:13344
    v_lshrrev_b32 v242, 6, v124
    v_lshrrev_b32 v243, 6, v126
    v_and_b32 v242, 0x3ffc, v242
    v_and_b32 v243, 0x3ffc, v243
    ds_read_b32 v242, v242 offset:0
    ds_read_b32 v243, v243 offset:0
    s_waitcnt lgkmcnt(7)
    v_add_u32 v240, v240, v121
    v_add_u32 v241, v241, v123
    v_lshlrev_b32_sdwa v240, 1, v240 dst_sel:DWORD dst_unused:UNUSED_PAD src0_sel:DWORD src1_sel:WORD_0
    ds_write_b64 v240, v[120:121] offset:25856
    v_lshlrev_b32_sdwa v241, 1, v241 dst_sel:DWORD dst_unused:UNUSED_PAD src0_sel:DWORD src1_sel:WORD_0
    ds_write_b64 v241, v[122:123] offset:25856
    s_movk_i32 s51, 1536
    s_waitcnt lgkmcnt(11)
    v_add_u32 v244, v244, v251
    buffer_load_dwordx3 v[104:106], v244, s[24:27], s51 offen
    s_waitcnt vmcnt(5)
    v_lshrrev_b32 v236, 6, v196
    v_lshrrev_b32 v238, 6, v198
    v_and_b32 v236, 0x3ffc, v236
    v_and_b32 v238, 0x3ffc, v238
    v_cmpx_gt_i32 vcc, 0, v197
    ds_add_rtn_u32 v236, v236, v250 offset:0
    ds_add_rtn_u32 v238, v238, v250 offset:0
    s_mov_b64 exec, -1
    s_waitcnt lgkmcnt(7)
    v_lshl_or_b32 v195, v193, 16, v247
    v_and_or_b32 v193, v193, s55, v246
    v_readlane_b32 s74, v248, 8
    v_readlane_b32 s75, v248, 9
    s_bcnt1_i32_b64 s50, s[74:75]
    v_mbcnt_lo_u32_b32 v244, s74, 0
    v_mbcnt_hi_u32_b32 v244, s75, v244
    v_lshl_add_u32 v244, v244, 2, s70
    s_lshl2_add_u32 s70, s50, s70
    ds_read_b32 v244, v244 offset:13344
    v_lshrrev_b32 v240, 6, v128
    v_lshrrev_b32 v241, 6, v130
    v_and_b32 v240, 0x3ffc, v240
    v_and_b32 v241, 0x3ffc, v241
    ds_read_b32 v240, v240 offset:0
    ds_read_b32 v241, v241 offset:0
    s_waitcnt lgkmcnt(7)
    v_add_u32 v242, v242, v125
    v_add_u32 v243, v243, v127
    v_lshlrev_b32_sdwa v242, 1, v242 dst_sel:DWORD dst_unused:UNUSED_PAD src0_sel:DWORD src1_sel:WORD_0
    ds_write_b64 v242, v[124:125] offset:25856
    v_lshlrev_b32_sdwa v243, 1, v243 dst_sel:DWORD dst_unused:UNUSED_PAD src0_sel:DWORD src1_sel:WORD_0
    ds_write_b64 v243, v[126:127] offset:25856
    s_movk_i32 s51, 2304
    s_waitcnt lgkmcnt(11)
    v_add_u32 v245, v245, v251
    buffer_load_dwordx3 v[108:110], v245, s[24:27], s51 offen
    s_waitcnt vmcnt(5)
    v_lshrrev_b32 v246, 6, v200
    v_lshrrev_b32 v247, 6, v202
    v_and_b32 v246, 0x3ffc, v246
    v_and_b32 v247, 0x3ffc, v247
    v_cmpx_gt_i32 vcc, 0, v201
    ds_add_rtn_u32 v246, v246, v250 offset:0
    ds_add_rtn_u32 v247, v247, v250 offset:0
    s_mov_b64 exec, -1
    s_waitcnt lgkmcnt(7)
    v_lshl_or_b32 v199, v197, 16, v238
    v_and_or_b32 v197, v197, s55, v236
    v_readlane_b32 s74, v248, 10
    v_readlane_b32 s75, v248, 11
    s_bcnt1_i32_b64 s50, s[74:75]
    v_mbcnt_lo_u32_b32 v245, s74, 0
    v_mbcnt_hi_u32_b32 v245, s75, v245
    v_lshl_add_u32 v245, v245, 2, s70
    s_lshl2_add_u32 s70, s50, s70
    ds_read_b32 v245, v245 offset:13344
    v_lshrrev_b32 v242, 6, v132
    v_lshrrev_b32 v243, 6, v134
    v_and_b32 v242, 0x3ffc, v242
    v_and_b32 v243, 0x3ffc, v243
    ds_read_b32 v242, v242 offset:0
    ds_read_b32 v243, v243 offset:0
    s_waitcnt lgkmcnt(7)
    v_add_u32 v240, v240, v129
    v_add_u32 v241, v241, v131
    v_lshlrev_b32_sdwa v240, 1, v240 dst_sel:DWORD dst_unused:UNUSED_PAD src0_sel:DWORD src1_sel:WORD_0
    ds_write_b64 v240, v[128:129] offset:25856
    v_lshlrev_b32_sdwa v241, 1, v241 dst_sel:DWORD dst_unused:UNUSED_PAD src0_sel:DWORD src1_sel:WORD_0
    ds_write_b64 v241, v[130:131] offset:25856
    s_movk_i32 s51, 3072
    s_waitcnt lgkmcnt(11)
    v_add_u32 v244, v244, v251
    buffer_load_dwordx3 v[112:114], v244, s[24:27], s51 offen
    s_waitcnt vmcnt(5)
    v_lshrrev_b32 v236, 6, v204
    v_lshrrev_b32 v238, 6, v206
    v_and_b32 v236, 0x3ffc, v236
    v_and_b32 v238, 0x3ffc, v238
    v_cmpx_gt_i32 vcc, 0, v205
    ds_add_rtn_u32 v236, v236, v250 offset:0
    ds_add_rtn_u32 v238, v238, v250 offset:0
    s_mov_b64 exec, -1
    s_waitcnt lgkmcnt(7)
    v_lshl_or_b32 v203, v201, 16, v247
    v_and_or_b32 v201, v201, s55, v246
    s_waitcnt lgkmcnt(0)
    v_lshl_or_b32 v207, v205, 16, v238
    v_and_or_b32 v205, v205, s55, v236
    s_cmp_le_u32 s81, 832
    s_cbranch_scc1 Lg3
    s_waitcnt vmcnt(5)
    v_lshrrev_b32 v246, 6, v208
    v_lshrrev_b32 v247, 6, v210
    v_and_b32 v246, 0x3ffc, v246
    v_and_b32 v247, 0x3ffc, v247
    v_cmpx_gt_i32 vcc, 0, v209
    ds_add_rtn_u32 v246, v246, v250 offset:0
    ds_add_rtn_u32 v247, v247, v250 offset:0
    s_mov_b64 exec, -1
    s_waitcnt lgkmcnt(0)
    v_lshl_or_b32 v211, v209, 16, v247
    v_and_or_b32 v209, v209, s55, v246
    s_cmp_le_u32 s81, 896
    s_cbranch_scc1 Lg3
    s_waitcnt vmcnt(5)
    v_lshrrev_b32 v236, 6, v212
    v_lshrrev_b32 v238, 6, v214
    v_and_b32 v236, 0x3ffc, v236
    v_and_b32 v238, 0x3ffc, v238
    v_cmpx_gt_i32 vcc, 0, v213
    ds_add_rtn_u32 v236, v236, v250 offset:0
    ds_add_rtn_u32 v238, v238, v250 offset:0
    s_mov_b64 exec, -1
    s_waitcnt lgkmcnt(0)
    v_lshl_or_b32 v215, v213, 16, v238
    v_and_or_b32 v213, v213, s55, v236
Lg3:
    s_nop 3
    v_readlane_b32 s74, v248, 12
    v_readlane_b32 s75, v248, 13
    s_bcnt1_i32_b64 s50, s[74:75]
    v_mbcnt_lo_u32_b32 v244, s74, 0
    v_mbcnt_hi_u32_b32 v244, s75, v244
    v_lshl_add_u32 v244, v244, 2, s70
    s_lshl2_add_u32 s70, s50, s70
    ds_read_b32 v244, v244 offset:13344
    v_lshrrev_b32 v240, 6, v136
    v_lshrrev_b32 v241, 6, v138
    v_and_b32 v240, 0x3ffc, v240
    v_and_b32 v241, 0x3ffc, v241
    ds_read_b32 v240, v240 offset:0
    ds_read_b32 v241, v241 offset:0
    s_waitcnt lgkmcnt(7)
    v_add_u32 v242, v242, v133
    v_add_u32 v243, v243, v135
    v_lshlrev_b32_sdwa v242, 1, v242 dst_sel:DWORD dst_unused:UNUSED_PAD src0_sel:DWORD src1_sel:WORD_0
    ds_write_b64 v242, v[132:133] offset:25856
    v_lshlrev_b32_sdwa v243, 1, v243 dst_sel:DWORD dst_unused:UNUSED_PAD src0_sel:DWORD src1_sel:WORD_0
    ds_write_b64 v243, v[134:135] offset:25856
    s_movk_i32 s51, 3840
    s_waitcnt lgkmcnt(11)
    v_add_u32 v245, v245, v251
    buffer_load_dwordx3 v[116:118], v245, s[24:27], s51 offen
    s_waitcnt lgkmcnt(5)
    s_barrier
    s_cmp_lg_u32 s48, 3
    s_cbranch_scc1 Lks1
    v_lshlrev_b32 v232, 6, v1
    ds_read_b128 v[216:219], v232 offset:3136
    ds_read_b128 v[220:223], v232 offset:3152
    ds_read_b128 v[224:227], v232 offset:3168
    ds_read_b128 v[228:231], v232 offset:3184
    s_waitcnt lgkmcnt(0)
    v_add_u32 v217, v217, v216
    v_add_u32 v218, v218, v217
    v_add_u32 v219, v219, v218
    v_add_u32 v220, v220, v219
    v_add_u32 v221, v221, v220
    v_add_u32 v222, v222, v221
    v_add_u32 v223, v223, v222
    v_add_u32 v224, v224, v223
    v_add_u32 v225, v225, v224
    v_add_u32 v226, v226, v225
    v_add_u32 v227, v227, v226
    v_add_u32 v228, v228, v227
    v_add_u32 v229, v229, v228
    v_add_u32 v230, v230, v229
    v_add_u32 v231, v231, v230
    v_mov_b32 v233, v231
    s_nop 1
    v_add_u32_dpp v233, v233, v233 row_shr:1 row_mask:0xf bank_mask:0xf
    s_nop 1
    v_add_u32_dpp v233, v233, v233 row_shr:2 row_mask:0xf bank_mask:0xf
    s_nop 1
    v_add_u32_dpp v233, v233, v233 row_shr:4 row_mask:0xf bank_mask:0xf
    s_nop 1
    v_add_u32_dpp v233, v233, v233 row_shr:8 row_mask:0xf bank_mask:0xf
    s_nop 1
    v_add_u32_dpp v233, v233, v233 row_bcast:15 row_mask:0xa bank_mask:0xf
    s_nop 1
    v_add_u32_dpp v233, v233, v233 row_bcast:31 row_mask:0xc bank_mask:0xf
    v_sub_u32 v233, v233, v231
    v_lshl_add_u32 v233, s65, 2, v233
    v_cmpx_gt_u32 vcc, 49, v1
    v_add_u32 v231, v230, v233
    v_add_u32 v230, v229, v233
    v_add_u32 v229, v228, v233
    v_add_u32 v228, v227, v233
    ds_write_b128 v232, v[228:231] offset:3184
    v_add_u32 v227, v226, v233
    v_add_u32 v226, v225, v233
    v_add_u32 v225, v224, v233
    v_add_u32 v224, v223, v233
    ds_write_b128 v232, v[224:227] offset:3168
    v_add_u32 v223, v222, v233
    v_add_u32 v222, v221, v233
    v_add_u32 v221, v220, v233
    v_add_u32 v220, v219, v233
    ds_write_b128 v232, v[220:223] offset:3152
    v_add_u32 v219, v218, v233
    v_add_u32 v218, v217, v233
    v_add_u32 v217, v216, v233
    v_mov_b32 v216, v233
    ds_write_b128 v232, v[216:219] offset:3136
    s_lshl_b32 s50, s66, 2
    v_mov_b32 v233, s50
    v_lshlrev_b32 v232, 2, v1
    s_mov_b64 exec, 0xffff
    ds_write_b32 v232, v233 offset:12608
    s_mov_b64 exec, -1
Lks1:
    s_nop 1
    v_readlane_b32 s74, v248, 14
    v_readlane_b32 s75, v248, 15
    s_bcnt1_i32_b64 s50, s[74:75]
    v_mbcnt_lo_u32_b32 v245, s74, 0
    v_mbcnt_hi_u32_b32 v245, s75, v245
    v_lshl_add_u32 v245, v245, 2, s70
    s_lshl2_add_u32 s70, s50, s70
    ds_read_b32 v245, v245 offset:13344
    v_lshrrev_b32 v242, 6, v140
    v_lshrrev_b32 v243, 6, v142
    v_and_b32 v242, 0x3ffc, v242
    v_and_b32 v243, 0x3ffc, v243
    ds_read_b32 v242, v242 offset:0
    ds_read_b32 v243, v243 offset:0
    v_cmpx_gt_i32 vcc, 0, v137
    s_waitcnt lgkmcnt(5)
    v_add_u32 v240, v240, v137
    v_add_u32 v241, v241, v139
    v_lshlrev_b32_sdwa v240, 1, v240 dst_sel:DWORD dst_unused:UNUSED_PAD src0_sel:DWORD src1_sel:WORD_0
    ds_write_b64 v240, v[136:137] offset:25856
    v_lshlrev_b32_sdwa v241, 1, v241 dst_sel:DWORD dst_unused:UNUSED_PAD src0_sel:DWORD src1_sel:WORD_0
    ds_write_b64 v241, v[138:139] offset:25856
    s_mov_b64 exec, -1
    s_movk_i32 s51, 4608
    s_waitcnt lgkmcnt(9)
    v_add_u32 v244, v244, v251
    buffer_load_dwordx3 v[120:122], v244, s[24:27], s51 offen
    v_readlane_b32 s74, v248, 16
    v_readlane_b32 s75, v248, 17
    s_bcnt1_i32_b64 s50, s[74:75]
    v_mbcnt_lo_u32_b32 v244, s74, 0
    v_mbcnt_hi_u32_b32 v244, s75, v244
    v_lshl_add_u32 v244, v244, 2, s70
    s_lshl2_add_u32 s70, s50, s70
    ds_read_b32 v244, v244 offset:13344
    v_lshrrev_b32 v240, 6, v144
    v_lshrrev_b32 v241, 6, v146
    v_and_b32 v240, 0x3ffc, v240
    v_and_b32 v241, 0x3ffc, v241
    ds_read_b32 v240, v240 offset:0
    ds_read_b32 v241, v241 offset:0
    v_cmpx_gt_i32 vcc, 0, v141
    s_waitcnt lgkmcnt(5)
    v_add_u32 v242, v242, v141
    v_add_u32 v243, v243, v143
    v_lshlrev_b32_sdwa v242, 1, v242 dst_sel:DWORD dst_unused:UNUSED_PAD src0_sel:DWORD src1_sel:WORD_0
    ds_write_b64 v242, v[140:141] offset:25856
    v_lshlrev_b32_sdwa v243, 1, v243 dst_sel:DWORD dst_unused:UNUSED_PAD src0_sel:DWORD src1_sel:WORD_0
    ds_write_b64 v243, v[142:143] offset:25856
    s_mov_b64 exec, -1
    s_movk_i32 s51, 5376
    s_waitcnt lgkmcnt(9)
    v_add_u32 v245, v245, v251
    buffer_load_dwordx3 v[124:126], v245, s[24:27], s51 offen
    v_readlane_b32 s74, v248, 18
    v_readlane_b32 s75, v248, 19
    s_bcnt1_i32_b64 s50, s[74:75]
    v_mbcnt_lo_u32_b32 v245, s74, 0
    v_mbcnt_hi_u32_b32 v245, s75, v245
    v_lshl_add_u32 v245, v245, 2, s70
    s_lshl2_add_u32 s70, s50, s70
    ds_read_b32 v245, v245 offset:13344
    v_cmpx_gt_i32 vcc, 0, v145
    s_waitcnt lgkmcnt(3)
    v_add_u32 v240, v240, v145
    v_add_u32 v241, v241, v147
    v_lshlrev_b32_sdwa v240, 1, v240 dst_sel:DWORD dst_unused:UNUSED_PAD src0_sel:DWORD src1_sel:WORD_0
    ds_write_b64 v240, v[144:145] offset:25856
    v_lshlrev_b32_sdwa v241, 1, v241 dst_sel:DWORD dst_unused:UNUSED_PAD src0_sel:DWORD src1_sel:WORD_0
    ds_write_b64 v241, v[146:147] offset:25856
    s_mov_b64 exec, -1
    s_movk_i32 s51, 6144
    s_waitcnt lgkmcnt(7)
    v_add_u32 v244, v244, v251
    buffer_load_dwordx3 v[128:130], v244, s[24:27], s51 offen
    s_cmp_le_u32 s80, 832
    s_cbranch_scc1 Lg4
    v_lshrrev_b32 v242, 6, v148
    v_lshrrev_b32 v243, 6, v150
    v_and_b32 v242, 0x3ffc, v242
    v_and_b32 v243, 0x3ffc, v243
    ds_read_b32 v242, v242 offset:0
    ds_read_b32 v243, v243 offset:0
    v_cmpx_gt_i32 vcc, 0, v149
    s_waitcnt lgkmcnt(0)
    v_add_u32 v242, v242, v149
    v_add_u32 v243, v243, v151
    v_lshlrev_b32_sdwa v242, 1, v242 dst_sel:DWORD dst_unused:UNUSED_PAD src0_sel:DWORD src1_sel:WORD_0
    ds_write_b64 v242, v[148:149] offset:25856
    v_lshlrev_b32_sdwa v243, 1, v243 dst_sel:DWORD dst_unused:UNUSED_PAD src0_sel:DWORD src1_sel:WORD_0
    ds_write_b64 v243, v[150:151] offset:25856
    s_mov_b64 exec, -1
    s_cmp_le_u32 s80, 896
    s_cbranch_scc1 Lg4
    v_lshrrev_b32 v240, 6, v152
    v_lshrrev_b32 v241, 6, v154
    v_and_b32 v240, 0x3ffc, v240
    v_and_b32 v241, 0x3ffc, v241
    ds_read_b32 v240, v240 offset:0
    ds_read_b32 v241, v241 offset:0
    v_cmpx_gt_i32 vcc, 0, v153
    s_waitcnt lgkmcnt(0)
    v_add_u32 v240, v240, v153
    v_add_u32 v241, v241, v155
    v_lshlrev_b32_sdwa v240, 1, v240 dst_sel:DWORD dst_unused:UNUSED_PAD src0_sel:DWORD src1_sel:WORD_0
    ds_write_b64 v240, v[152:153] offset:25856
    v_lshlrev_b32_sdwa v241, 1, v241 dst_sel:DWORD dst_unused:UNUSED_PAD src0_sel:DWORD src1_sel:WORD_0
    ds_write_b64 v241, v[154:155] offset:25856
    s_mov_b64 exec, -1
Lg4:
    s_nop 3
    s_waitcnt lgkmcnt(0)
    s_barrier
    s_lshr_b32 s72, s65, 10
    s_add_u32 s50, s71, 0
    s_and_b32 s50, s50, 15
    s_lshl_b32 s50, s50, 13
    v_add_u32 v232, s50, v252
    ds_read_b64 v[216:217], v232 offset:25856
    ds_read_b64 v[218:219], v232 offset:29952
    s_add_u32 s50, s71, 1
    s_and_b32 s50, s50, 15
    s_lshl_b32 s50, s50, 13
    v_add_u32 v233, s50, v252
    ds_read_b64 v[220:221], v233 offset:25856
    ds_read_b64 v[222:223], v233 offset:29952
    s_add_u32 s50, s71, 2
    s_and_b32 s50, s50, 15
    s_lshl_b32 s50, s50, 13
    v_add_u32 v234, s50, v252
    ds_read_b64 v[224:225], v234 offset:25856
    ds_read_b64 v[226:227], v234 offset:29952
    s_add_u32 s50, s71, 3
    s_and_b32 s50, s50, 15
    s_lshl_b32 s50, s50, 13
    v_add_u32 v235, s50, v252
    ds_read_b64 v[228:229], v235 offset:25856
    ds_read_b64 v[230:231], v235 offset:29952
    s_waitcnt vmcnt(8)
    v_lshrrev_b32 v246, 6, v96
    v_lshrrev_b32 v247, 6, v98
    v_and_b32 v246, 0x3ffc, v246
    v_and_b32 v247, 0x3ffc, v247
    ds_add_rtn_u32 v246, v246, v250 offset:0
    ds_add_rtn_u32 v247, v247, v250 offset:0
    s_mul_i32 s59, s71, 3
    s_set_gpr_idx_on s59, gpr_idx(DST)
    s_waitcnt lgkmcnt(8)
    v_mov_b32 v2, v216
    v_mov_b32 v3, v218
    v_perm_b32 v4, v219, v217, s73
    s_waitcnt lgkmcnt(6)
    v_mov_b32 v5, v220
    v_mov_b32 v6, v222
    v_perm_b32 v7, v223, v221, s73
    s_waitcnt lgkmcnt(4)
    v_mov_b32 v8, v224
    v_mov_b32 v9, v226
    v_perm_b32 v10, v227, v225, s73
    s_waitcnt lgkmcnt(2)
    v_mov_b32 v11, v228
    v_mov_b32 v12, v230
    v_perm_b32 v13, v231, v229, s73
    s_set_gpr_idx_off
    s_add_u32 s71, s71, 4
    s_add_u32 s50, s71, 0
    s_and_b32 s50, s50, 15
    s_lshl_b32 s50, s50, 13
    v_add_u32 v232, s50, v252
    ds_read_b64 v[216:217], v232 offset:25856
    ds_read_b64 v[218:219], v232 offset:29952
    s_add_u32 s50, s71, 1
    s_and_b32 s50, s50, 15
    s_lshl_b32 s50, s50, 13
    v_add_u32 v233, s50, v252
    ds_read_b64 v[220:221], v233 offset:25856
    ds_read_b64 v[222:223], v233 offset:29952
    s_add_u32 s50, s71, 2
    s_and_b32 s50, s50, 15
    s_lshl_b32 s50, s50, 13
    v_add_u32 v234, s50, v252
    ds_read_b64 v[224:225], v234 offset:25856
    ds_read_b64 v[226:227], v234 offset:29952
    s_add_u32 s50, s71, 3
    s_and_b32 s50, s50, 15
    s_lshl_b32 s50, s50, 13
    v_add_u32 v235, s50, v252
    ds_read_b64 v[228:229], v235 offset:25856
    ds_read_b64 v[230:231], v235 offset:29952
    s_waitcnt vmcnt(7)
    v_lshrrev_b32 v236, 6, v100
    v_lshrrev_b32 v238, 6, v102
    v_and_b32 v236, 0x3ffc, v236
    v_and_b32 v238, 0x3ffc, v238
    ds_add_rtn_u32 v236, v236, v250 offset:0
    ds_add_rtn_u32 v238, v238, v250 offset:0
    s_waitcnt lgkmcnt(10)
    v_lshl_or_b32 v99, v97, 16, v247
    v_and_or_b32 v97, v97, s55, v246
    s_mul_i32 s59, s71, 3
    s_set_gpr_idx_on s59, gpr_idx(DST)
    s_waitcnt lgkmcnt(8)
    v_mov_b32 v2, v216
    v_mov_b32 v3, v218
    v_perm_b32 v4, v219, v217, s73
    s_waitcnt lgkmcnt(6)
    v_mov_b32 v5, v220
    v_mov_b32 v6, v222
    v_perm_b32 v7, v223, v221, s73
    s_waitcnt lgkmcnt(4)
    v_mov_b32 v8, v224
    v_mov_b32 v9, v226
    v_perm_b32 v10, v227, v225, s73
    s_waitcnt lgkmcnt(2)
    v_mov_b32 v11, v228
    v_mov_b32 v12, v230
    v_perm_b32 v13, v231, v229, s73
    s_set_gpr_idx_off
    s_add_u32 s71, s71, 4
    s_add_u32 s50, s71, 0
    s_and_b32 s50, s50, 15
    s_lshl_b32 s50, s50, 13
    v_add_u32 v232, s50, v252
    ds_read_b64 v[216:217], v232 offset:25856
    ds_read_b64 v[218:219], v232 offset:29952
    s_add_u32 s50, s71, 1
    s_and_b32 s50, s50, 15
    s_lshl_b32 s50, s50, 13
    v_add_u32 v233, s50, v252
    ds_read_b64 v[220:221], v233 offset:25856
    ds_read_b64 v[222:223], v233 offset:29952
    s_add_u32 s50, s71, 2
    s_and_b32 s50, s50, 15
    s_lshl_b32 s50, s50, 13
    v_add_u32 v234, s50, v252
    ds_read_b64 v[224:225], v234 offset:25856
    ds_read_b64 v[226:227], v234 offset:29952
    s_add_u32 s50, s71, 3
    s_and_b32 s50, s50, 15
    s_lshl_b32 s50, s50, 13
    v_add_u32 v235, s50, v252
    ds_read_b64 v[228:229], v235 offset:25856
    ds_read_b64 v[230:231], v235 offset:29952
    s_waitcnt vmcnt(6)
    v_lshrrev_b32 v246, 6, v104
    v_lshrrev_b32 v247, 6, v106
    v_and_b32 v246, 0x3ffc, v246
    v_and_b32 v247, 0x3ffc, v247
    ds_add_rtn_u32 v246, v246, v250 offset:0
    ds_add_rtn_u32 v247, v247, v250 offset:0
    s_waitcnt lgkmcnt(10)
    v_lshl_or_b32 v103, v101, 16, v238
    v_and_or_b32 v101, v101, s55, v236
    s_mul_i32 s59, s71, 3
    s_set_gpr_idx_on s59, gpr_idx(DST)
    s_waitcnt lgkmcnt(8)
    v_mov_b32 v2, v216
    v_mov_b32 v3, v218
    v_perm_b32 v4, v219, v217, s73
    s_waitcnt lgkmcnt(6)
    v_mov_b32 v5, v220
    v_mov_b32 v6, v222
    v_perm_b32 v7, v223, v221, s73
    s_waitcnt lgkmcnt(4)
    v_mov_b32 v8, v224
    v_mov_b32 v9, v226
    v_perm_b32 v10, v227, v225, s73
    s_waitcnt lgkmcnt(2)
    v_mov_b32 v11, v228
    v_mov_b32 v12, v230
    v_perm_b32 v13, v231, v229, s73
    s_set_gpr_idx_off
    s_add_u32 s71, s71, 4
    s_cmp_ge_u32 s71, s72
    s_cbranch_scc1 Lrd1
Lrl1:
    s_add_u32 s50, s71, 0
    s_and_b32 s50, s50, 15
    s_lshl_b32 s50, s50, 13
    v_add_u32 v232, s50, v252
    ds_read_b64 v[216:217], v232 offset:25856
    ds_read_b64 v[218:219], v232 offset:29952
    s_add_u32 s50, s71, 1
    s_and_b32 s50, s50, 15
    s_lshl_b32 s50, s50, 13
    v_add_u32 v233, s50, v252
    ds_read_b64 v[220:221], v233 offset:25856
    ds_read_b64 v[222:223], v233 offset:29952
    s_add_u32 s50, s71, 2
    s_and_b32 s50, s50, 15
    s_lshl_b32 s50, s50, 13
    v_add_u32 v234, s50, v252
    ds_read_b64 v[224:225], v234 offset:25856
    ds_read_b64 v[226:227], v234 offset:29952
    s_add_u32 s50, s71, 3
    s_and_b32 s50, s50, 15
    s_lshl_b32 s50, s50, 13
    v_add_u32 v235, s50, v252
    ds_read_b64 v[228:229], v235 offset:25856
    ds_read_b64 v[230:231], v235 offset:29952
    s_mul_i32 s59, s71, 3
    s_set_gpr_idx_on s59, gpr_idx(DST)
    s_waitcnt lgkmcnt(6)
    v_mov_b32 v2, v216
    v_mov_b32 v3, v218
    v_perm_b32 v4, v219, v217, s73
    s_waitcnt lgkmcnt(4)
    v_mov_b32 v5, v220
    v_mov_b32 v6, v222
    v_perm_b32 v7, v223, v221, s73
    s_waitcnt lgkmcnt(2)
    v_mov_b32 v8, v224
    v_mov_b32 v9, v226
    v_perm_b32 v10, v227, v225, s73
    s_waitcnt lgkmcnt(0)
    v_mov_b32 v11, v228
    v_mov_b32 v12, v230
    v_perm_b32 v13, v231, v229, s73
    s_set_gpr_idx_off
    s_add_u32 s71, s71, 4
    s_cmp_lt_u32 s71, s72
    s_cbranch_scc1 Lrl1
Lrd1:
    s_mov_b32 s71, s72
    s_waitcnt vmcnt(5)
    v_lshrrev_b32 v236, 6, v108
    v_lshrrev_b32 v238, 6, v110
    v_and_b32 v236, 0x3ffc, v236
    v_and_b32 v238, 0x3ffc, v238
    ds_add_rtn_u32 v236, v236, v250 offset:0
    ds_add_rtn_u32 v238, v238, v250 offset:0
    s_waitcnt lgkmcnt(2)
    v_lshl_or_b32 v107, v105, 16, v247
    v_and_or_b32 v105, v105, s55, v246
    v_lshrrev_b32 v242, 6, v156
    v_lshrrev_b32 v243, 6, v158
    v_and_b32 v242, 0x3ffc, v242
    v_and_b32 v243, 0x3ffc, v243
    ds_read_b32 v242, v242 offset:0
    ds_read_b32 v243, v243 offset:0
    s_barrier
    v_readlane_b32 s74, v248, 20
    v_readlane_b32 s75, v248, 21
    s_bcnt1_i32_b64 s50, s[74:75]
    v_mbcnt_lo_u32_b32 v244, s74, 0
    v_mbcnt_hi_u32_b32 v244, s75, v244
    v_lshl_add_u32 v244, v244, 2, s70
    s_lshl2_add_u32 s70, s50, s70
    ds_read_b32 v244, v244 offset:13344
    v_lshrrev_b32 v240, 6, v160
    v_lshrrev_b32 v241, 6, v162
    v_and_b32 v240, 0x3ffc, v240
    v_and_b32 v241, 0x3ffc, v241
    ds_read_b32 v240, v240 offset:0
    ds_read_b32 v241, v241 offset:0
    s_waitcnt lgkmcnt(3)
    v_add_u32 v242, v242, v157
    v_add_u32 v243, v243, v159
    v_lshlrev_b32_sdwa v242, 1, v242 dst_sel:DWORD dst_unused:UNUSED_PAD src0_sel:DWORD src1_sel:WORD_0
    ds_write_b64 v242, v[156:157] offset:25856
    v_lshlrev_b32_sdwa v243, 1, v243 dst_sel:DWORD dst_unused:UNUSED_PAD src0_sel:DWORD src1_sel:WORD_0
    ds_write_b64 v243, v[158:159] offset:25856
    s_movk_i32 s51, 6912
    s_waitcnt lgkmcnt(15)
    v_add_u32 v245, v245, v251
    buffer_load_dwordx3 v[132:134], v245, s[24:27], s51 offen
    s_waitcnt vmcnt(5)
    v_lshrrev_b32 v246, 6, v112
    v_lshrrev_b32 v247, 6, v114
    v_and_b32 v246, 0x3ffc, v246
    v_and_b32 v247, 0x3ffc, v247
    ds_add_rtn_u32 v246, v246, v250 offset:0
    ds_add_rtn_u32 v247, v247, v250 offset:0
    s_waitcnt lgkmcnt(9)
    v_lshl_or_b32 v111, v109, 16, v238
    v_and_or_b32 v109, v109, s55, v236
    v_readlane_b32 s74, v248, 22
    v_readlane_b32 s75, v248, 23
    s_bcnt1_i32_b64 s50, s[74:75]
    v_mbcnt_lo_u32_b32 v245, s74, 0
    v_mbcnt_hi_u32_b32 v245, s75, v245
    v_lshl_add_u32 v245, v245, 2, s70
    s_lshl2_add_u32 s70, s50, s70
    ds_read_b32 v245, v245 offset:13344
    v_lshrrev_b32 v242, 6, v164
    v_lshrrev_b32 v243, 6, v166
    v_and_b32 v242, 0x3ffc, v242
    v_and_b32 v243, 0x3ffc, v243
    ds_read_b32 v242, v242 offset:0
    ds_read_b32 v243, v243 offset:0
    s_waitcnt lgkmcnt(7)
    v_add_u32 v240, v240, v161
    v_add_u32 v241, v241, v163
    v_lshlrev_b32_sdwa v240, 1, v240 dst_sel:DWORD dst_unused:UNUSED_PAD src0_sel:DWORD src1_sel:WORD_0
    ds_write_b64 v240, v[160:161] offset:25856
    v_lshlrev_b32_sdwa v241, 1, v241 dst_sel:DWORD dst_unused:UNUSED_PAD src0_sel:DWORD src1_sel:WORD_0
    ds_write_b64 v241, v[162:163] offset:25856
    s_movk_i32 s51, 7680
    s_waitcnt lgkmcnt(11)
    v_add_u32 v244, v244, v251
    buffer_load_dwordx3 v[136:138], v244, s[24:27], s51 offen
    s_waitcnt vmcnt(5)
    v_lshrrev_b32 v236, 6, v116
    v_lshrrev_b32 v238, 6, v118
    v_and_b32 v236, 0x3ffc, v236
    v_and_b32 v238, 0x3ffc, v238
    ds_add_rtn_u32 v236, v236, v250 offset:0
    ds_add_rtn_u32 v238, v238, v250 offset:0
    s_waitcnt lgkmcnt(7)
    v_lshl_or_b32 v115, v113, 16, v247
    v_and_or_b32 v113, v113, s55, v246
    v_readlane_b32 s74, v248, 24
    v_readlane_b32 s75, v248, 25
    s_bcnt1_i32_b64 s50, s[74:75]
    v_mbcnt_lo_u32_b32 v244, s74, 0
    v_mbcnt_hi_u32_b32 v244, s75, v244
    v_lshl_add_u32 v244, v244, 2, s70
    s_lshl2_add_u32 s70, s50, s70
    ds_read_b32 v244, v244 offset:13344
    v_lshrrev_b32 v240, 6, v168
    v_lshrrev_b32 v241, 6, v170
    v_and_b32 v240, 0x3ffc, v240
    v_and_b32 v241, 0x3ffc, v241
    ds_read_b32 v240, v240 offset:0
    ds_read_b32 v241, v241 offset:0
    s_waitcnt lgkmcnt(7)
    v_add_u32 v242, v242, v165
    v_add_u32 v243, v243, v167
    v_lshlrev_b32_sdwa v242, 1, v242 dst_sel:DWORD dst_unused:UNUSED_PAD src0_sel:DWORD src1_sel:WORD_0
    ds_write_b64 v242, v[164:165] offset:25856
    v_lshlrev_b32_sdwa v243, 1, v243 dst_sel:DWORD dst_unused:UNUSED_PAD src0_sel:DWORD src1_sel:WORD_0
    ds_write_b64 v243, v[166:167] offset:25856
    s_movk_i32 s51, 8448
    s_waitcnt lgkmcnt(11)
    v_add_u32 v245, v245, v251
    buffer_load_dwordx3 v[140:142], v245, s[24:27], s51 offen
    s_waitcnt vmcnt(5)
    v_lshrrev_b32 v246, 6, v120
    v_lshrrev_b32 v247, 6, v122
    v_and_b32 v246, 0x3ffc, v246
    v_and_b32 v247, 0x3ffc, v247
    ds_add_rtn_u32 v246, v246, v250 offset:0
    ds_add_rtn_u32 v247, v247, v250 offset:0
    s_waitcnt lgkmcnt(7)
    v_lshl_or_b32 v119, v117, 16, v238
    v_and_or_b32 v117, v117, s55, v236
    v_lshrrev_b32 v242, 6, v172
    v_lshrrev_b32 v243, 6, v174
    v_and_b32 v242, 0x3ffc, v242
    v_and_b32 v243, 0x3ffc, v243
    ds_read_b32 v242, v242 offset:0
    ds_read_b32 v243, v243 offset:0
    s_waitcnt lgkmcnt(6)
    v_add_u32 v240, v240, v169
    v_add_u32 v241, v241, v171
    v_lshlrev_b32_sdwa v240, 1, v240 dst_sel:DWORD dst_unused:UNUSED_PAD src0_sel:DWORD src1_sel:WORD_0
    ds_write_b64 v240, v[168:169] offset:25856
    v_lshlrev_b32_sdwa v241, 1, v241 dst_sel:DWORD dst_unused:UNUSED_PAD src0_sel:DWORD src1_sel:WORD_0
    ds_write_b64 v241, v[170:171] offset:25856
    s_movk_i32 s51, 9216
    s_waitcnt lgkmcnt(10)
    v_add_u32 v244, v244, v251
    buffer_load_dwordx3 v[144:146], v244, s[24:27], s51 offen
    s_cmp_le_u32 s82, 832
    s_cbranch_scc1 Lg5
    v_readlane_b32 s74, v248, 26
    v_readlane_b32 s75, v248, 27
    s_bcnt1_i32_b64 s50, s[74:75]
    v_mbcnt_lo_u32_b32 v245, s74, 0
    v_mbcnt_hi_u32_b32 v245, s75, v245
    v_lshl_add_u32 v245, v245, 2, s70
    s_lshl2_add_u32 s70, s50, s70
    ds_read_b32 v245, v245 offset:13344
    s_movk_i32 s51, 9984
    s_waitcnt lgkmcnt(0)
    v_add_u32 v245, v245, v251
    buffer_load_dwordx3 v[148:150], v245, s[24:27], s51 offen
    s_cmp_le_u32 s82, 896
    s_cbranch_scc1 Lg5
    v_readlane_b32 s74, v248, 28
    v_readlane_b32 s75, v248, 29
    s_bcnt1_i32_b64 s50, s[74:75]
    v_mbcnt_lo_u32_b32 v244, s74, 0
    v_mbcnt_hi_u32_b32 v244, s75, v244
    v_lshl_add_u32 v244, v244, 2, s70
    s_lshl2_add_u32 s70, s50, s70
    ds_read_b32 v244, v244 offset:13344
    s_movk_i32 s51, 10752
    s_waitcnt lgkmcnt(0)
    v_add_u32 v244, v244, v251
    buffer_load_dwordx3 v[152:154], v244, s[24:27], s51 offen
Lg5:
    s_nop 3
    s_mul_i32 s70, s48, 1088
    v_readlane_b32 s74, v248, 32
    v_readlane_b32 s75, v248, 33
    s_bcnt1_i32_b64 s50, s[74:75]
    v_mbcnt_lo_u32_b32 v245, s74, 0
    v_mbcnt_hi_u32_b32 v245, s75, v245
    v_lshl_add_u32 v245, v245, 2, s70
    s_lshl2_add_u32 s70, s50, s70
    ds_read_b32 v245, v245 offset:13616
    s_waitcnt vmcnt(5)
    v_lshrrev_b32 v236, 6, v124
    v_lshrrev_b32 v238, 6, v126
    v_and_b32 v236, 0x3ffc, v236
    v_and_b32 v238, 0x3ffc, v238
    ds_add_rtn_u32 v236, v236, v250 offset:0
    ds_add_rtn_u32 v238, v238, v250 offset:0
    s_waitcnt lgkmcnt(7)
    v_lshl_or_b32 v123, v121, 16, v247
    v_and_or_b32 v121, v121, s55, v246
    v_readlane_b32 s74, v248, 34
    v_readlane_b32 s75, v248, 35
    s_bcnt1_i32_b64 s50, s[74:75]
    v_mbcnt_lo_u32_b32 v244, s74, 0
    v_mbcnt_hi_u32_b32 v244, s75, v244
    v_lshl_add_u32 v244, v244, 2, s70
    s_lshl2_add_u32 s70, s50, s70
    ds_read_b32 v244, v244 offset:13616
    v_lshrrev_b32 v240, 6, v176
    v_lshrrev_b32 v241, 6, v178
    v_and_b32 v240, 0x3ffc, v240
    v_and_b32 v241, 0x3ffc, v241
    ds_read_b32 v240, v240 offset:0
    ds_read_b32 v241, v241 offset:0
    s_waitcnt lgkmcnt(8)
    v_add_u32 v242, v242, v173
    v_add_u32 v243, v243, v175
    v_lshlrev_b32_sdwa v242, 1, v242 dst_sel:DWORD dst_unused:UNUSED_PAD src0_sel:DWORD src1_sel:WORD_0
    ds_write_b64 v242, v[172:173] offset:25856
    v_lshlrev_b32_sdwa v243, 1, v243 dst_sel:DWORD dst_unused:UNUSED_PAD src0_sel:DWORD src1_sel:WORD_0
    ds_write_b64 v243, v[174:175] offset:25856
    s_movk_i32 s51, 0
    s_waitcnt lgkmcnt(7)
    v_add_u32 v245, v245, v251
    buffer_load_dwordx3 v[156:158], v245, s[24:27], s51 offen
    s_waitcnt vmcnt(5)
    v_lshrrev_b32 v246, 6, v128
    v_lshrrev_b32 v247, 6, v130
    v_and_b32 v246, 0x3ffc, v246
    v_and_b32 v247, 0x3ffc, v247
    ds_add_rtn_u32 v246, v246, v250 offset:0
    ds_add_rtn_u32 v247, v247, v250 offset:0
    s_waitcnt lgkmcnt(7)
    v_lshl_or_b32 v127, v125, 16, v238
    v_and_or_b32 v125, v125, s55, v236
    v_readlane_b32 s74, v248, 36
    v_readlane_b32 s75, v248, 37
    s_bcnt1_i32_b64 s50, s[74:75]
    v_mbcnt_lo_u32_b32 v245, s74, 0
    v_mbcnt_hi_u32_b32 v245, s75, v245
    v_lshl_add_u32 v245, v245, 2, s70
    s_lshl2_add_u32 s70, s50, s70
    ds_read_b32 v245, v245 offset:13616
    v_lshrrev_b32 v242, 6, v180
    v_lshrrev_b32 v243, 6, v182
    v_and_b32 v242, 0x3ffc, v242
    v_and_b32 v243, 0x3ffc, v243
    ds_read_b32 v242, v242 offset:0
    ds_read_b32 v243, v243 offset:0
    s_waitcnt lgkmcnt(7)
    v_add_u32 v240, v240, v177
    v_add_u32 v241, v241, v179
    v_lshlrev_b32_sdwa v240, 1, v240 dst_sel:DWORD dst_unused:UNUSED_PAD src0_sel:DWORD src1_sel:WORD_0
    ds_write_b64 v240, v[176:177] offset:25856
    v_lshlrev_b32_sdwa v241, 1, v241 dst_sel:DWORD dst_unused:UNUSED_PAD src0_sel:DWORD src1_sel:WORD_0
    ds_write_b64 v241, v[178:179] offset:25856
    s_movk_i32 s51, 768
    s_waitcnt lgkmcnt(11)
    v_add_u32 v244, v244, v251
    buffer_load_dwordx3 v[160:162], v244, s[24:27], s51 offen
    s_waitcnt vmcnt(5)
    v_lshrrev_b32 v236, 6, v132
    v_lshrrev_b32 v238, 6, v134
    v_and_b32 v236, 0x3ffc, v236
    v_and_b32 v238, 0x3ffc, v238
    ds_add_rtn_u32 v236, v236, v250 offset:0
    ds_add_rtn_u32 v238, v238, v250 offset:0
    s_waitcnt lgkmcnt(7)
    v_lshl_or_b32 v131, v129, 16, v247
    v_and_or_b32 v129, v129, s55, v246
    v_readlane_b32 s74, v248, 38
    v_readlane_b32 s75, v248, 39
    s_bcnt1_i32_b64 s50, s[74:75]
    v_mbcnt_lo_u32_b32 v244, s74, 0
    v_mbcnt_hi_u32_b32 v244, s75, v244
    v_lshl_add_u32 v244, v244, 2, s70
    s_lshl2_add_u32 s70, s50, s70
    ds_read_b32 v244, v244 offset:13616
    v_lshrrev_b32 v240, 6, v184
    v_lshrrev_b32 v241, 6, v186
    v_and_b32 v240, 0x3ffc, v240
    v_and_b32 v241, 0x3ffc, v241
    ds_read_b32 v240, v240 offset:0
    ds_read_b32 v241, v241 offset:0
    s_waitcnt lgkmcnt(7)
    v_add_u32 v242, v242, v181
    v_add_u32 v243, v243, v183
    v_lshlrev_b32_sdwa v242, 1, v242 dst_sel:DWORD dst_unused:UNUSED_PAD src0_sel:DWORD src1_sel:WORD_0
    ds_write_b64 v242, v[180:181] offset:25856
    v_lshlrev_b32_sdwa v243, 1, v243 dst_sel:DWORD dst_unused:UNUSED_PAD src0_sel:DWORD src1_sel:WORD_0
    ds_write_b64 v243, v[182:183] offset:25856
    s_movk_i32 s51, 1536
    s_waitcnt lgkmcnt(11)
    v_add_u32 v245, v245, v251
    buffer_load_dwordx3 v[164:166], v245, s[24:27], s51 offen
    s_waitcnt vmcnt(5)
    v_lshrrev_b32 v246, 6, v136
    v_lshrrev_b32 v247, 6, v138
    v_and_b32 v246, 0x3ffc, v246
    v_and_b32 v247, 0x3ffc, v247
    v_cmpx_gt_i32 vcc, 0, v137
    ds_add_rtn_u32 v246, v246, v250 offset:0
    ds_add_rtn_u32 v247, v247, v250 offset:0
    s_mov_b64 exec, -1
    s_waitcnt lgkmcnt(7)
    v_lshl_or_b32 v135, v133, 16, v238
    v_and_or_b32 v133, v133, s55, v236
    v_readlane_b32 s74, v248, 40
    v_readlane_b32 s75, v248, 41
    s_bcnt1_i32_b64 s50, s[74:75]
    v_mbcnt_lo_u32_b32 v245, s74, 0
    v_mbcnt_hi_u32_b32 v245, s75, v245
    v_lshl_add_u32 v245, v245, 2, s70
    s_lshl2_add_u32 s70, s50, s70
    ds_read_b32 v245, v245 offset:13616
    v_lshrrev_b32 v242, 6, v188
    v_lshrrev_b32 v243, 6, v190
    v_and_b32 v242, 0x3ffc, v242
    v_and_b32 v243, 0x3ffc, v243
    ds_read_b32 v242, v242 offset:0
    ds_read_b32 v243, v243 offset:0
    s_waitcnt lgkmcnt(7)
    v_add_u32 v240, v240, v185
    v_add_u32 v241, v241, v187
    v_lshlrev_b32_sdwa v240, 1, v240 dst_sel:DWORD dst_unused:UNUSED_PAD src0_sel:DWORD src1_sel:WORD_0
    ds_write_b64 v240, v[184:185] offset:25856
    v_lshlrev_b32_sdwa v241, 1, v241 dst_sel:DWORD dst_unused:UNUSED_PAD src0_sel:DWORD src1_sel:WORD_0
    ds_write_b64 v241, v[186:187] offset:25856
    s_movk_i32 s51, 2304
    s_waitcnt lgkmcnt(11)
    v_add_u32 v244, v244, v251
    buffer_load_dwordx3 v[168:170], v244, s[24:27], s51 offen
    s_waitcnt vmcnt(5)
    v_lshrrev_b32 v236, 6, v140
    v_lshrrev_b32 v238, 6, v142
    v_and_b32 v236, 0x3ffc, v236
    v_and_b32 v238, 0x3ffc, v238
    v_cmpx_gt_i32 vcc, 0, v141
    ds_add_rtn_u32 v236, v236, v250 offset:0
    ds_add_rtn_u32 v238, v238, v250 offset:0
    s_mov_b64 exec, -1
    s_waitcnt lgkmcnt(7)
    v_lshl_or_b32 v139, v137, 16, v247
    v_and_or_b32 v137, v137, s55, v246
    v_readlane_b32 s74, v248, 42
    v_readlane_b32 s75, v248, 43
    s_bcnt1_i32_b64 s50, s[74:75]
    v_mbcnt_lo_u32_b32 v244, s74, 0
    v_mbcnt_hi_u32_b32 v244, s75, v244
    v_lshl_add_u32 v244, v244, 2, s70
    s_lshl2_add_u32 s70, s50, s70
    ds_read_b32 v244, v244 offset:13616
    v_lshrrev_b32 v240, 6, v192
    v_lshrrev_b32 v241, 6, v194
    v_and_b32 v240, 0x3ffc, v240
    v_and_b32 v241, 0x3ffc, v241
    ds_read_b32 v240, v240 offset:0
    ds_read_b32 v241, v241 offset:0
    s_waitcnt lgkmcnt(7)
    v_add_u32 v242, v242, v189
    v_add_u32 v243, v243, v191
    v_lshlrev_b32_sdwa v242, 1, v242 dst_sel:DWORD dst_unused:UNUSED_PAD src0_sel:DWORD src1_sel:WORD_0
    ds_write_b64 v242, v[188:189] offset:25856
    v_lshlrev_b32_sdwa v243, 1, v243 dst_sel:DWORD dst_unused:UNUSED_PAD src0_sel:DWORD src1_sel:WORD_0
    ds_write_b64 v243, v[190:191] offset:25856
    s_movk_i32 s51, 3072
    s_waitcnt lgkmcnt(11)
    v_add_u32 v245, v245, v251
    buffer_load_dwordx3 v[172:174], v245, s[24:27], s51 offen
    s_waitcnt vmcnt(5)
    v_lshrrev_b32 v246, 6, v144
    v_lshrrev_b32 v247, 6, v146
    v_and_b32 v246, 0x3ffc, v246
    v_and_b32 v247, 0x3ffc, v247
    v_cmpx_gt_i32 vcc, 0, v145
    ds_add_rtn_u32 v246, v246, v250 offset:0
    ds_add_rtn_u32 v247, v247, v250 offset:0
    s_mov_b64 exec, -1
    s_waitcnt lgkmcnt(7)
    v_lshl_or_b32 v143, v141, 16, v238
    v_and_or_b32 v141, v141, s55, v236
    s_waitcnt lgkmcnt(0)
    v_lshl_or_b32 v147, v145, 16, v247
    v_and_or_b32 v145, v145, s55, v246
    s_cmp_le_u32 s82, 832
    s_cbranch_scc1 Lg6
    s_waitcnt vmcnt(5)
    v_lshrrev_b32 v236, 6, v148
    v_lshrrev_b32 v238, 6, v150
    v_and_b32 v236, 0x3ffc, v236
    v_and_b32 v238, 0x3ffc, v238
    v_cmpx_gt_i32 vcc, 0, v149
    ds_add_rtn_u32 v236, v236, v250 offset:0
    ds_add_rtn_u32 v238, v238, v250 offset:0
    s_mov_b64 exec, -1
    s_waitcnt lgkmcnt(0)
    v_lshl_or_b32 v151, v149, 16, v238
    v_and_or_b32 v149, v149, s55, v236
    s_cmp_le_u32 s82, 896
    s_cbranch_scc1 Lg6
    s_waitcnt vmcnt(5)
    v_lshrrev_b32 v246, 6, v152
    v_lshrrev_b32 v247, 6, v154
    v_and_b32 v246, 0x3ffc, v246
    v_and_b32 v247, 0x3ffc, v247
    v_cmpx_gt_i32 vcc, 0, v153
    ds_add_rtn_u32 v246, v246, v250 offset:0
    ds_add_rtn_u32 v247, v247, v250 offset:0
    s_mov_b64 exec, -1
    s_waitcnt lgkmcnt(0)
    v_lshl_or_b32 v155, v153, 16, v247
    v_and_or_b32 v153, v153, s55, v246
Lg6:
    s_nop 3
    v_readlane_b32 s74, v248, 44
    v_readlane_b32 s75, v248, 45
    s_bcnt1_i32_b64 s50, s[74:75]
    v_mbcnt_lo_u32_b32 v245, s74, 0
    v_mbcnt_hi_u32_b32 v245, s75, v245
    v_lshl_add_u32 v245, v245, 2, s70
    s_lshl2_add_u32 s70, s50, s70
    ds_read_b32 v245, v245 offset:13616
    v_lshrrev_b32 v242, 6, v196
    v_lshrrev_b32 v243, 6, v198
    v_and_b32 v242, 0x3ffc, v242
    v_and_b32 v243, 0x3ffc, v243
    ds_read_b32 v242, v242 offset:0
    ds_read_b32 v243, v243 offset:0
    s_waitcnt lgkmcnt(7)
    v_add_u32 v240, v240, v193
    v_add_u32 v241, v241, v195
    v_lshlrev_b32_sdwa v240, 1, v240 dst_sel:DWORD dst_unused:UNUSED_PAD src0_sel:DWORD src1_sel:WORD_0
    ds_write_b64 v240, v[192:193] offset:25856
    v_lshlrev_b32_sdwa v241, 1, v241 dst_sel:DWORD dst_unused:UNUSED_PAD src0_sel:DWORD src1_sel:WORD_0
    ds_write_b64 v241, v[194:195] offset:25856
    s_movk_i32 s51, 3840
    s_waitcnt lgkmcnt(11)
    v_add_u32 v244, v244, v251
    buffer_load_dwordx3 v[176:178], v244, s[24:27], s51 offen
    s_waitcnt lgkmcnt(5)
    s_barrier
    s_cmp_lg_u32 s48, 3
    s_cbranch_scc1 Lks2
    v_lshlrev_b32 v232, 6, v1
    ds_read_b128 v[216:219], v232 offset:6272
    ds_read_b128 v[220:223], v232 offset:6288
    ds_read_b128 v[224:227], v232 offset:6304
    ds_read_b128 v[228:231], v232 offset:6320
    s_waitcnt lgkmcnt(0)
    v_add_u32 v217, v217, v216
    v_add_u32 v218, v218, v217
    v_add_u32 v219, v219, v218
    v_add_u32 v220, v220, v219
    v_add_u32 v221, v221, v220
    v_add_u32 v222, v222, v221
    v_add_u32 v223, v223, v222
    v_add_u32 v224, v224, v223
    v_add_u32 v225, v225, v224
    v_add_u32 v226, v226, v225
    v_add_u32 v227, v227, v226
    v_add_u32 v228, v228, v227
    v_add_u32 v229, v229, v228
    v_add_u32 v230, v230, v229
    v_add_u32 v231, v231, v230
    v_mov_b32 v233, v231
    s_nop 1
    v_add_u32_dpp v233, v233, v233 row_shr:1 row_mask:0xf bank_mask:0xf
    s_nop 1
    v_add_u32_dpp v233, v233, v233 row_shr:2 row_mask:0xf bank_mask:0xf
    s_nop 1
    v_add_u32_dpp v233, v233, v233 row_shr:4 row_mask:0xf bank_mask:0xf
    s_nop 1
    v_add_u32_dpp v233, v233, v233 row_shr:8 row_mask:0xf bank_mask:0xf
    s_nop 1
    v_add_u32_dpp v233, v233, v233 row_bcast:15 row_mask:0xa bank_mask:0xf
    s_nop 1
    v_add_u32_dpp v233, v233, v233 row_bcast:31 row_mask:0xc bank_mask:0xf
    v_sub_u32 v233, v233, v231
    v_lshl_add_u32 v233, s66, 2, v233
    v_cmpx_gt_u32 vcc, 49, v1
    v_add_u32 v231, v230, v233
    v_add_u32 v230, v229, v233
    v_add_u32 v229, v228, v233
    v_add_u32 v228, v227, v233
    ds_write_b128 v232, v[228:231] offset:6320
    v_add_u32 v227, v226, v233
    v_add_u32 v226, v225, v233
    v_add_u32 v225, v224, v233
    v_add_u32 v224, v223, v233
    ds_write_b128 v232, v[224:227] offset:6304
    v_add_u32 v223, v222, v233
    v_add_u32 v222, v221, v233
    v_add_u32 v221, v220, v233
    v_add_u32 v220, v219, v233
    ds_write_b128 v232, v[220:223] offset:6288
    v_add_u32 v219, v218, v233
    v_add_u32 v218, v217, v233
    v_add_u32 v217, v216, v233
    v_mov_b32 v216, v233
    ds_write_b128 v232, v[216:219] offset:6272
    s_lshl_b32 s50, s67, 2
    v_mov_b32 v233, s50
    v_lshlrev_b32 v232, 2, v1
    s_mov_b64 exec, 0xffff
    ds_write_b32 v232, v233 offset:12672
    s_mov_b64 exec, -1
Lks2:
    s_nop 1
    v_readlane_b32 s74, v248, 46
    v_readlane_b32 s75, v248, 47
    s_bcnt1_i32_b64 s50, s[74:75]
    v_mbcnt_lo_u32_b32 v244, s74, 0
    v_mbcnt_hi_u32_b32 v244, s75, v244
    v_lshl_add_u32 v244, v244, 2, s70
    s_lshl2_add_u32 s70, s50, s70
    ds_read_b32 v244, v244 offset:13616
    v_lshrrev_b32 v240, 6, v200
    v_lshrrev_b32 v241, 6, v202
    v_and_b32 v240, 0x3ffc, v240
    v_and_b32 v241, 0x3ffc, v241
    ds_read_b32 v240, v240 offset:0
    ds_read_b32 v241, v241 offset:0
    v_cmpx_gt_i32 vcc, 0, v197
    s_waitcnt lgkmcnt(5)
    v_add_u32 v242, v242, v197
    v_add_u32 v243, v243, v199
    v_lshlrev_b32_sdwa v242, 1, v242 dst_sel:DWORD dst_unused:UNUSED_PAD src0_sel:DWORD src1_sel:WORD_0
    ds_write_b64 v242, v[196:197] offset:25856
    v_lshlrev_b32_sdwa v243, 1, v243 dst_sel:DWORD dst_unused:UNUSED_PAD src0_sel:DWORD src1_sel:WORD_0
    ds_write_b64 v243, v[198:199] offset:25856
    s_mov_b64 exec, -1
    s_movk_i32 s51, 4608
    s_waitcnt lgkmcnt(9)
    v_add_u32 v245, v245, v251
    buffer_load_dwordx3 v[180:182], v245, s[24:27], s51 offen
    v_readlane_b32 s74, v248, 48
    v_readlane_b32 s75, v248, 49
    s_bcnt1_i32_b64 s50, s[74:75]
    v_mbcnt_lo_u32_b32 v245, s74, 0
    v_mbcnt_hi_u32_b32 v245, s75, v245
    v_lshl_add_u32 v245, v245, 2, s70
    s_lshl2_add_u32 s70, s50, s70
    ds_read_b32 v245, v245 offset:13616
    v_lshrrev_b32 v242, 6, v204
    v_lshrrev_b32 v243, 6, v206
    v_and_b32 v242, 0x3ffc, v242
    v_and_b32 v243, 0x3ffc, v243
    ds_read_b32 v242, v242 offset:0
    ds_read_b32 v243, v243 offset:0
    v_cmpx_gt_i32 vcc, 0, v201
    s_waitcnt lgkmcnt(5)
    v_add_u32 v240, v240, v201
    v_add_u32 v241, v241, v203
    v_lshlrev_b32_sdwa v240, 1, v240 dst_sel:DWORD dst_unused:UNUSED_PAD src0_sel:DWORD src1_sel:WORD_0
    ds_write_b64 v240, v[200:201] offset:25856
    v_lshlrev_b32_sdwa v241, 1, v241 dst_sel:DWORD dst_unused:UNUSED_PAD src0_sel:DWORD src1_sel:WORD_0
    ds_write_b64 v241, v[202:203] offset:25856
    s_mov_b64 exec, -1
    s_movk_i32 s51, 5376
    s_waitcnt lgkmcnt(9)
    v_add_u32 v244, v244, v251
    buffer_load_dwordx3 v[184:186], v244, s[24:27], s51 offen
    v_readlane_b32 s74, v248, 50
    v_readlane_b32 s75, v248, 51
    s_bcnt1_i32_b64 s50, s[74:75]
    v_mbcnt_lo_u32_b32 v244, s74, 0
    v_mbcnt_hi_u32_b32 v244, s75, v244
    v_lshl_add_u32 v244, v244, 2, s70
    s_lshl2_add_u32 s70, s50, s70
    ds_read_b32 v244, v244 offset:13616
    v_cmpx_gt_i32 vcc, 0, v205
    s_waitcnt lgkmcnt(3)
    v_add_u32 v242, v242, v205
    v_add_u32 v243, v243, v207
    v_lshlrev_b32_sdwa v242, 1, v242 dst_sel:DWORD dst_unused:UNUSED_PAD src0_sel:DWORD src1_sel:WORD_0
    ds_write_b64 v242, v[204:205] offset:25856
    v_lshlrev_b32_sdwa v243, 1, v243 dst_sel:DWORD dst_unused:UNUSED_PAD src0_sel:DWORD src1_sel:WORD_0
    ds_write_b64 v243, v[206:207] offset:25856
    s_mov_b64 exec, -1
    s_movk_i32 s51, 6144
    s_waitcnt lgkmcnt(7)
    v_add_u32 v245, v245, v251
    buffer_load_dwordx3 v[188:190], v245, s[24:27], s51 offen
    s_cmp_le_u32 s81, 832
    s_cbranch_scc1 Lg7
    v_lshrrev_b32 v240, 6, v208
    v_lshrrev_b32 v241, 6, v210
    v_and_b32 v240, 0x3ffc, v240
    v_and_b32 v241, 0x3ffc, v241
    ds_read_b32 v240, v240 offset:0
    ds_read_b32 v241, v241 offset:0
    v_cmpx_gt_i32 vcc, 0, v209
    s_waitcnt lgkmcnt(0)
    v_add_u32 v240, v240, v209
    v_add_u32 v241, v241, v211
    v_lshlrev_b32_sdwa v240, 1, v240 dst_sel:DWORD dst_unused:UNUSED_PAD src0_sel:DWORD src1_sel:WORD_0
    ds_write_b64 v240, v[208:209] offset:25856
    v_lshlrev_b32_sdwa v241, 1, v241 dst_sel:DWORD dst_unused:UNUSED_PAD src0_sel:DWORD src1_sel:WORD_0
    ds_write_b64 v241, v[210:211] offset:25856
    s_mov_b64 exec, -1
    s_cmp_le_u32 s81, 896
    s_cbranch_scc1 Lg7
    v_lshrrev_b32 v242, 6, v212
    v_lshrrev_b32 v243, 6, v214
    v_and_b32 v242, 0x3ffc, v242
    v_and_b32 v243, 0x3ffc, v243
    ds_read_b32 v242, v242 offset:0
    ds_read_b32 v243, v243 offset:0
    v_cmpx_gt_i32 vcc, 0, v213
    s_waitcnt lgkmcnt(0)
    v_add_u32 v242, v242, v213
    v_add_u32 v243, v243, v215
    v_lshlrev_b32_sdwa v242, 1, v242 dst_sel:DWORD dst_unused:UNUSED_PAD src0_sel:DWORD src1_sel:WORD_0
    ds_write_b64 v242, v[212:213] offset:25856
    v_lshlrev_b32_sdwa v243, 1, v243 dst_sel:DWORD dst_unused:UNUSED_PAD src0_sel:DWORD src1_sel:WORD_0
    ds_write_b64 v243, v[214:215] offset:25856
    s_mov_b64 exec, -1
Lg7:
    s_nop 3
    s_waitcnt lgkmcnt(0)
    s_barrier
    s_lshr_b32 s72, s66, 10
    s_add_u32 s50, s71, 0
    s_and_b32 s50, s50, 15
    s_lshl_b32 s50, s50, 13
    v_add_u32 v232, s50, v252
    ds_read_b64 v[216:217], v232 offset:25856
    ds_read_b64 v[218:219], v232 offset:29952
    s_add_u32 s50, s71, 1
    s_and_b32 s50, s50, 15
    s_lshl_b32 s50, s50, 13
    v_add_u32 v233, s50, v252
    ds_read_b64 v[220:221], v233 offset:25856
    ds_read_b64 v[222:223], v233 offset:29952
    s_add_u32 s50, s71, 2
    s_and_b32 s50, s50, 15
    s_lshl_b32 s50, s50, 13
    v_add_u32 v234, s50, v252
    ds_read_b64 v[224:225], v234 offset:25856
    ds_read_b64 v[226:227], v234 offset:29952
    s_add_u32 s50, s71, 3
    s_and_b32 s50, s50, 15
    s_lshl_b32 s50, s50, 13
    v_add_u32 v235, s50, v252
    ds_read_b64 v[228:229], v235 offset:25856
    ds_read_b64 v[230:231], v235 offset:29952
    s_waitcnt vmcnt(8)
    v_lshrrev_b32 v236, 6, v156
    v_lshrrev_b32 v238, 6, v158
    v_and_b32 v236, 0x3ffc, v236
    v_and_b32 v238, 0x3ffc, v238
    ds_add_rtn_u32 v236, v236, v250 offset:0
    ds_add_rtn_u32 v238, v238, v250 offset:0
    s_mul_i32 s59, s71, 3
    s_set_gpr_idx_on s59, gpr_idx(DST)
    s_waitcnt lgkmcnt(8)
    v_mov_b32 v2, v216
    v_mov_b32 v3, v218
    v_perm_b32 v4, v219, v217, s73
    s_waitcnt lgkmcnt(6)
    v_mov_b32 v5, v220
    v_mov_b32 v6, v222
    v_perm_b32 v7, v223, v221, s73
    s_waitcnt lgkmcnt(4)
    v_mov_b32 v8, v224
    v_mov_b32 v9, v226
    v_perm_b32 v10, v227, v225, s73
    s_waitcnt lgkmcnt(2)
    v_mov_b32 v11, v228
    v_mov_b32 v12, v230
    v_perm_b32 v13, v231, v229, s73
    s_set_gpr_idx_off
    s_add_u32 s71, s71, 4
    s_add_u32 s50, s71, 0
    s_and_b32 s50, s50, 15
    s_lshl_b32 s50, s50, 13
    v_add_u32 v232, s50, v252
    ds_read_b64 v[216:217], v232 offset:25856
    ds_read_b64 v[218:219], v232 offset:29952
    s_add_u32 s50, s71, 1
    s_and_b32 s50, s50, 15
    s_lshl_b32 s50, s50, 13
    v_add_u32 v233, s50, v252
    ds_read_b64 v[220:221], v233 offset:25856
    ds_read_b64 v[222:223], v233 offset:29952
    s_add_u32 s50, s71, 2
    s_and_b32 s50, s50, 15
    s_lshl_b32 s50, s50, 13
    v_add_u32 v234, s50, v252
    ds_read_b64 v[224:225], v234 offset:25856
    ds_read_b64 v[226:227], v234 offset:29952
    s_add_u32 s50, s71, 3
    s_and_b32 s50, s50, 15
    s_lshl_b32 s50, s50, 13
    v_add_u32 v235, s50, v252
    ds_read_b64 v[228:229], v235 offset:25856
    ds_read_b64 v[230:231], v235 offset:29952
    s_waitcnt vmcnt(7)
    v_lshrrev_b32 v246, 6, v160
    v_lshrrev_b32 v247, 6, v162
    v_and_b32 v246, 0x3ffc, v246
    v_and_b32 v247, 0x3ffc, v247
    ds_add_rtn_u32 v246, v246, v250 offset:0
    ds_add_rtn_u32 v247, v247, v250 offset:0
    s_waitcnt lgkmcnt(10)
    v_lshl_or_b32 v159, v157, 16, v238
    v_and_or_b32 v157, v157, s55, v236
    s_mul_i32 s59, s71, 3
    s_set_gpr_idx_on s59, gpr_idx(DST)
    s_waitcnt lgkmcnt(8)
    v_mov_b32 v2, v216
    v_mov_b32 v3, v218
    v_perm_b32 v4, v219, v217, s73
    s_waitcnt lgkmcnt(6)
    v_mov_b32 v5, v220
    v_mov_b32 v6, v222
    v_perm_b32 v7, v223, v221, s73
    s_waitcnt lgkmcnt(4)
    v_mov_b32 v8, v224
    v_mov_b32 v9, v226
    v_perm_b32 v10, v227, v225, s73
    s_waitcnt lgkmcnt(2)
    v_mov_b32 v11, v228
    v_mov_b32 v12, v230
    v_perm_b32 v13, v231, v229, s73
    s_set_gpr_idx_off
    s_add_u32 s71, s71, 4
    s_add_u32 s50, s71, 0
    s_and_b32 s50, s50, 15
    s_lshl_b32 s50, s50, 13
    v_add_u32 v232, s50, v252
    ds_read_b64 v[216:217], v232 offset:25856
    ds_read_b64 v[218:219], v232 offset:29952
    s_add_u32 s50, s71, 1
    s_and_b32 s50, s50, 15
    s_lshl_b32 s50, s50, 13
    v_add_u32 v233, s50, v252
    ds_read_b64 v[220:221], v233 offset:25856
    ds_read_b64 v[222:223], v233 offset:29952
    s_add_u32 s50, s71, 2
    s_and_b32 s50, s50, 15
    s_lshl_b32 s50, s50, 13
    v_add_u32 v234, s50, v252
    ds_read_b64 v[224:225], v234 offset:25856
    ds_read_b64 v[226:227], v234 offset:29952
    s_add_u32 s50, s71, 3
    s_and_b32 s50, s50, 15
    s_lshl_b32 s50, s50, 13
    v_add_u32 v235, s50, v252
    ds_read_b64 v[228:229], v235 offset:25856
    ds_read_b64 v[230:231], v235 offset:29952
    s_waitcnt vmcnt(6)
    v_lshrrev_b32 v236, 6, v164
    v_lshrrev_b32 v238, 6, v166
    v_and_b32 v236, 0x3ffc, v236
    v_and_b32 v238, 0x3ffc, v238
    ds_add_rtn_u32 v236, v236, v250 offset:0
    ds_add_rtn_u32 v238, v238, v250 offset:0
    s_waitcnt lgkmcnt(10)
    v_lshl_or_b32 v163, v161, 16, v247
    v_and_or_b32 v161, v161, s55, v246
    s_mul_i32 s59, s71, 3
    s_set_gpr_idx_on s59, gpr_idx(DST)
    s_waitcnt lgkmcnt(8)
    v_mov_b32 v2, v216
    v_mov_b32 v3, v218
    v_perm_b32 v4, v219, v217, s73
    s_waitcnt lgkmcnt(6)
    v_mov_b32 v5, v220
    v_mov_b32 v6, v222
    v_perm_b32 v7, v223, v221, s73
    s_waitcnt lgkmcnt(4)
    v_mov_b32 v8, v224
    v_mov_b32 v9, v226
    v_perm_b32 v10, v227, v225, s73
    s_waitcnt lgkmcnt(2)
    v_mov_b32 v11, v228
    v_mov_b32 v12, v230
    v_perm_b32 v13, v231, v229, s73
    s_set_gpr_idx_off
    s_add_u32 s71, s71, 4
    s_cmp_ge_u32 s71, s72
    s_cbranch_scc1 Lrd2
Lrl2:
    s_add_u32 s50, s71, 0
    s_and_b32 s50, s50, 15
    s_lshl_b32 s50, s50, 13
    v_add_u32 v232, s50, v252
    ds_read_b64 v[216:217], v232 offset:25856
    ds_read_b64 v[218:219], v232 offset:29952
    s_add_u32 s50, s71, 1
    s_and_b32 s50, s50, 15
    s_lshl_b32 s50, s50, 13
    v_add_u32 v233, s50, v252
    ds_read_b64 v[220:221], v233 offset:25856
    ds_read_b64 v[222:223], v233 offset:29952
    s_add_u32 s50, s71, 2
    s_and_b32 s50, s50, 15
    s_lshl_b32 s50, s50, 13
    v_add_u32 v234, s50, v252
    ds_read_b64 v[224:225], v234 offset:25856
    ds_read_b64 v[226:227], v234 offset:29952
    s_add_u32 s50, s71, 3
    s_and_b32 s50, s50, 15
    s_lshl_b32 s50, s50, 13
    v_add_u32 v235, s50, v252
    ds_read_b64 v[228:229], v235 offset:25856
    ds_read_b64 v[230:231], v235 offset:29952
    s_mul_i32 s59, s71, 3
    s_set_gpr_idx_on s59, gpr_idx(DST)
    s_waitcnt lgkmcnt(6)
    v_mov_b32 v2, v216
    v_mov_b32 v3, v218
    v_perm_b32 v4, v219, v217, s73
    s_waitcnt lgkmcnt(4)
    v_mov_b32 v5, v220
    v_mov_b32 v6, v222
    v_perm_b32 v7, v223, v221, s73
    s_waitcnt lgkmcnt(2)
    v_mov_b32 v8, v224
    v_mov_b32 v9, v226
    v_perm_b32 v10, v227, v225, s73
    s_waitcnt lgkmcnt(0)
    v_mov_b32 v11, v228
    v_mov_b32 v12, v230
    v_perm_b32 v13, v231, v229, s73
    s_set_gpr_idx_off
    s_add_u32 s71, s71, 4
    s_cmp_lt_u32 s71, s72
    s_cbranch_scc1 Lrl2
Lrd2:
    s_mov_b32 s71, s72
    s_waitcnt vmcnt(5)
    v_lshrrev_b32 v246, 6, v168
    v_lshrrev_b32 v247, 6, v170
    v_and_b32 v246, 0x3ffc, v246
    v_and_b32 v247, 0x3ffc, v247
    ds_add_rtn_u32 v246, v246, v250 offset:0
    ds_add_rtn_u32 v247, v247, v250 offset:0
    s_waitcnt lgkmcnt(2)
    v_lshl_or_b32 v167, v165, 16, v238
    v_and_or_b32 v165, v165, s55, v236
    v_lshrrev_b32 v240, 6, v96
    v_lshrrev_b32 v241, 6, v98
    v_and_b32 v240, 0x3ffc, v240
    v_and_b32 v241, 0x3ffc, v241
    ds_read_b32 v240, v240 offset:0
    ds_read_b32 v241, v241 offset:0
    s_barrier
    v_readlane_b32 s74, v248, 52
    v_readlane_b32 s75, v248, 53
    s_bcnt1_i32_b64 s50, s[74:75]
    v_mbcnt_lo_u32_b32 v245, s74, 0
    v_mbcnt_hi_u32_b32 v245, s75, v245
    v_lshl_add_u32 v245, v245, 2, s70
    s_lshl2_add_u32 s70, s50, s70
    ds_read_b32 v245, v245 offset:13616
    v_lshrrev_b32 v242, 6, v100
    v_lshrrev_b32 v243, 6, v102
    v_and_b32 v242, 0x3ffc, v242
    v_and_b32 v243, 0x3ffc, v243
    ds_read_b32 v242, v242 offset:0
    ds_read_b32 v243, v243 offset:0
    s_waitcnt lgkmcnt(3)
    v_add_u32 v240, v240, v97
    v_add_u32 v241, v241, v99
    v_lshlrev_b32_sdwa v240, 1, v240 dst_sel:DWORD dst_unused:UNUSED_PAD src0_sel:DWORD src1_sel:WORD_0
    ds_write_b64 v240, v[96:97] offset:25856
    v_lshlrev_b32_sdwa v241, 1, v241 dst_sel:DWORD dst_unused:UNUSED_PAD src0_sel:DWORD src1_sel:WORD_0
    ds_write_b64 v241, v[98:99] offset:25856
    s_movk_i32 s51, 6912
    s_waitcnt lgkmcnt(15)
    v_add_u32 v244, v244, v251
    buffer_load_dwordx3 v[192:194], v244, s[24:27], s51 offen
    s_waitcnt vmcnt(5)
    v_lshrrev_b32 v236, 6, v172
    v_lshrrev_b32 v238, 6, v174
    v_and_b32 v236, 0x3ffc, v236
    v_and_b32 v238, 0x3ffc, v238
    ds_add_rtn_u32 v236, v236, v250 offset:0
    ds_add_rtn_u32 v238, v238, v250 offset:0
    s_waitcnt lgkmcnt(9)
    v_lshl_or_b32 v171, v169, 16, v247
    v_and_or_b32 v169, v169, s55, v246
    v_readlane_b32 s74, v248, 54
    v_readlane_b32 s75, v248, 55
    s_bcnt1_i32_b64 s50, s[74:75]
    v_mbcnt_lo_u32_b32 v244, s74, 0
    v_mbcnt_hi_u32_b32 v244, s75, v244
    v_lshl_add_u32 v244, v244, 2, s70
    s_lshl2_add_u32 s70, s50, s70
    ds_read_b32 v244, v244 offset:13616
    v_lshrrev_b32 v240, 6, v104
    v_lshrrev_b32 v241, 6, v106
    v_and_b32 v240, 0x3ffc, v240
    v_and_b32 v241, 0x3ffc, v241
    ds_read_b32 v240, v240 offset:0
    ds_read_b32 v241, v241 offset:0
    s_waitcnt lgkmcnt(7)
    v_add_u32 v242, v242, v101
    v_add_u32 v243, v243, v103
    v_lshlrev_b32_sdwa v242, 1, v242 dst_sel:DWORD dst_unused:UNUSED_PAD src0_sel:DWORD src1_sel:WORD_0
    ds_write_b64 v242, v[100:101] offset:25856
    v_lshlrev_b32_sdwa v243, 1, v243 dst_sel:DWORD dst_unused:UNUSED_PAD src0_sel:DWORD src1_sel:WORD_0
    ds_write_b64 v243, v[102:103] offset:25856
    s_movk_i32 s51, 7680
    s_waitcnt lgkmcnt(11)
    v_add_u32 v245, v245, v251
    buffer_load_dwordx3 v[196:198], v245, s[24:27], s51 offen
    s_waitcnt vmcnt(5)
    v_lshrrev_b32 v246, 6, v176
    v_lshrrev_b32 v247, 6, v178
    v_and_b32 v246, 0x3ffc, v246
    v_and_b32 v247, 0x3ffc, v247
    ds_add_rtn_u32 v246, v246, v250 offset:0
    ds_add_rtn_u32 v247, v247, v250 offset:0
    s_waitcnt lgkmcnt(7)
    v_lshl_or_b32 v175, v173, 16, v238
    v_and_or_b32 v173, v173, s55, v236
    v_readlane_b32 s74, v248, 56
    v_readlane_b32 s75, v248, 57
    s_bcnt1_i32_b64 s50, s[74:75]
    v_mbcnt_lo_u32_b32 v245, s74, 0
    v_mbcnt_hi_u32_b32 v245, s75, v245
    v_lshl_add_u32 v245, v245, 2, s70
    s_lshl2_add_u32 s70, s50, s70
    ds_read_b32 v245, v245 offset:13616
    v_lshrrev_b32 v242, 6, v108
    v_lshrrev_b32 v243, 6, v110
    v_and_b32 v242, 0x3ffc, v242
    v_and_b32 v243, 0x3ffc, v243
    ds_read_b32 v242, v242 offset:0
    ds_read_b32 v243, v243 offset:0
    s_waitcnt lgkmcnt(7)
    v_add_u32 v240, v240, v105
    v_add_u32 v241, v241, v107
    v_lshlrev_b32_sdwa v240, 1, v240 dst_sel:DWORD dst_unused:UNUSED_PAD src0_sel:DWORD src1_sel:WORD_0
    ds_write_b64 v240, v[104:105] offset:25856
    v_lshlrev_b32_sdwa v241, 1, v241 dst_sel:DWORD dst_unused:UNUSED_PAD src0_sel:DWORD src1_sel:WORD_0
    ds_write_b64 v241, v[106:107] offset:25856
    s_movk_i32 s51, 8448
    s_waitcnt lgkmcnt(11)
    v_add_u32 v244, v244, v251
    buffer_load_dwordx3 v[200:202], v244, s[24:27], s51 offen
    s_waitcnt vmcnt(5)
    v_lshrrev_b32 v236, 6, v180
    v_lshrrev_b32 v238, 6, v182
    v_and_b32 v236, 0x3ffc, v236
    v_and_b32 v238, 0x3ffc, v238
    ds_add_rtn_u32 v236, v236, v250 offset:0
    ds_add_rtn_u32 v238, v238, v250 offset:0
    s_waitcnt lgkmcnt(7)
    v_lshl_or_b32 v179, v177, 16, v247
    v_and_or_b32 v177, v177, s55, v246
    v_lshrrev_b32 v240, 6, v112
    v_lshrrev_b32 v241, 6, v114
    v_and_b32 v240, 0x3ffc, v240
    v_and_b32 v241, 0x3ffc, v241
    ds_read_b32 v240, v240 offset:0
    ds_read_b32 v241, v241 offset:0
    s_waitcnt lgkmcnt(6)
    v_add_u32 v242, v242, v109
    v_add_u32 v243, v243, v111
    v_lshlrev_b32_sdwa v242, 1, v242 dst_sel:DWORD dst_unused:UNUSED_PAD src0_sel:DWORD src1_sel:WORD_0
    ds_write_b64 v242, v[108:109] offset:25856
    v_lshlrev_b32_sdwa v243, 1, v243 dst_sel:DWORD dst_unused:UNUSED_PAD src0_sel:DWORD src1_sel:WORD_0
    ds_write_b64 v243, v[110:111] offset:25856
    s_movk_i32 s51, 9216
    s_waitcnt lgkmcnt(10)
    v_add_u32 v245, v245, v251
    buffer_load_dwordx3 v[204:206], v245, s[24:27], s51 offen
    s_cmp_le_u32 s83, 832
    s_cbranch_scc1 Lg8
    v_readlane_b32 s74, v248, 58
    v_readlane_b32 s75, v248, 59
    s_bcnt1_i32_b64 s50, s[74:75]
    v_mbcnt_lo_u32_b32 v244, s74, 0
    v_mbcnt_hi_u32_b32 v244, s75, v244
    v_lshl_add_u32 v244, v244, 2, s70
    s_lshl2_add_u32 s70, s50, s70
    ds_read_b32 v244, v244 offset:13616
    s_movk_i32 s51, 9984
    s_waitcnt lgkmcnt(0)
    v_add_u32 v244, v244, v251
    buffer_load_dwordx3 v[208:210], v244, s[24:27], s51 offen
    s_cmp_le_u32 s83, 896
    s_cbranch_scc1 Lg8
    v_readlane_b32 s74, v248, 60
    v_readlane_b32 s75, v248, 61
    s_bcnt1_i32_b64 s50, s[74:75]
    v_mbcnt_lo_u32_b32 v245, s74, 0
    v_mbcnt_hi_u32_b32 v245, s75, v245
    v_lshl_add_u32 v245, v245, 2, s70
    s_lshl2_add_u32 s70, s50, s70
    ds_read_b32 v245, v245 offset:13616
    s_movk_i32 s51, 10752
    s_waitcnt lgkmcnt(0)
    v_add_u32 v245, v245, v251
    buffer_load_dwordx3 v[212:214], v245, s[24:27], s51 offen
Lg8:
    s_nop 3
    s_waitcnt vmcnt(5)
    v_lshrrev_b32 v246, 6, v184
    v_lshrrev_b32 v247, 6, v186
    v_and_b32 v246, 0x3ffc, v246
    v_and_b32 v247, 0x3ffc, v247
    ds_add_rtn_u32 v246, v246, v250 offset:0
    ds_add_rtn_u32 v247, v247, v250 offset:0
    s_waitcnt lgkmcnt(6)
    v_lshl_or_b32 v183, v181, 16, v238
    v_and_or_b32 v181, v181, s55, v236
    v_lshrrev_b32 v242, 6, v116
    v_lshrrev_b32 v243, 6, v118
    v_and_b32 v242, 0x3ffc, v242
    v_and_b32 v243, 0x3ffc, v243
    ds_read_b32 v242, v242 offset:0
    ds_read_b32 v243, v243 offset:0
    s_waitcnt lgkmcnt(6)
    v_add_u32 v240, v240, v113
    v_add_u32 v241, v241, v115
    v_lshlrev_b32_sdwa v240, 1, v240 dst_sel:DWORD dst_unused:UNUSED_PAD src0_sel:DWORD src1_sel:WORD_0
    ds_write_b64 v240, v[112:113] offset:25856
    v_lshlrev_b32_sdwa v241, 1, v241 dst_sel:DWORD dst_unused:UNUSED_PAD src0_sel:DWORD src1_sel:WORD_0
    ds_write_b64 v241, v[114:115] offset:25856
    s_waitcnt vmcnt(4)
    v_lshrrev_b32 v236, 6, v188
    v_lshrrev_b32 v238, 6, v190
    v_and_b32 v236, 0x3ffc, v236
    v_and_b32 v238, 0x3ffc, v238
    ds_add_rtn_u32 v236, v236, v250 offset:0
    ds_add_rtn_u32 v238, v238, v250 offset:0
    s_waitcnt lgkmcnt(6)
    v_lshl_or_b32 v187, v185, 16, v247
    v_and_or_b32 v185, v185, s55, v246
    v_lshrrev_b32 v240, 6, v120
    v_lshrrev_b32 v241, 6, v122
    v_and_b32 v240, 0x3ffc, v240
    v_and_b32 v241, 0x3ffc, v241
    ds_read_b32 v240, v240 offset:0
    ds_read_b32 v241, v241 offset:0
    s_waitcnt lgkmcnt(6)
    v_add_u32 v242, v242, v117
    v_add_u32 v243, v243, v119
    v_lshlrev_b32_sdwa v242, 1, v242 dst_sel:DWORD dst_unused:UNUSED_PAD src0_sel:DWORD src1_sel:WORD_0
    ds_write_b64 v242, v[116:117] offset:25856
    v_lshlrev_b32_sdwa v243, 1, v243 dst_sel:DWORD dst_unused:UNUSED_PAD src0_sel:DWORD src1_sel:WORD_0
    ds_write_b64 v243, v[118:119] offset:25856
    s_waitcnt vmcnt(3)
    v_lshrrev_b32 v246, 6, v192
    v_lshrrev_b32 v247, 6, v194
    v_and_b32 v246, 0x3ffc, v246
    v_and_b32 v247, 0x3ffc, v247
    ds_add_rtn_u32 v246, v246, v250 offset:0
    ds_add_rtn_u32 v247, v247, v250 offset:0
    s_waitcnt lgkmcnt(6)
    v_lshl_or_b32 v191, v189, 16, v238
    v_and_or_b32 v189, v189, s55, v236
    v_lshrrev_b32 v242, 6, v124
    v_lshrrev_b32 v243, 6, v126
    v_and_b32 v242, 0x3ffc, v242
    v_and_b32 v243, 0x3ffc, v243
    ds_read_b32 v242, v242 offset:0
    ds_read_b32 v243, v243 offset:0
    s_waitcnt lgkmcnt(6)
    v_add_u32 v240, v240, v121
    v_add_u32 v241, v241, v123
    v_lshlrev_b32_sdwa v240, 1, v240 dst_sel:DWORD dst_unused:UNUSED_PAD src0_sel:DWORD src1_sel:WORD_0
    ds_write_b64 v240, v[120:121] offset:25856
    v_lshlrev_b32_sdwa v241, 1, v241 dst_sel:DWORD dst_unused:UNUSED_PAD src0_sel:DWORD src1_sel:WORD_0
    ds_write_b64 v241, v[122:123] offset:25856
    s_waitcnt vmcnt(2)
    v_lshrrev_b32 v236, 6, v196
    v_lshrrev_b32 v238, 6, v198
    v_and_b32 v236, 0x3ffc, v236
    v_and_b32 v238, 0x3ffc, v238
    v_cmpx_gt_i32 vcc, 0, v197
    ds_add_rtn_u32 v236, v236, v250 offset:0
    ds_add_rtn_u32 v238, v238, v250 offset:0
    s_mov_b64 exec, -1
    s_waitcnt lgkmcnt(6)
    v_lshl_or_b32 v195, v193, 16, v247
    v_and_or_b32 v193, v193, s55, v246
    v_lshrrev_b32 v240, 6, v128
    v_lshrrev_b32 v241, 6, v130
    v_and_b32 v240, 0x3ffc, v240
    v_and_b32 v241, 0x3ffc, v241
    ds_read_b32 v240, v240 offset:0
    ds_read_b32 v241, v241 offset:0
    s_waitcnt lgkmcnt(6)
    v_add_u32 v242, v242, v125
    v_add_u32 v243, v243, v127
    v_lshlrev_b32_sdwa v242, 1, v242 dst_sel:DWORD dst_unused:UNUSED_PAD src0_sel:DWORD src1_sel:WORD_0
    ds_write_b64 v242, v[124:125] offset:25856
    v_lshlrev_b32_sdwa v243, 1, v243 dst_sel:DWORD dst_unused:UNUSED_PAD src0_sel:DWORD src1_sel:WORD_0
    ds_write_b64 v243, v[126:127] offset:25856
    s_waitcnt vmcnt(1)
    v_lshrrev_b32 v246, 6, v200
    v_lshrrev_b32 v247, 6, v202
    v_and_b32 v246, 0x3ffc, v246
    v_and_b32 v247, 0x3ffc, v247
    v_cmpx_gt_i32 vcc, 0, v201
    ds_add_rtn_u32 v246, v246, v250 offset:0
    ds_add_rtn_u32 v247, v247, v250 offset:0
    s_mov_b64 exec, -1
    s_waitcnt lgkmcnt(6)
    v_lshl_or_b32 v199, v197, 16, v238
    v_and_or_b32 v197, v197, s55, v236
    v_lshrrev_b32 v242, 6, v132
    v_lshrrev_b32 v243, 6, v134
    v_and_b32 v242, 0x3ffc, v242
    v_and_b32 v243, 0x3ffc, v243
    ds_read_b32 v242, v242 offset:0
    ds_read_b32 v243, v243 offset:0
    s_waitcnt lgkmcnt(6)
    v_add_u32 v240, v240, v129
    v_add_u32 v241, v241, v131
    v_lshlrev_b32_sdwa v240, 1, v240 dst_sel:DWORD dst_unused:UNUSED_PAD src0_sel:DWORD src1_sel:WORD_0
    ds_write_b64 v240, v[128:129] offset:25856
    v_lshlrev_b32_sdwa v241, 1, v241 dst_sel:DWORD dst_unused:UNUSED_PAD src0_sel:DWORD src1_sel:WORD_0
    ds_write_b64 v241, v[130:131] offset:25856
    s_waitcnt vmcnt(0)
    v_lshrrev_b32 v236, 6, v204
    v_lshrrev_b32 v238, 6, v206
    v_and_b32 v236, 0x3ffc, v236
    v_and_b32 v238, 0x3ffc, v238
    v_cmpx_gt_i32 vcc, 0, v205
    ds_add_rtn_u32 v236, v236, v250 offset:0
    ds_add_rtn_u32 v238, v238, v250 offset:0
    s_mov_b64 exec, -1
    s_waitcnt lgkmcnt(6)
    v_lshl_or_b32 v203, v201, 16, v247
    v_and_or_b32 v201, v201, s55, v246
    s_waitcnt lgkmcnt(0)
    v_lshl_or_b32 v207, v205, 16, v238
    v_and_or_b32 v205, v205, s55, v236
    s_cmp_le_u32 s83, 832
    s_cbranch_scc1 Lg9
    s_waitcnt vmcnt(0)
    v_lshrrev_b32 v246, 6, v208
    v_lshrrev_b32 v247, 6, v210
    v_and_b32 v246, 0x3ffc, v246
    v_and_b32 v247, 0x3ffc, v247
    v_cmpx_gt_i32 vcc, 0, v209
    ds_add_rtn_u32 v246, v246, v250 offset:0
    ds_add_rtn_u32 v247, v247, v250 offset:0
    s_mov_b64 exec, -1
    s_waitcnt lgkmcnt(0)
    v_lshl_or_b32 v211, v209, 16, v247
    v_and_or_b32 v209, v209, s55, v246
    s_cmp_le_u32 s83, 896
    s_cbranch_scc1 Lg9
    s_waitcnt vmcnt(0)
    v_lshrrev_b32 v236, 6, v212
    v_lshrrev_b32 v238, 6, v214
    v_and_b32 v236, 0x3ffc, v236
    v_and_b32 v238, 0x3ffc, v238
    v_cmpx_gt_i32 vcc, 0, v213
    ds_add_rtn_u32 v236, v236, v250 offset:0
    ds_add_rtn_u32 v238, v238, v250 offset:0
    s_mov_b64 exec, -1
    s_waitcnt lgkmcnt(0)
    v_lshl_or_b32 v215, v213, 16, v238
    v_and_or_b32 v213, v213, s55, v236
Lg9:
    s_nop 3
    v_lshlrev_b32 v234, 1, v0
    s_movk_i32 s50, 0
    buffer_load_ushort v244, v234, s[28:31], s50 offen
    s_movk_i32 s50, 1024
    buffer_load_ushort v245, v234, s[28:31], s50 offen
    s_movk_i32 s50, 2048
    buffer_load_ushort v248, v234, s[28:31], s50 offen
    s_movk_i32 s50, 3072
    buffer_load_ushort v251, v234, s[28:31], s50 offen
    s_movk_i32 s50, 4096
    buffer_load_ushort v246, v234, s[28:31], s50 offen
    s_movk_i32 s50, 5120
    buffer_load_ushort v247, v234, s[28:31], s50 offen
    s_movk_i32 s50, 6144
    buffer_load_ushort v250, v234, s[28:31], s50 offen
    v_lshrrev_b32 v240, 6, v136
    v_lshrrev_b32 v241, 6, v138
    v_and_b32 v240, 0x3ffc, v240
    v_and_b32 v241, 0x3ffc, v241
    ds_read_b32 v240, v240 offset:0
    ds_read_b32 v241, v241 offset:0
    s_waitcnt lgkmcnt(6)
    v_add_u32 v242, v242, v133
    v_add_u32 v243, v243, v135
    v_lshlrev_b32_sdwa v242, 1, v242 dst_sel:DWORD dst_unused:UNUSED_PAD src0_sel:DWORD src1_sel:WORD_0
    ds_write_b64 v242, v[132:133] offset:25856
    v_lshlrev_b32_sdwa v243, 1, v243 dst_sel:DWORD dst_unused:UNUSED_PAD src0_sel:DWORD src1_sel:WORD_0
    ds_write_b64 v243, v[134:135] offset:25856
    s_waitcnt lgkmcnt(4)
    s_barrier
    s_cmp_lg_u32 s48, 3
    s_cbranch_scc1 Lks3
    v_lshlrev_b32 v232, 6, v1
    ds_read_b128 v[216:219], v232 offset:9408
    ds_read_b128 v[220:223], v232 offset:9424
    ds_read_b128 v[224:227], v232 offset:9440
    ds_read_b128 v[228:231], v232 offset:9456
    s_waitcnt lgkmcnt(0)
    v_add_u32 v217, v217, v216
    v_add_u32 v218, v218, v217
    v_add_u32 v219, v219, v218
    v_add_u32 v220, v220, v219
    v_add_u32 v221, v221, v220
    v_add_u32 v222, v222, v221
    v_add_u32 v223, v223, v222
    v_add_u32 v224, v224, v223
    v_add_u32 v225, v225, v224
    v_add_u32 v226, v226, v225
    v_add_u32 v227, v227, v226
    v_add_u32 v228, v228, v227
    v_add_u32 v229, v229, v228
    v_add_u32 v230, v230, v229
    v_add_u32 v231, v231, v230
    v_mov_b32 v233, v231
    s_nop 1
    v_add_u32_dpp v233, v233, v233 row_shr:1 row_mask:0xf bank_mask:0xf
    s_nop 1
    v_add_u32_dpp v233, v233, v233 row_shr:2 row_mask:0xf bank_mask:0xf
    s_nop 1
    v_add_u32_dpp v233, v233, v233 row_shr:4 row_mask:0xf bank_mask:0xf
    s_nop 1
    v_add_u32_dpp v233, v233, v233 row_shr:8 row_mask:0xf bank_mask:0xf
    s_nop 1
    v_add_u32_dpp v233, v233, v233 row_bcast:15 row_mask:0xa bank_mask:0xf
    s_nop 1
    v_add_u32_dpp v233, v233, v233 row_bcast:31 row_mask:0xc bank_mask:0xf
    v_sub_u32 v233, v233, v231
    v_lshl_add_u32 v233, s67, 2, v233
    v_cmpx_gt_u32 vcc, 49, v1
    v_add_u32 v231, v230, v233
    v_add_u32 v230, v229, v233
    v_add_u32 v229, v228, v233
    v_add_u32 v228, v227, v233
    ds_write_b128 v232, v[228:231] offset:9456
    v_add_u32 v227, v226, v233
    v_add_u32 v226, v225, v233
    v_add_u32 v225, v224, v233
    v_add_u32 v224, v223, v233
    ds_write_b128 v232, v[224:227] offset:9440
    v_add_u32 v223, v222, v233
    v_add_u32 v222, v221, v233
    v_add_u32 v221, v220, v233
    v_add_u32 v220, v219, v233
    ds_write_b128 v232, v[220:223] offset:9424
    v_add_u32 v219, v218, v233
    v_add_u32 v218, v217, v233
    v_add_u32 v217, v216, v233
    v_mov_b32 v216, v233
    ds_write_b128 v232, v[216:219] offset:9408
    s_lshl_b32 s50, s68, 2
    v_mov_b32 v233, s50
    v_lshlrev_b32 v232, 2, v1
    s_mov_b64 exec, 0xffff
    ds_write_b32 v232, v233 offset:12736
    s_mov_b64 exec, -1
Lks3:
    s_nop 1
    v_lshrrev_b32 v242, 6, v140
    v_lshrrev_b32 v243, 6, v142
    v_and_b32 v242, 0x3ffc, v242
    v_and_b32 v243, 0x3ffc, v243
    ds_read_b32 v242, v242 offset:0
    ds_read_b32 v243, v243 offset:0
    v_cmpx_gt_i32 vcc, 0, v137
    s_waitcnt lgkmcnt(4)
    v_add_u32 v240, v240, v137
    v_add_u32 v241, v241, v139
    v_lshlrev_b32_sdwa v240, 1, v240 dst_sel:DWORD dst_unused:UNUSED_PAD src0_sel:DWORD src1_sel:WORD_0
    ds_write_b64 v240, v[136:137] offset:25856
    v_lshlrev_b32_sdwa v241, 1, v241 dst_sel:DWORD dst_unused:UNUSED_PAD src0_sel:DWORD src1_sel:WORD_0
    ds_write_b64 v241, v[138:139] offset:25856
    s_mov_b64 exec, -1
    s_mov_b32 s50, 0
    buffer_load_dword v253, v254, s[20:23], s50 offen
    v_lshrrev_b32 v240, 6, v144
    v_lshrrev_b32 v241, 6, v146
    v_and_b32 v240, 0x3ffc, v240
    v_and_b32 v241, 0x3ffc, v241
    ds_read_b32 v240, v240 offset:0
    ds_read_b32 v241, v241 offset:0
    v_cmpx_gt_i32 vcc, 0, v141
    s_waitcnt lgkmcnt(4)
    v_add_u32 v242, v242, v141
    v_add_u32 v243, v243, v143
    v_lshlrev_b32_sdwa v242, 1, v242 dst_sel:DWORD dst_unused:UNUSED_PAD src0_sel:DWORD src1_sel:WORD_0
    ds_write_b64 v242, v[140:141] offset:25856
    v_lshlrev_b32_sdwa v243, 1, v243 dst_sel:DWORD dst_unused:UNUSED_PAD src0_sel:DWORD src1_sel:WORD_0
    ds_write_b64 v243, v[142:143] offset:25856
    s_mov_b64 exec, -1
    v_cmpx_gt_i32 vcc, 0, v145
    s_waitcnt lgkmcnt(2)
    v_add_u32 v240, v240, v145
    v_add_u32 v241, v241, v147
    v_lshlrev_b32_sdwa v240, 1, v240 dst_sel:DWORD dst_unused:UNUSED_PAD src0_sel:DWORD src1_sel:WORD_0
    ds_write_b64 v240, v[144:145] offset:25856
    v_lshlrev_b32_sdwa v241, 1, v241 dst_sel:DWORD dst_unused:UNUSED_PAD src0_sel:DWORD src1_sel:WORD_0
    ds_write_b64 v241, v[146:147] offset:25856
    s_mov_b64 exec, -1
    s_cmp_le_u32 s82, 832
    s_cbranch_scc1 Lg10
    v_lshrrev_b32 v242, 6, v148
    v_lshrrev_b32 v243, 6, v150
    v_and_b32 v242, 0x3ffc, v242
    v_and_b32 v243, 0x3ffc, v243
    ds_read_b32 v242, v242 offset:0
    ds_read_b32 v243, v243 offset:0
    v_cmpx_gt_i32 vcc, 0, v149
    s_waitcnt lgkmcnt(0)
    v_add_u32 v242, v242, v149
    v_add_u32 v243, v243, v151
    v_lshlrev_b32_sdwa v242, 1, v242 dst_sel:DWORD dst_unused:UNUSED_PAD src0_sel:DWORD src1_sel:WORD_0
    ds_write_b64 v242, v[148:149] offset:25856
    v_lshlrev_b32_sdwa v243, 1, v243 dst_sel:DWORD dst_unused:UNUSED_PAD src0_sel:DWORD src1_sel:WORD_0
    ds_write_b64 v243, v[150:151] offset:25856
    s_mov_b64 exec, -1
    s_cmp_le_u32 s82, 896
    s_cbranch_scc1 Lg10
    v_lshrrev_b32 v240, 6, v152
    v_lshrrev_b32 v241, 6, v154
    v_and_b32 v240, 0x3ffc, v240
    v_and_b32 v241, 0x3ffc, v241
    ds_read_b32 v240, v240 offset:0
    ds_read_b32 v241, v241 offset:0
    v_cmpx_gt_i32 vcc, 0, v153
    s_waitcnt lgkmcnt(0)
    v_add_u32 v240, v240, v153
    v_add_u32 v241, v241, v155
    v_lshlrev_b32_sdwa v240, 1, v240 dst_sel:DWORD dst_unused:UNUSED_PAD src0_sel:DWORD src1_sel:WORD_0
    ds_write_b64 v240, v[152:153] offset:25856
    v_lshlrev_b32_sdwa v241, 1, v241 dst_sel:DWORD dst_unused:UNUSED_PAD src0_sel:DWORD src1_sel:WORD_0
    ds_write_b64 v241, v[154:155] offset:25856
    s_mov_b64 exec, -1
Lg10:
    s_nop 3
    s_waitcnt lgkmcnt(0)
    s_barrier
    s_lshr_b32 s72, s67, 10
    s_add_u32 s50, s71, 0
    s_and_b32 s50, s50, 15
    s_lshl_b32 s50, s50, 13
    v_add_u32 v232, s50, v252
    ds_read_b64 v[216:217], v232 offset:25856
    ds_read_b64 v[218:219], v232 offset:29952
    s_add_u32 s50, s71, 1
    s_and_b32 s50, s50, 15
    s_lshl_b32 s50, s50, 13
    v_add_u32 v233, s50, v252
    ds_read_b64 v[220:221], v233 offset:25856
    ds_read_b64 v[222:223], v233 offset:29952
    s_add_u32 s50, s71, 2
    s_and_b32 s50, s50, 15
    s_lshl_b32 s50, s50, 13
    v_add_u32 v234, s50, v252
    ds_read_b64 v[224:225], v234 offset:25856
    ds_read_b64 v[226:227], v234 offset:29952
    s_add_u32 s50, s71, 3
    s_and_b32 s50, s50, 15
    s_lshl_b32 s50, s50, 13
    v_add_u32 v235, s50, v252
    ds_read_b64 v[228:229], v235 offset:25856
    ds_read_b64 v[230:231], v235 offset:29952
    s_mul_i32 s59, s71, 3
    s_set_gpr_idx_on s59, gpr_idx(DST)
    s_waitcnt lgkmcnt(6)
    v_mov_b32 v2, v216
    v_mov_b32 v3, v218
    v_perm_b32 v4, v219, v217, s73
    s_waitcnt lgkmcnt(4)
    v_mov_b32 v5, v220
    v_mov_b32 v6, v222
    v_perm_b32 v7, v223, v221, s73
    s_waitcnt lgkmcnt(2)
    v_mov_b32 v8, v224
    v_mov_b32 v9, v226
    v_perm_b32 v10, v227, v225, s73
    s_waitcnt lgkmcnt(0)
    v_mov_b32 v11, v228
    v_mov_b32 v12, v230
    v_perm_b32 v13, v231, v229, s73
    s_set_gpr_idx_off
    s_add_u32 s71, s71, 4
    s_add_u32 s50, s71, 0
    s_and_b32 s50, s50, 15
    s_lshl_b32 s50, s50, 13
    v_add_u32 v232, s50, v252
    ds_read_b64 v[216:217], v232 offset:25856
    ds_read_b64 v[218:219], v232 offset:29952
    s_add_u32 s50, s71, 1
    s_and_b32 s50, s50, 15
    s_lshl_b32 s50, s50, 13
    v_add_u32 v233, s50, v252
    ds_read_b64 v[220:221], v233 offset:25856
    ds_read_b64 v[222:223], v233 offset:29952
    s_add_u32 s50, s71, 2
    s_and_b32 s50, s50, 15
    s_lshl_b32 s50, s50, 13
    v_add_u32 v234, s50, v252
    ds_read_b64 v[224:225], v234 offset:25856
    ds_read_b64 v[226:227], v234 offset:29952
    s_add_u32 s50, s71, 3
    s_and_b32 s50, s50, 15
    s_lshl_b32 s50, s50, 13
    v_add_u32 v235, s50, v252
    ds_read_b64 v[228:229], v235 offset:25856
    ds_read_b64 v[230:231], v235 offset:29952
    s_mul_i32 s59, s71, 3
    s_set_gpr_idx_on s59, gpr_idx(DST)
    s_waitcnt lgkmcnt(6)
    v_mov_b32 v2, v216
    v_mov_b32 v3, v218
    v_perm_b32 v4, v219, v217, s73
    s_waitcnt lgkmcnt(4)
    v_mov_b32 v5, v220
    v_mov_b32 v6, v222
    v_perm_b32 v7, v223, v221, s73
    s_waitcnt lgkmcnt(2)
    v_mov_b32 v8, v224
    v_mov_b32 v9, v226
    v_perm_b32 v10, v227, v225, s73
    s_waitcnt lgkmcnt(0)
    v_mov_b32 v11, v228
    v_mov_b32 v12, v230
    v_perm_b32 v13, v231, v229, s73
    s_set_gpr_idx_off
    s_add_u32 s71, s71, 4
    s_add_u32 s50, s71, 0
    s_and_b32 s50, s50, 15
    s_lshl_b32 s50, s50, 13
    v_add_u32 v232, s50, v252
    ds_read_b64 v[216:217], v232 offset:25856
    ds_read_b64 v[218:219], v232 offset:29952
    s_add_u32 s50, s71, 1
    s_and_b32 s50, s50, 15
    s_lshl_b32 s50, s50, 13
    v_add_u32 v233, s50, v252
    ds_read_b64 v[220:221], v233 offset:25856
    ds_read_b64 v[222:223], v233 offset:29952
    s_add_u32 s50, s71, 2
    s_and_b32 s50, s50, 15
    s_lshl_b32 s50, s50, 13
    v_add_u32 v234, s50, v252
    ds_read_b64 v[224:225], v234 offset:25856
    ds_read_b64 v[226:227], v234 offset:29952
    s_add_u32 s50, s71, 3
    s_and_b32 s50, s50, 15
    s_lshl_b32 s50, s50, 13
    v_add_u32 v235, s50, v252
    ds_read_b64 v[228:229], v235 offset:25856
    ds_read_b64 v[230:231], v235 offset:29952
    s_mul_i32 s59, s71, 3
    s_set_gpr_idx_on s59, gpr_idx(DST)
    s_waitcnt lgkmcnt(6)
    v_mov_b32 v2, v216
    v_mov_b32 v3, v218
    v_perm_b32 v4, v219, v217, s73
    s_waitcnt lgkmcnt(4)
    v_mov_b32 v5, v220
    v_mov_b32 v6, v222
    v_perm_b32 v7, v223, v221, s73
    s_waitcnt lgkmcnt(2)
    v_mov_b32 v8, v224
    v_mov_b32 v9, v226
    v_perm_b32 v10, v227, v225, s73
    s_waitcnt lgkmcnt(0)
    v_mov_b32 v11, v228
    v_mov_b32 v12, v230
    v_perm_b32 v13, v231, v229, s73
    s_set_gpr_idx_off
    s_add_u32 s71, s71, 4
    s_cmp_ge_u32 s71, s72
    s_cbranch_scc1 Lrd3
Lrl3:
    s_add_u32 s50, s71, 0
    s_and_b32 s50, s50, 15
    s_lshl_b32 s50, s50, 13
    v_add_u32 v232, s50, v252
    ds_read_b64 v[216:217], v232 offset:25856
    ds_read_b64 v[218:219], v232 offset:29952
    s_add_u32 s50, s71, 1
    s_and_b32 s50, s50, 15
    s_lshl_b32 s50, s50, 13
    v_add_u32 v233, s50, v252
    ds_read_b64 v[220:221], v233 offset:25856
    ds_read_b64 v[222:223], v233 offset:29952
    s_add_u32 s50, s71, 2
    s_and_b32 s50, s50, 15
    s_lshl_b32 s50, s50, 13
    v_add_u32 v234, s50, v252
    ds_read_b64 v[224:225], v234 offset:25856
    ds_read_b64 v[226:227], v234 offset:29952
    s_add_u32 s50, s71, 3
    s_and_b32 s50, s50, 15
    s_lshl_b32 s50, s50, 13
    v_add_u32 v235, s50, v252
    ds_read_b64 v[228:229], v235 offset:25856
    ds_read_b64 v[230:231], v235 offset:29952
    s_mul_i32 s59, s71, 3
    s_set_gpr_idx_on s59, gpr_idx(DST)
    s_waitcnt lgkmcnt(6)
    v_mov_b32 v2, v216
    v_mov_b32 v3, v218
    v_perm_b32 v4, v219, v217, s73
    s_waitcnt lgkmcnt(4)
    v_mov_b32 v5, v220
    v_mov_b32 v6, v222
    v_perm_b32 v7, v223, v221, s73
    s_waitcnt lgkmcnt(2)
    v_mov_b32 v8, v224
    v_mov_b32 v9, v226
    v_perm_b32 v10, v227, v225, s73
    s_waitcnt lgkmcnt(0)
    v_mov_b32 v11, v228
    v_mov_b32 v12, v230
    v_perm_b32 v13, v231, v229, s73
    s_set_gpr_idx_off
    s_add_u32 s71, s71, 4
    s_cmp_lt_u32 s71, s72
    s_cbranch_scc1 Lrl3
Lrd3:
    s_mov_b32 s71, s72
    v_lshrrev_b32 v242, 6, v156
    v_lshrrev_b32 v243, 6, v158
    v_and_b32 v242, 0x3ffc, v242
    v_and_b32 v243, 0x3ffc, v243
    ds_read_b32 v242, v242 offset:0
    ds_read_b32 v243, v243 offset:0
    s_barrier
    v_lshrrev_b32 v240, 6, v160
    v_lshrrev_b32 v241, 6, v162
    v_and_b32 v240, 0x3ffc, v240
    v_and_b32 v241, 0x3ffc, v241
    ds_read_b32 v240, v240 offset:0
    ds_read_b32 v241, v241 offset:0
    s_waitcnt lgkmcnt(2)
    v_add_u32 v242, v242, v157
    v_add_u32 v243, v243, v159
    v_lshlrev_b32_sdwa v242, 1, v242 dst_sel:DWORD dst_unused:UNUSED_PAD src0_sel:DWORD src1_sel:WORD_0
    ds_write_b64 v242, v[156:157] offset:25856
    v_lshlrev_b32_sdwa v243, 1, v243 dst_sel:DWORD dst_unused:UNUSED_PAD src0_sel:DWORD src1_sel:WORD_0
    ds_write_b64 v243, v[158:159] offset:25856
    v_lshrrev_b32 v242, 6, v164
    v_lshrrev_b32 v243, 6, v166
    v_and_b32 v242, 0x3ffc, v242
    v_and_b32 v243, 0x3ffc, v243
    ds_read_b32 v242, v242 offset:0
    ds_read_b32 v243, v243 offset:0
    s_waitcnt lgkmcnt(4)
    v_add_u32 v240, v240, v161
    v_add_u32 v241, v241, v163
    v_lshlrev_b32_sdwa v240, 1, v240 dst_sel:DWORD dst_unused:UNUSED_PAD src0_sel:DWORD src1_sel:WORD_0
    ds_write_b64 v240, v[160:161] offset:25856
    v_lshlrev_b32_sdwa v241, 1, v241 dst_sel:DWORD dst_unused:UNUSED_PAD src0_sel:DWORD src1_sel:WORD_0
    ds_write_b64 v241, v[162:163] offset:25856
    s_mov_b32 s50, 6553600
    buffer_load_dword v253, v254, s[20:23], s50 offen
    s_waitcnt vmcnt(2)
    v_lshlrev_b32 v224, 16, v244
    v_mul_f32 v224, s69, v224
    v_subrev_f32 v216, s40, v224
    v_subrev_f32 v217, s41, v224
    v_subrev_f32 v218, s42, v224
    v_subrev_f32 v219, s43, v224
    v_mul_f32 v216, v216, v216
    v_mul_f32 v217, v217, v217
    v_mul_f32 v218, v218, v218
    v_mul_f32 v219, v219, v219
    v_exp_f32 v216, -v216
    v_exp_f32 v217, -v217
    v_exp_f32 v218, -v218
    v_exp_f32 v219, -v219
    v_lshrrev_b32 v240, 6, v168
    v_lshrrev_b32 v241, 6, v170
    v_and_b32 v240, 0x3ffc, v240
    v_and_b32 v241, 0x3ffc, v241
    ds_read_b32 v240, v240 offset:0
    ds_read_b32 v241, v241 offset:0
    s_waitcnt lgkmcnt(4)
    v_add_u32 v242, v242, v165
    v_add_u32 v243, v243, v167
    v_lshlrev_b32_sdwa v242, 1, v242 dst_sel:DWORD dst_unused:UNUSED_PAD src0_sel:DWORD src1_sel:WORD_0
    ds_write_b64 v242, v[164:165] offset:25856
    v_lshlrev_b32_sdwa v243, 1, v243 dst_sel:DWORD dst_unused:UNUSED_PAD src0_sel:DWORD src1_sel:WORD_0
    ds_write_b64 v243, v[166:167] offset:25856
    v_subrev_f32 v220, s44, v224
    v_subrev_f32 v221, s45, v224
    v_subrev_f32 v222, s46, v224
    v_subrev_f32 v223, s47, v224
    v_mul_f32 v220, v220, v220
    v_mul_f32 v221, v221, v221
    v_mul_f32 v222, v222, v222
    v_mul_f32 v223, v223, v223
    v_exp_f32 v220, -v220
    v_exp_f32 v221, -v221
    v_exp_f32 v222, -v222
    v_exp_f32 v223, -v223
    v_cvt_pk_f16_f32 v164, v216, v217
    v_cvt_pk_f16_f32 v165, v218, v219
    v_cvt_pk_f16_f32 v166, v220, v221
    v_cvt_pk_f16_f32 v167, v222, v223
    v_lshrrev_b32 v242, 6, v172
    v_lshrrev_b32 v243, 6, v174
    v_and_b32 v242, 0x3ffc, v242
    v_and_b32 v243, 0x3ffc, v243
    ds_read_b32 v242, v242 offset:0
    ds_read_b32 v243, v243 offset:0
    s_waitcnt lgkmcnt(4)
    v_add_u32 v240, v240, v169
    v_add_u32 v241, v241, v171
    v_lshlrev_b32_sdwa v240, 1, v240 dst_sel:DWORD dst_unused:UNUSED_PAD src0_sel:DWORD src1_sel:WORD_0
    ds_write_b64 v240, v[168:169] offset:25856
    v_lshlrev_b32_sdwa v241, 1, v241 dst_sel:DWORD dst_unused:UNUSED_PAD src0_sel:DWORD src1_sel:WORD_0
    ds_write_b64 v241, v[170:171] offset:25856
    v_lshlrev_b32 v224, 16, v245
    v_mul_f32 v224, s69, v224
    v_subrev_f32 v216, s40, v224
    v_subrev_f32 v217, s41, v224
    v_subrev_f32 v218, s42, v224
    v_subrev_f32 v219, s43, v224
    v_mul_f32 v216, v216, v216
    v_mul_f32 v217, v217, v217
    v_mul_f32 v218, v218, v218
    v_mul_f32 v219, v219, v219
    v_exp_f32 v216, -v216
    v_exp_f32 v217, -v217
    v_exp_f32 v218, -v218
    v_exp_f32 v219, -v219
    v_lshrrev_b32 v240, 6, v176
    v_lshrrev_b32 v241, 6, v178
    v_and_b32 v240, 0x3ffc, v240
    v_and_b32 v241, 0x3ffc, v241
    ds_read_b32 v240, v240 offset:0
    ds_read_b32 v241, v241 offset:0
    s_waitcnt lgkmcnt(4)
    v_add_u32 v242, v242, v173
    v_add_u32 v243, v243, v175
    v_lshlrev_b32_sdwa v242, 1, v242 dst_sel:DWORD dst_unused:UNUSED_PAD src0_sel:DWORD src1_sel:WORD_0
    ds_write_b64 v242, v[172:173] offset:25856
    v_lshlrev_b32_sdwa v243, 1, v243 dst_sel:DWORD dst_unused:UNUSED_PAD src0_sel:DWORD src1_sel:WORD_0
    ds_write_b64 v243, v[174:175] offset:25856
    v_subrev_f32 v220, s44, v224
    v_subrev_f32 v221, s45, v224
    v_subrev_f32 v222, s46, v224
    v_subrev_f32 v223, s47, v224
    v_mul_f32 v220, v220, v220
    v_mul_f32 v221, v221, v221
    v_mul_f32 v222, v222, v222
    v_mul_f32 v223, v223, v223
    v_exp_f32 v220, -v220
    v_exp_f32 v221, -v221
    v_exp_f32 v222, -v222
    v_exp_f32 v223, -v223
    v_cvt_pk_f16_f32 v168, v216, v217
    v_cvt_pk_f16_f32 v169, v218, v219
    v_cvt_pk_f16_f32 v170, v220, v221
    v_cvt_pk_f16_f32 v171, v222, v223
    v_lshrrev_b32 v242, 6, v180
    v_lshrrev_b32 v243, 6, v182
    v_and_b32 v242, 0x3ffc, v242
    v_and_b32 v243, 0x3ffc, v243
    ds_read_b32 v242, v242 offset:0
    ds_read_b32 v243, v243 offset:0
    s_waitcnt lgkmcnt(4)
    v_add_u32 v240, v240, v177
    v_add_u32 v241, v241, v179
    v_lshlrev_b32_sdwa v240, 1, v240 dst_sel:DWORD dst_unused:UNUSED_PAD src0_sel:DWORD src1_sel:WORD_0
    ds_write_b64 v240, v[176:177] offset:25856
    v_lshlrev_b32_sdwa v241, 1, v241 dst_sel:DWORD dst_unused:UNUSED_PAD src0_sel:DWORD src1_sel:WORD_0
    ds_write_b64 v241, v[178:179] offset:25856
    s_mov_b32 s50, 13107200
    buffer_load_dword v253, v254, s[20:23], s50 offen
    v_lshlrev_b32 v224, 16, v248
    v_mul_f32 v224, s69, v224
    v_subrev_f32 v216, s40, v224
    v_subrev_f32 v217, s41, v224
    v_subrev_f32 v218, s42, v224
    v_subrev_f32 v219, s43, v224
    v_mul_f32 v216, v216, v216
    v_mul_f32 v217, v217, v217
    v_mul_f32 v218, v218, v218
    v_mul_f32 v219, v219, v219
    v_exp_f32 v216, -v216
    v_exp_f32 v217, -v217
    v_exp_f32 v218, -v218
    v_exp_f32 v219, -v219
    v_lshrrev_b32 v240, 6, v184
    v_lshrrev_b32 v241, 6, v186
    v_and_b32 v240, 0x3ffc, v240
    v_and_b32 v241, 0x3ffc, v241
    ds_read_b32 v240, v240 offset:0
    ds_read_b32 v241, v241 offset:0
    s_waitcnt lgkmcnt(4)
    v_add_u32 v242, v242, v181
    v_add_u32 v243, v243, v183
    v_lshlrev_b32_sdwa v242, 1, v242 dst_sel:DWORD dst_unused:UNUSED_PAD src0_sel:DWORD src1_sel:WORD_0
    ds_write_b64 v242, v[180:181] offset:25856
    v_lshlrev_b32_sdwa v243, 1, v243 dst_sel:DWORD dst_unused:UNUSED_PAD src0_sel:DWORD src1_sel:WORD_0
    ds_write_b64 v243, v[182:183] offset:25856
    v_subrev_f32 v220, s44, v224
    v_subrev_f32 v221, s45, v224
    v_subrev_f32 v222, s46, v224
    v_subrev_f32 v223, s47, v224
    v_mul_f32 v220, v220, v220
    v_mul_f32 v221, v221, v221
    v_mul_f32 v222, v222, v222
    v_mul_f32 v223, v223, v223
    v_exp_f32 v220, -v220
    v_exp_f32 v221, -v221
    v_exp_f32 v222, -v222
    v_exp_f32 v223, -v223
    v_cvt_pk_f16_f32 v172, v216, v217
    v_cvt_pk_f16_f32 v173, v218, v219
    v_cvt_pk_f16_f32 v174, v220, v221
    v_cvt_pk_f16_f32 v175, v222, v223
    v_lshrrev_b32 v242, 6, v188
    v_lshrrev_b32 v243, 6, v190
    v_and_b32 v242, 0x3ffc, v242
    v_and_b32 v243, 0x3ffc, v243
    ds_read_b32 v242, v242 offset:0
    ds_read_b32 v243, v243 offset:0
    s_waitcnt lgkmcnt(4)
    v_add_u32 v240, v240, v185
    v_add_u32 v241, v241, v187
    v_lshlrev_b32_sdwa v240, 1, v240 dst_sel:DWORD dst_unused:UNUSED_PAD src0_sel:DWORD src1_sel:WORD_0
    ds_write_b64 v240, v[184:185] offset:25856
    v_lshlrev_b32_sdwa v241, 1, v241 dst_sel:DWORD dst_unused:UNUSED_PAD src0_sel:DWORD src1_sel:WORD_0
    ds_write_b64 v241, v[186:187] offset:25856
    v_lshlrev_b32 v224, 16, v251
    v_mul_f32 v224, s69, v224
    v_subrev_f32 v216, s40, v224
    v_subrev_f32 v217, s41, v224
    v_subrev_f32 v218, s42, v224
    v_subrev_f32 v219, s43, v224
    v_mul_f32 v216, v216, v216
    v_mul_f32 v217, v217, v217
    v_mul_f32 v218, v218, v218
    v_mul_f32 v219, v219, v219
    v_exp_f32 v216, -v216
    v_exp_f32 v217, -v217
    v_exp_f32 v218, -v218
    v_exp_f32 v219, -v219
    v_lshrrev_b32 v240, 6, v192
    v_lshrrev_b32 v241, 6, v194
    v_and_b32 v240, 0x3ffc, v240
    v_and_b32 v241, 0x3ffc, v241
    ds_read_b32 v240, v240 offset:0
    ds_read_b32 v241, v241 offset:0
    s_waitcnt lgkmcnt(4)
    v_add_u32 v242, v242, v189
    v_add_u32 v243, v243, v191
    v_lshlrev_b32_sdwa v242, 1, v242 dst_sel:DWORD dst_unused:UNUSED_PAD src0_sel:DWORD src1_sel:WORD_0
    ds_write_b64 v242, v[188:189] offset:25856
    v_lshlrev_b32_sdwa v243, 1, v243 dst_sel:DWORD dst_unused:UNUSED_PAD src0_sel:DWORD src1_sel:WORD_0
    ds_write_b64 v243, v[190:191] offset:25856
    v_subrev_f32 v220, s44, v224
    v_subrev_f32 v221, s45, v224
    v_subrev_f32 v222, s46, v224
    v_subrev_f32 v223, s47, v224
    v_mul_f32 v220, v220, v220
    v_mul_f32 v221, v221, v221
    v_mul_f32 v222, v222, v222
    v_mul_f32 v223, v223, v223
    v_exp_f32 v220, -v220
    v_exp_f32 v221, -v221
    v_exp_f32 v222, -v222
    v_exp_f32 v223, -v223
    v_cvt_pk_f16_f32 v176, v216, v217
    v_cvt_pk_f16_f32 v177, v218, v219
    v_cvt_pk_f16_f32 v178, v220, v221
    v_cvt_pk_f16_f32 v179, v222, v223
    v_lshrrev_b32 v242, 6, v196
    v_lshrrev_b32 v243, 6, v198
    v_and_b32 v242, 0x3ffc, v242
    v_and_b32 v243, 0x3ffc, v243
    ds_read_b32 v242, v242 offset:0
    ds_read_b32 v243, v243 offset:0
    s_waitcnt lgkmcnt(4)
    v_add_u32 v240, v240, v193
    v_add_u32 v241, v241, v195
    v_lshlrev_b32_sdwa v240, 1, v240 dst_sel:DWORD dst_unused:UNUSED_PAD src0_sel:DWORD src1_sel:WORD_0
    ds_write_b64 v240, v[192:193] offset:25856
    v_lshlrev_b32_sdwa v241, 1, v241 dst_sel:DWORD dst_unused:UNUSED_PAD src0_sel:DWORD src1_sel:WORD_0
    ds_write_b64 v241, v[194:195] offset:25856
    s_mov_b32 s50, 19660800
    buffer_load_dword v253, v254, s[20:23], s50 offen
    v_lshlrev_b32 v224, 16, v246
    v_mul_f32 v224, s69, v224
    v_subrev_f32 v216, s40, v224
    v_subrev_f32 v217, s41, v224
    v_subrev_f32 v218, s42, v224
    v_subrev_f32 v219, s43, v224
    v_mul_f32 v216, v216, v216
    v_mul_f32 v217, v217, v217
    v_mul_f32 v218, v218, v218
    v_mul_f32 v219, v219, v219
    v_exp_f32 v216, -v216
    v_exp_f32 v217, -v217
    v_exp_f32 v218, -v218
    v_exp_f32 v219, -v219
    v_lshrrev_b32 v240, 6, v200
    v_lshrrev_b32 v241, 6, v202
    v_and_b32 v240, 0x3ffc, v240
    v_and_b32 v241, 0x3ffc, v241
    ds_read_b32 v240, v240 offset:0
    ds_read_b32 v241, v241 offset:0
    v_cmpx_gt_i32 vcc, 0, v197
    s_waitcnt lgkmcnt(4)
    v_add_u32 v242, v242, v197
    v_add_u32 v243, v243, v199
    v_lshlrev_b32_sdwa v242, 1, v242 dst_sel:DWORD dst_unused:UNUSED_PAD src0_sel:DWORD src1_sel:WORD_0
    ds_write_b64 v242, v[196:197] offset:25856
    v_lshlrev_b32_sdwa v243, 1, v243 dst_sel:DWORD dst_unused:UNUSED_PAD src0_sel:DWORD src1_sel:WORD_0
    ds_write_b64 v243, v[198:199] offset:25856
    s_mov_b64 exec, -1
    v_subrev_f32 v220, s44, v224
    v_subrev_f32 v221, s45, v224
    v_subrev_f32 v222, s46, v224
    v_subrev_f32 v223, s47, v224
    v_mul_f32 v220, v220, v220
    v_mul_f32 v221, v221, v221
    v_mul_f32 v222, v222, v222
    v_mul_f32 v223, v223, v223
    v_exp_f32 v220, -v220
    v_exp_f32 v221, -v221
    v_exp_f32 v222, -v222
    v_exp_f32 v223, -v223
    v_cvt_pk_f16_f32 v180, v216, v217
    v_cvt_pk_f16_f32 v181, v218, v219
    v_cvt_pk_f16_f32 v182, v220, v221
    v_cvt_pk_f16_f32 v183, v222, v223
    v_lshrrev_b32 v242, 6, v204
    v_lshrrev_b32 v243, 6, v206
    v_and_b32 v242, 0x3ffc, v242
    v_and_b32 v243, 0x3ffc, v243
    ds_read_b32 v242, v242 offset:0
    ds_read_b32 v243, v243 offset:0
    v_cmpx_gt_i32 vcc, 0, v201
    s_waitcnt lgkmcnt(4)
    v_add_u32 v240, v240, v201
    v_add_u32 v241, v241, v203
    v_lshlrev_b32_sdwa v240, 1, v240 dst_sel:DWORD dst_unused:UNUSED_PAD src0_sel:DWORD src1_sel:WORD_0
    ds_write_b64 v240, v[200:201] offset:25856
    v_lshlrev_b32_sdwa v241, 1, v241 dst_sel:DWORD dst_unused:UNUSED_PAD src0_sel:DWORD src1_sel:WORD_0
    ds_write_b64 v241, v[202:203] offset:25856
    s_mov_b64 exec, -1
    v_lshlrev_b32 v224, 16, v247
    v_mul_f32 v224, s69, v224
    v_subrev_f32 v216, s40, v224
    v_subrev_f32 v217, s41, v224
    v_subrev_f32 v218, s42, v224
    v_subrev_f32 v219, s43, v224
    v_mul_f32 v216, v216, v216
    v_mul_f32 v217, v217, v217
    v_mul_f32 v218, v218, v218
    v_mul_f32 v219, v219, v219
    v_exp_f32 v216, -v216
    v_exp_f32 v217, -v217
    v_exp_f32 v218, -v218
    v_exp_f32 v219, -v219
    v_cmpx_gt_i32 vcc, 0, v205
    s_waitcnt lgkmcnt(2)
    v_add_u32 v242, v242, v205
    v_add_u32 v243, v243, v207
    v_lshlrev_b32_sdwa v242, 1, v242 dst_sel:DWORD dst_unused:UNUSED_PAD src0_sel:DWORD src1_sel:WORD_0
    ds_write_b64 v242, v[204:205] offset:25856
    v_lshlrev_b32_sdwa v243, 1, v243 dst_sel:DWORD dst_unused:UNUSED_PAD src0_sel:DWORD src1_sel:WORD_0
    ds_write_b64 v243, v[206:207] offset:25856
    s_mov_b64 exec, -1
    v_subrev_f32 v220, s44, v224
    v_subrev_f32 v221, s45, v224
    v_subrev_f32 v222, s46, v224
    v_subrev_f32 v223, s47, v224
    v_mul_f32 v220, v220, v220
    v_mul_f32 v221, v221, v221
    v_mul_f32 v222, v222, v222
    v_mul_f32 v223, v223, v223
    v_exp_f32 v220, -v220
    v_exp_f32 v221, -v221
    v_exp_f32 v222, -v222
    v_exp_f32 v223, -v223
    v_cvt_pk_f16_f32 v184, v216, v217
    v_cvt_pk_f16_f32 v185, v218, v219
    v_cvt_pk_f16_f32 v186, v220, v221
    v_cvt_pk_f16_f32 v187, v222, v223
    s_cmp_le_u32 s83, 832
    s_cbranch_scc1 Lg11
    v_lshrrev_b32 v240, 6, v208
    v_lshrrev_b32 v241, 6, v210
    v_and_b32 v240, 0x3ffc, v240
    v_and_b32 v241, 0x3ffc, v241
    ds_read_b32 v240, v240 offset:0
    ds_read_b32 v241, v241 offset:0
    v_cmpx_gt_i32 vcc, 0, v209
    s_waitcnt lgkmcnt(0)
    v_add_u32 v240, v240, v209
    v_add_u32 v241, v241, v211
    v_lshlrev_b32_sdwa v240, 1, v240 dst_sel:DWORD dst_unused:UNUSED_PAD src0_sel:DWORD src1_sel:WORD_0
    ds_write_b64 v240, v[208:209] offset:25856
    v_lshlrev_b32_sdwa v241, 1, v241 dst_sel:DWORD dst_unused:UNUSED_PAD src0_sel:DWORD src1_sel:WORD_0
    ds_write_b64 v241, v[210:211] offset:25856
    s_mov_b64 exec, -1
    s_cmp_le_u32 s83, 896
    s_cbranch_scc1 Lg11
    v_lshrrev_b32 v242, 6, v212
    v_lshrrev_b32 v243, 6, v214
    v_and_b32 v242, 0x3ffc, v242
    v_and_b32 v243, 0x3ffc, v243
    ds_read_b32 v242, v242 offset:0
    ds_read_b32 v243, v243 offset:0
    v_cmpx_gt_i32 vcc, 0, v213
    s_waitcnt lgkmcnt(0)
    v_add_u32 v242, v242, v213
    v_add_u32 v243, v243, v215
    v_lshlrev_b32_sdwa v242, 1, v242 dst_sel:DWORD dst_unused:UNUSED_PAD src0_sel:DWORD src1_sel:WORD_0
    ds_write_b64 v242, v[212:213] offset:25856
    v_lshlrev_b32_sdwa v243, 1, v243 dst_sel:DWORD dst_unused:UNUSED_PAD src0_sel:DWORD src1_sel:WORD_0
    ds_write_b64 v243, v[214:215] offset:25856
    s_mov_b64 exec, -1
Lg11:
    s_nop 3
    s_cmp_lg_u32 s48, 0
    s_cbranch_scc1 Lk2_r6
    v_lshlrev_b32 v224, 16, v250
    v_mul_f32 v224, s69, v224
    v_subrev_f32 v216, s40, v224
    v_subrev_f32 v217, s41, v224
    v_subrev_f32 v218, s42, v224
    v_subrev_f32 v219, s43, v224
    v_subrev_f32 v220, s44, v224
    v_subrev_f32 v221, s45, v224
    v_subrev_f32 v222, s46, v224
    v_subrev_f32 v223, s47, v224
    v_mul_f32 v216, v216, v216
    v_mul_f32 v217, v217, v217
    v_mul_f32 v218, v218, v218
    v_mul_f32 v219, v219, v219
    v_mul_f32 v220, v220, v220
    v_mul_f32 v221, v221, v221
    v_mul_f32 v222, v222, v222
    v_mul_f32 v223, v223, v223
    v_exp_f32 v216, -v216
    v_exp_f32 v217, -v217
    v_exp_f32 v218, -v218
    v_exp_f32 v219, -v219
    v_exp_f32 v220, -v220
    v_exp_f32 v221, -v221
    v_exp_f32 v222, -v222
    v_exp_f32 v223, -v223
    v_cvt_pk_f16_f32 v188, v216, v217
    v_cvt_pk_f16_f32 v189, v218, v219
    v_cvt_pk_f16_f32 v190, v220, v221
    v_cvt_pk_f16_f32 v191, v222, v223
Lk2_r6:
    s_waitcnt lgkmcnt(0)
    s_barrier
    s_add_u32 s72, s68, 1023
    s_lshr_b32 s72, s72, 10
    s_cmp_ge_u32 s71, s72
    s_cbranch_scc1 LrdL
LrlL:
    s_add_u32 s50, s71, 0
    s_and_b32 s50, s50, 15
    s_lshl_b32 s50, s50, 13
    v_add_u32 v232, s50, v252
    ds_read_b64 v[216:217], v232 offset:25856
    ds_read_b64 v[218:219], v232 offset:29952
    s_add_u32 s50, s71, 1
    s_and_b32 s50, s50, 15
    s_lshl_b32 s50, s50, 13
    v_add_u32 v233, s50, v252
    ds_read_b64 v[220:221], v233 offset:25856
    ds_read_b64 v[222:223], v233 offset:29952
    s_add_u32 s50, s71, 2
    s_and_b32 s50, s50, 15
    s_lshl_b32 s50, s50, 13
    v_add_u32 v234, s50, v252
    ds_read_b64 v[224:225], v234 offset:25856
    ds_read_b64 v[226:227], v234 offset:29952
    s_add_u32 s50, s71, 3
    s_and_b32 s50, s50, 15
    s_lshl_b32 s50, s50, 13
    v_add_u32 v235, s50, v252
    ds_read_b64 v[228:229], v235 offset:25856
    ds_read_b64 v[230:231], v235 offset:29952
    s_mul_i32 s59, s71, 3
    s_set_gpr_idx_on s59, gpr_idx(DST)
    s_waitcnt lgkmcnt(6)
    v_mov_b32 v2, v216
    v_mov_b32 v3, v218
    v_perm_b32 v4, v219, v217, s73
    s_waitcnt lgkmcnt(4)
    v_mov_b32 v5, v220
    v_mov_b32 v6, v222
    v_perm_b32 v7, v223, v221, s73
    s_waitcnt lgkmcnt(2)
    v_mov_b32 v8, v224
    v_mov_b32 v9, v226
    v_perm_b32 v10, v227, v225, s73
    s_waitcnt lgkmcnt(0)
    v_mov_b32 v11, v228
    v_mov_b32 v12, v230
    v_perm_b32 v13, v231, v229, s73
    s_set_gpr_idx_off
    s_add_u32 s71, s71, 4
    s_cmp_lt_u32 s71, s72
    s_cbranch_scc1 LrlL
LrdL:
    s_mov_b32 s71, s72
    s_max_u32 s71, s71, 1
    s_sub_u32 s71, s71, 1
    s_mul_i32 s88, s71, 3
    s_lshl_b32 s50, s71, 10
    s_sub_u32 s50, s68, s50
    v_lshrrev_b32 v251, 3, v252
    v_add_u32 v252, 512, v251
    v_cmp_gt_u32 s[84:85], s50, v251
    v_cmp_gt_u32 s[86:87], s50, v252
    s_set_gpr_idx_on s88, gpr_idx(SRC1,DST)
    s_andn2_b64 exec, -1, s[86:87]
    v_mov_b32 v3, 0
    v_and_b32 v4, 0xffff, v4
    s_andn2_b64 exec, -1, s[84:85]
    v_mov_b32 v2, 0
    v_mov_b32 v4, 0
    s_mov_b64 exec, -1
    s_set_gpr_idx_off
    s_mov_b32 s59, 0
    s_mov_b32 s77, 0
    s_mov_b32 s79, s71
    s_bitcmp1_b32 s2, 3
    s_cselect_b32 s78, 1, 0
    s_mov_b32 s75, 1
    s_add_u32 s76, s77, s78
    s_xor_b32 s76, s76, s75
    s_sub_u32 s76, s76, s78
    s_max_u32 s50, s76, s77
    s_cmp_ge_u32 s50, s79
    s_cselect_b32 s76, s77, s76
    s_mul_i32 s76, s76, 3
    s_add_u32 s77, s77, 1
Lk2_init:
    s_barrier
    v_mov_b32 v212, 0
    v_mov_b32 v213, 0
    v_mov_b32 v214, 0
    v_mov_b32 v215, 0
    v_lshlrev_b32 v244, 4, v0
    v_add_u32 v245, 112608, v244
    v_add_u32 v246, 62560, v244
    ds_write_b128 v246, v[164:167] offset:0
    ds_write_b128 v246, v[168:171] offset:8192
    ds_write_b128 v246, v[172:175] offset:16384
    ds_write_b128 v246, v[176:179] offset:24576
    ds_write_b128 v246, v[180:183] offset:32768
    ds_write_b128 v246, v[184:187] offset:40960
    s_mov_b64 exec, s[60:61]
    ds_write_b128 v246, v[188:191] offset:49152
    s_mov_b64 exec, -1
    v_lshlrev_b32 v251, 4, v1
    s_mov_b32 s50, 85983232
    buffer_load_dwordx4 v[164:167], v251, s[24:27], s50 offen
    s_mov_b32 s50, 85984256
    buffer_load_dwordx4 v[168:171], v251, s[24:27], s50 offen
    s_mov_b32 s50, 85985280
    buffer_load_dwordx4 v[172:175], v251, s[24:27], s50 offen
    s_mov_b32 s50, 85986304
    buffer_load_dwordx4 v[176:179], v251, s[24:27], s50 offen
    s_mov_b32 s50, 85987328
    buffer_load_dwordx4 v[180:183], v251, s[24:27], s50 offen
    s_cmp_lg_u32 s58, 0
    s_cbranch_scc1 Lk2_ng
    s_set_gpr_idx_on s76, gpr_idx(SRC1)
    s_nop 0
    v_and_b32 v236, s54, v2
    v_and_b32 v238, s54, v2
    v_and_b32_sdwa v240, s56, v2 dst_sel:DWORD dst_unused:UNUSED_PAD src0_sel:DWORD src1_sel:WORD_1
    v_lshlrev_b32 v242, 16, v4
    s_set_gpr_idx_off
    v_permlane32_swap_b32 v236, v238
    buffer_load_dwordx4 v[156:159], v[236:237], s[16:19], 0 idxen offen
    buffer_load_dwordx4 v[160:163], v[238:239], s[16:19], 0 idxen offen
    s_set_gpr_idx_on s76, gpr_idx(SRC1)
    s_nop 0
    v_and_b32 v236, s54, v3
    v_and_b32 v238, s54, v3
    v_and_b32_sdwa v241, s56, v3 dst_sel:DWORD dst_unused:UNUSED_PAD src0_sel:DWORD src1_sel:WORD_1
    v_and_b32 v243, s55, v4
    s_set_gpr_idx_off
    v_permlane32_swap_b32 v236, v238
    buffer_load_dwordx4 v[216:219], v[236:237], s[16:19], 0 idxen offen
    buffer_load_dwordx4 v[220:223], v[238:239], s[16:19], 0 idxen offen
Lk2_ng:
    ds_write_b128 v244, v[212:215] offset:0
    ds_write_b128 v244, v[212:215] offset:8192
    ds_write_b128 v244, v[212:215] offset:16384
    ds_write_b128 v244, v[212:215] offset:24576
    ds_write_b128 v244, v[212:215] offset:32768
    ds_write_b128 v244, v[212:215] offset:40960
    ds_write_b128 v244, v[212:215] offset:49152
    ds_write_b128 v244, v[212:215] offset:54368
    ds_write_b128 v245, v[212:215] offset:0
    ds_write_b128 v245, v[212:215] offset:8192
    ds_write_b128 v245, v[212:215] offset:16384
    ds_write_b128 v245, v[212:215] offset:24576
    ds_write_b128 v245, v[212:215] offset:32768
    ds_write_b128 v245, v[212:215] offset:40960
    ds_write_b128 v245, v[212:215] offset:41856
    v_mov_b32 v249, 0
    v_mov_b32 v247, 0
    v_mov_b32 v248, 0
    v_mov_b32 v250, 0x1000000
    v_and_b32 v255, 0x1df, v0
    v_lshl_add_u32 v255, v255, 5, v237
    s_waitcnt lgkmcnt(0)
    s_barrier
    s_cmp_lg_u32 s58, 0
    s_cbranch_scc1 Lk2_all
    ds_read_b128 v[232:235], v240 offset:62560
    v_mov_b32 v251, v242
    v_mul_f32 v242, 0x40400000, v251
    v_mul_f32 v251, 0.15915494, v251
    v_cvt_pk_bf16_f32 v242, 0, v242
    v_fract_f32 v251, v251
    v_mul_f32 v242, 0.15915494, v242
    v_cos_f32 v251, v251
    v_fract_f32 v242, v242
    v_cos_f32 v242, v242
    v_fma_mixlo_f16 v243, v251, v251, -0.5
    v_cvt_pk_f16_f32 v242, v251, v242
    s_mov_b32 s74, s76
    s_add_u32 s76, s77, s78
    s_xor_b32 s76, s76, s75
    s_sub_u32 s76, s76, s78
    s_max_u32 s50, s76, s77
    s_cmp_ge_u32 s50, s79
    s_cselect_b32 s76, s77, s76
    s_mul_i32 s76, s76, 3
    s_add_u32 s77, s77, 1
    s_waitcnt vmcnt(4)
    s_waitcnt lgkmcnt(0)
    s_mul_i32 s89, s49, 49
    s_lshr_b32 s89, s89, 8
    s_add_u32 s89, s89, 2
    s_and_b32 s50, s49, 15
    s_add_u32 s50, s50, 30
    s_cmp_lt_u32 s89, 30
    s_cselect_b32 s89, s50, s89
    s_mul_i32 s89, s89, 3
    s_min_u32 s89, s89, s88
    s_sub_u32 s50, s68, 1
    s_bitcmp0_b32 s50, 9
    s_cselect_b32 s71, s88, -1
.p2align 6
Lk2_loop:
    s_cmp_eq_u32 s59, s89
    s_cbranch_scc1 Lk2_el
Lk2_lc:
    s_waitcnt lgkmcnt(5)
    v_pk_mul_f16 v224, v232, v242 op_sel:[0,0] op_sel_hi:[1,0]
    v_pk_mul_f16 v225, v233, v242 op_sel:[0,0] op_sel_hi:[1,0]
    v_pk_mul_f16 v226, v234, v242 op_sel:[0,0] op_sel_hi:[1,0]
    v_pk_mul_f16 v227, v235, v242 op_sel:[0,0] op_sel_hi:[1,0]
    v_lshrrev_b32 v244, 1, v240
    v_lshrrev_b32 v155, 2, v240
    v_add_u32 v245, 112608, v244
    v_mfma_f32_32x32x16_f16 v[184:199], v[164:167], v[224:227], 0
    v_pk_mul_f16 v228, v232, v243 op_sel:[0,0] op_sel_hi:[1,0]
    v_pk_mul_f16 v229, v233, v243 op_sel:[0,0] op_sel_hi:[1,0]
    v_pk_mul_f16 v230, v234, v243 op_sel:[0,0] op_sel_hi:[1,0]
    v_pk_mul_f16 v231, v235, v243 op_sel:[0,0] op_sel_hi:[1,0]
    v_or_b32 v249, v249, v247
    s_cmp_eq_u32 s59, s88
    s_cselect_b64 s[62:63], s[84:85], -1
    s_cselect_b32 s72, 0, s54
    v_mfma_f32_32x32x16_f16 v[184:199], v[168:171], v[228:231], v[184:199]
    v_pk_mul_f16 v224, v232, v242 op_sel:[0,1] op_sel_hi:[1,1]
    v_pk_mul_f16 v225, v233, v242 op_sel:[0,1] op_sel_hi:[1,1]
    v_pk_mul_f16 v226, v234, v242 op_sel:[0,1] op_sel_hi:[1,1]
    v_pk_mul_f16 v227, v235, v242 op_sel:[0,1] op_sel_hi:[1,1]
    ds_read_b128 v[232:235], v241 offset:62560
    s_nop 0
    v_mfma_f32_32x32x16_f16 v[184:199], v[172:175], v[224:227], v[184:199]
    s_set_gpr_idx_on s76, gpr_idx(SRC1)
    s_nop 0
    v_and_b32 v236, s72, v2
    v_and_b32 v238, s72, v2
    v_and_b32_sdwa v240, s56, v2 dst_sel:DWORD dst_unused:UNUSED_PAD src0_sel:DWORD src1_sel:WORD_1
    s_set_gpr_idx_idx s74
    s_nop 0
    v_and_b32 v251, s55, v4
    s_set_gpr_idx_off
    v_permlane32_swap_b32 v236, v238
    v_mul_f32 v242, 0x40400000, v251
    v_mul_f32 v251, 0.15915494, v251
    s_waitcnt vmcnt(2)
    v_mfma_f32_32x32x16_bf16 v[200:215], v[176:179], v[156:159], 0
    v_cvt_pk_bf16_f32 v242, 0, v242
    v_fract_f32 v251, v251
    v_mul_f32 v242, 0.15915494, v242
    v_cos_f32 v251, v251
    v_fract_f32 v242, v242
    v_mfma_f32_32x32x16_bf16 v[200:215], v[180:183], v[160:163], v[200:215]
    buffer_load_dwordx4 v[156:159], v[236:237], s[16:19], 0 idxen offen
    buffer_load_dwordx4 v[160:163], v[238:239], s[16:19], 0 idxen offen
    v_cos_f32 v242, v242
    v_fma_mixlo_f16 v243, v251, v251, -0.5
    v_cvt_pk_f16_f32 v242, v251, v242
    s_mov_b64 exec, s[62:63]
    s_nop 5
    v_fma_f32 v200, v200, v184, s52
    v_fma_f32 v201, v201, v185, s52
    v_fma_f32 v202, v202, v186, s52
    v_fma_f32 v203, v203, v187, s52
    v_cvt_pknorm_u16_f32 v200, v200, v201
    v_fma_f32 v204, v204, v188, s52
    v_fma_f32 v205, v205, v189, s52
    v_cvt_pknorm_u16_f32 v201, v202, v203
    v_sad_u16 v251, v200, s53, v250
    ds_add_u64 v244, v[200:201] offset:0
    v_fma_f32 v206, v206, v190, s52
    v_fma_f32 v207, v207, v191, s52
    v_cvt_pknorm_u16_f32 v204, v204, v205
    v_sad_u16 v251, v201, s53, v251
    v_fma_f32 v208, v208, v192, s52
    v_fma_f32 v209, v209, v193, s52
    v_cvt_pknorm_u16_f32 v205, v206, v207
    v_sad_u16 v252, v204, s53, v250
    ds_add_u64 v244, v[204:205] offset:37536
    v_fma_f32 v210, v210, v194, s52
    v_fma_f32 v211, v211, v195, s52
    v_cvt_pknorm_u16_f32 v208, v208, v209
    v_sad_u16 v252, v205, s53, v252
    v_fma_f32 v212, v212, v196, s52
    v_fma_f32 v213, v213, v197, s52
    v_cvt_pknorm_u16_f32 v209, v210, v211
    v_sad_u16 v253, v208, s53, v250
    ds_add_u64 v245, v[208:209] offset:0
    v_fma_f32 v214, v214, v198, s52
    v_fma_f32 v215, v215, v199, s52
    v_cvt_pknorm_u16_f32 v212, v212, v213
    v_sad_u16 v253, v209, s53, v253
    v_max3_u32 v246, v251, v252, v253
    v_cvt_pknorm_u16_f32 v213, v214, v215
    v_sad_u16 v254, v212, s53, v250
    ds_add_u64 v245, v[212:213] offset:25024
    v_sad_u16 v254, v213, s53, v254
    v_max_u32 v246, v246, v254
    ds_add_rtn_u32 v247, v155, v246 offset:25024
    s_mov_b64 exec, -1
    s_cmp_eq_u32 s59, s71
    s_cbranch_scc1 Lk2_x
    s_waitcnt lgkmcnt(5)
    v_pk_mul_f16 v224, v232, v242 op_sel:[0,0] op_sel_hi:[1,0]
    v_pk_mul_f16 v225, v233, v242 op_sel:[0,0] op_sel_hi:[1,0]
    v_pk_mul_f16 v226, v234, v242 op_sel:[0,0] op_sel_hi:[1,0]
    v_pk_mul_f16 v227, v235, v242 op_sel:[0,0] op_sel_hi:[1,0]
    v_lshrrev_b32 v244, 1, v241
    v_lshrrev_b32 v155, 2, v241
    v_add_u32 v245, 112608, v244
    v_mfma_f32_32x32x16_f16 v[184:199], v[164:167], v[224:227], 0
    v_pk_mul_f16 v228, v232, v243 op_sel:[0,0] op_sel_hi:[1,0]
    v_pk_mul_f16 v229, v233, v243 op_sel:[0,0] op_sel_hi:[1,0]
    v_pk_mul_f16 v230, v234, v243 op_sel:[0,0] op_sel_hi:[1,0]
    v_pk_mul_f16 v231, v235, v243 op_sel:[0,0] op_sel_hi:[1,0]
    v_or_b32 v249, v249, v248
    s_cmp_eq_u32 s59, s88
    s_cselect_b64 s[62:63], s[86:87], -1
    v_mfma_f32_32x32x16_f16 v[184:199], v[168:171], v[228:231], v[184:199]
    v_pk_mul_f16 v224, v232, v242 op_sel:[0,1] op_sel_hi:[1,1]
    v_pk_mul_f16 v225, v233, v242 op_sel:[0,1] op_sel_hi:[1,1]
    v_pk_mul_f16 v226, v234, v242 op_sel:[0,1] op_sel_hi:[1,1]
    v_pk_mul_f16 v227, v235, v242 op_sel:[0,1] op_sel_hi:[1,1]
    ds_read_b128 v[232:235], v240 offset:62560
    s_bitcmp0_b32 s48, 1
    s_cbranch_scc1 Lhb12
    s_barrier
Lhb12:
    v_mfma_f32_32x32x16_f16 v[184:199], v[172:175], v[224:227], v[184:199]
    s_set_gpr_idx_on s76, gpr_idx(SRC1)
    s_nop 0
    v_and_b32 v236, s72, v3
    v_and_b32 v238, s72, v3
    v_and_b32_sdwa v241, s56, v3 dst_sel:DWORD dst_unused:UNUSED_PAD src0_sel:DWORD src1_sel:WORD_1
    v_lshlrev_b32 v251, 16, v4
    s_set_gpr_idx_off
    v_permlane32_swap_b32 v236, v238
    v_mul_f32 v242, 0x40400000, v251
    v_mul_f32 v251, 0.15915494, v251
    s_waitcnt vmcnt(2)
    v_mfma_f32_32x32x16_bf16 v[200:215], v[176:179], v[216:219], 0
    v_cvt_pk_bf16_f32 v242, 0, v242
    v_fract_f32 v251, v251
    v_mul_f32 v242, 0.15915494, v242
    v_cos_f32 v251, v251
    v_fract_f32 v242, v242
    v_mfma_f32_32x32x16_bf16 v[200:215], v[180:183], v[220:223], v[200:215]
    buffer_load_dwordx4 v[216:219], v[236:237], s[16:19], 0 idxen offen
    buffer_load_dwordx4 v[220:223], v[238:239], s[16:19], 0 idxen offen
    v_cos_f32 v242, v242
    v_fma_mixlo_f16 v243, v251, v251, -0.5
    v_cvt_pk_f16_f32 v242, v251, v242
    s_mov_b32 s74, s76
    s_add_u32 s76, s77, s78
    s_xor_b32 s76, s76, s75
    s_sub_u32 s76, s76, s78
    s_max_u32 s50, s76, s77
    s_cmp_ge_u32 s50, s79
    s_cselect_b32 s76, s77, s76
    s_mul_i32 s76, s76, 3
    s_add_u32 s77, s77, 1
    s_mov_b64 exec, s[62:63]
    v_fma_f32 v200, v200, v184, s52
    v_fma_f32 v201, v201, v185, s52
    v_fma_f32 v202, v202, v186, s52
    v_fma_f32 v203, v203, v187, s52
    v_cvt_pknorm_u16_f32 v200, v200, v201
    v_fma_f32 v204, v204, v188, s52
    v_fma_f32 v205, v205, v189, s52
    v_cvt_pknorm_u16_f32 v201, v202, v203
    v_sad_u16 v251, v200, s53, v250
    ds_add_u64 v244, v[200:201] offset:0
    v_fma_f32 v206, v206, v190, s52
    v_fma_f32 v207, v207, v191, s52
    v_cvt_pknorm_u16_f32 v204, v204, v205
    v_sad_u16 v251, v201, s53, v251
    v_fma_f32 v208, v208, v192, s52
    v_fma_f32 v209, v209, v193, s52
    v_cvt_pknorm_u16_f32 v205, v206, v207
    v_sad_u16 v252, v204, s53, v250
    ds_add_u64 v244, v[204:205] offset:37536
    v_fma_f32 v210, v210, v194, s52
    v_fma_f32 v211, v211, v195, s52
    v_cvt_pknorm_u16_f32 v208, v208, v209
    v_sad_u16 v252, v205, s53, v252
    v_fma_f32 v212, v212, v196, s52
    v_fma_f32 v213, v213, v197, s52
    v_cvt_pknorm_u16_f32 v209, v210, v211
    v_sad_u16 v253, v208, s53, v250
    ds_add_u64 v245, v[208:209] offset:0
    v_fma_f32 v214, v214, v198, s52
    v_fma_f32 v215, v215, v199, s52
    v_cvt_pknorm_u16_f32 v212, v212, v213
    v_sad_u16 v253, v209, s53, v253
    v_max3_u32 v246, v251, v252, v253
    v_cvt_pknorm_u16_f32 v213, v214, v215
    v_sad_u16 v254, v212, s53, v250
    ds_add_u64 v245, v[212:213] offset:25024
    v_sad_u16 v254, v213, s53, v254
    v_max_u32 v246, v246, v254
    ds_add_rtn_u32 v248, v155, v246 offset:25024
    s_mov_b64 exec, -1
    s_bitcmp1_b32 s48, 1
    s_cbranch_scc1 Lhb13
    s_barrier
Lhb13:
    s_add_u32 s59, s59, 3
    s_cmp_le_u32 s59, s88
    s_cbranch_scc1 Lk2_loop
Lk2_x:
    s_mov_b32 s57, 0
    s_mov_b64 s[64:65], 0
    s_mov_b64 s[78:79], 0
    s_mov_b64 s[66:67], 0
    s_mov_b64 s[80:81], 0
    s_mov_b64 s[68:69], 0
    s_mov_b64 s[82:83], 0
    s_mov_b64 s[70:71], 0
    s_mov_b64 s[84:85], 0
    s_mov_b64 s[72:73], 0
    s_mov_b64 s[86:87], 0
    s_mov_b64 s[74:75], 0
    s_mov_b64 s[88:89], 0
    s_mov_b64 s[76:77], 0
    s_mov_b64 s[90:91], 0
Lk2_epi:
    v_lshlrev_b32 v244, 3, v0
    v_lshlrev_b32 v155, 2, v0
    v_add_u32 v245, 112608, v244
    v_lshlrev_b32 v92, 4, v0
    s_mov_b32 s50, 81920
    buffer_load_dwordx4 v[44:47], v255, s[32:35], s50 offen
    buffer_load_dwordx4 v[48:51], v255, s[32:35], s50 offen offset:1024
    s_mov_b32 s50, 98304
    buffer_load_dwordx4 v[52:55], v255, s[32:35], s50 offen
    buffer_load_dwordx4 v[56:59], v255, s[32:35], s50 offen offset:1024
    s_waitcnt vmcnt(6) lgkmcnt(0)
    v_or3_b32 v249, v249, v247, v248
    s_barrier
    ds_read_b32 v144, v155 offset:25024
    ds_read_b64 v[132:133], v244 offset:0
    ds_read_b64 v[134:135], v244 offset:37536
    ds_read_b64 v[136:137], v245 offset:0
    ds_read_b64 v[138:139], v245 offset:25024
    ds_read_b128 v[140:143], v92 offset:62560
    v_add_u32 v92, 8192, v92
    ds_read_b32 v108, v155 offset:27072
    ds_read_b64 v[96:97], v244 offset:4096
    ds_read_b64 v[98:99], v244 offset:41632
    ds_read_b64 v[100:101], v245 offset:4096
    ds_read_b64 v[102:103], v245 offset:29120
    ds_read_b128 v[104:107], v92 offset:62560
    v_add_u32 v92, 8192, v92
    s_waitcnt lgkmcnt(11)
    v_lshrrev_b32 v145, 24, v144
    v_and_b32 v144, 0xffffff, v144
    v_sub_u32 v112, 0x20001, v145
    v_mad_u64_u32 v[146:147], vcc, v112, s53, v[80:81]
    v_cmp_lt_u32 vcc, 127, v145
    v_mul_u32_u24 v145, 64, v145
    s_or_b64 s[64:65], s[64:65], vcc
    v_cmp_lt_u32 vcc, 0x7ffe, v144
    v_add_u32 v147, v147, v146
    s_or_b64 s[64:65], s[64:65], vcc
    v_cmp_lt_u32 vcc, v144, v145
    s_or_b64 s[64:65], s[64:65], vcc
    s_andn2_b64 exec, -1, s[78:79]
    s_waitcnt lgkmcnt(10)
    v_lshl_add_u64 v[132:133], v[132:133], 0, v[146:147]
    v_xor_b32 v132, s53, v132
    v_xor_b32 v133, s53, v133
    v_cvt_f32_i32_sdwa v144, sext(v132) dst_sel:DWORD dst_unused:UNUSED_PAD src0_sel:WORD_1
    v_cvt_f32_i32_sdwa v132, sext(v132) dst_sel:DWORD dst_unused:UNUSED_PAD src0_sel:WORD_0
    v_cvt_f32_i32_sdwa v145, sext(v133) dst_sel:DWORD dst_unused:UNUSED_PAD src0_sel:WORD_1
    v_cvt_f32_i32_sdwa v133, sext(v133) dst_sel:DWORD dst_unused:UNUSED_PAD src0_sel:WORD_0
    v_cvt_pk_bf16_f32 v132, v132, v144
    v_cvt_pk_bf16_f32 v133, v133, v145
    s_mov_b64 exec, -1
    s_andn2_b64 exec, -1, s[78:79]
    s_waitcnt lgkmcnt(9)
    v_lshl_add_u64 v[134:135], v[134:135], 0, v[146:147]
    v_xor_b32 v134, s53, v134
    v_xor_b32 v135, s53, v135
    v_cvt_f32_i32_sdwa v144, sext(v134) dst_sel:DWORD dst_unused:UNUSED_PAD src0_sel:WORD_1
    v_cvt_f32_i32_sdwa v134, sext(v134) dst_sel:DWORD dst_unused:UNUSED_PAD src0_sel:WORD_0
    v_cvt_f32_i32_sdwa v145, sext(v135) dst_sel:DWORD dst_unused:UNUSED_PAD src0_sel:WORD_1
    v_cvt_f32_i32_sdwa v135, sext(v135) dst_sel:DWORD dst_unused:UNUSED_PAD src0_sel:WORD_0
    v_cvt_pk_bf16_f32 v134, v134, v144
    v_cvt_pk_bf16_f32 v135, v135, v145
    s_mov_b64 exec, -1
    s_andn2_b64 exec, -1, s[78:79]
    s_waitcnt lgkmcnt(8)
    v_lshl_add_u64 v[136:137], v[136:137], 0, v[146:147]
    v_xor_b32 v136, s53, v136
    v_xor_b32 v137, s53, v137
    v_cvt_f32_i32_sdwa v144, sext(v136) dst_sel:DWORD dst_unused:UNUSED_PAD src0_sel:WORD_1
    v_cvt_f32_i32_sdwa v136, sext(v136) dst_sel:DWORD dst_unused:UNUSED_PAD src0_sel:WORD_0
    v_cvt_f32_i32_sdwa v145, sext(v137) dst_sel:DWORD dst_unused:UNUSED_PAD src0_sel:WORD_1
    v_cvt_f32_i32_sdwa v137, sext(v137) dst_sel:DWORD dst_unused:UNUSED_PAD src0_sel:WORD_0
    v_cvt_pk_bf16_f32 v136, v136, v144
    v_cvt_pk_bf16_f32 v137, v137, v145
    s_mov_b64 exec, -1
    s_andn2_b64 exec, -1, s[78:79]
    s_waitcnt lgkmcnt(7)
    v_lshl_add_u64 v[138:139], v[138:139], 0, v[146:147]
    v_xor_b32 v138, s53, v138
    v_xor_b32 v139, s53, v139
    v_cvt_f32_i32_sdwa v144, sext(v138) dst_sel:DWORD dst_unused:UNUSED_PAD src0_sel:WORD_1
    v_cvt_f32_i32_sdwa v138, sext(v138) dst_sel:DWORD dst_unused:UNUSED_PAD src0_sel:WORD_0
    v_cvt_f32_i32_sdwa v145, sext(v139) dst_sel:DWORD dst_unused:UNUSED_PAD src0_sel:WORD_1
    v_cvt_f32_i32_sdwa v139, sext(v139) dst_sel:DWORD dst_unused:UNUSED_PAD src0_sel:WORD_0
    v_cvt_pk_bf16_f32 v138, v138, v144
    v_cvt_pk_bf16_f32 v139, v139, v145
    s_mov_b64 exec, -1
    s_waitcnt lgkmcnt(6)
    v_mfma_f32_32x32x16_bf16 v[116:131], v[72:75], v[4:7], 0
    s_waitcnt lgkmcnt(0)
    v_lshrrev_b32 v109, 24, v108
    v_and_b32 v108, 0xffffff, v108
    v_sub_u32 v112, 0x20001, v109
    v_mad_u64_u32 v[110:111], vcc, v112, s53, v[80:81]
    v_cmp_lt_u32 vcc, 127, v109
    v_mul_u32_u24 v109, 64, v109
    s_or_b64 s[66:67], s[66:67], vcc
    v_cmp_lt_u32 vcc, 0x7ffe, v108
    v_add_u32 v111, v111, v110
    s_or_b64 s[66:67], s[66:67], vcc
    v_cmp_lt_u32 vcc, v108, v109
    s_or_b64 s[66:67], s[66:67], vcc
    v_mfma_f32_32x32x16_bf16 v[116:131], v[76:79], v[8:11], v[116:131]
    s_andn2_b64 exec, -1, s[80:81]
    v_lshl_add_u64 v[96:97], v[96:97], 0, v[110:111]
    v_xor_b32 v96, s53, v96
    v_xor_b32 v97, s53, v97
    v_cvt_f32_i32_sdwa v108, sext(v96) dst_sel:DWORD dst_unused:UNUSED_PAD src0_sel:WORD_1
    v_cvt_f32_i32_sdwa v96, sext(v96) dst_sel:DWORD dst_unused:UNUSED_PAD src0_sel:WORD_0
    v_cvt_f32_i32_sdwa v109, sext(v97) dst_sel:DWORD dst_unused:UNUSED_PAD src0_sel:WORD_1
    v_cvt_f32_i32_sdwa v97, sext(v97) dst_sel:DWORD dst_unused:UNUSED_PAD src0_sel:WORD_0
    v_cvt_pk_bf16_f32 v96, v96, v108
    v_cvt_pk_bf16_f32 v97, v97, v109
    s_mov_b64 exec, -1
    v_mfma_f32_32x32x16_f16 v[184:199], v[68:71], v[140:143], 0
    s_andn2_b64 exec, -1, s[80:81]
    v_lshl_add_u64 v[98:99], v[98:99], 0, v[110:111]
    v_xor_b32 v98, s53, v98
    v_xor_b32 v99, s53, v99
    v_cvt_f32_i32_sdwa v108, sext(v98) dst_sel:DWORD dst_unused:UNUSED_PAD src0_sel:WORD_1
    v_cvt_f32_i32_sdwa v98, sext(v98) dst_sel:DWORD dst_unused:UNUSED_PAD src0_sel:WORD_0
    v_cvt_f32_i32_sdwa v109, sext(v99) dst_sel:DWORD dst_unused:UNUSED_PAD src0_sel:WORD_1
    v_cvt_f32_i32_sdwa v99, sext(v99) dst_sel:DWORD dst_unused:UNUSED_PAD src0_sel:WORD_0
    v_cvt_pk_bf16_f32 v98, v98, v108
    v_cvt_pk_bf16_f32 v99, v99, v109
    s_mov_b64 exec, -1
    v_mfma_f32_32x32x16_bf16 v[200:215], v[60:63], v[132:135], 0
    s_andn2_b64 exec, -1, s[80:81]
    v_lshl_add_u64 v[100:101], v[100:101], 0, v[110:111]
    v_xor_b32 v100, s53, v100
    v_xor_b32 v101, s53, v101
    v_cvt_f32_i32_sdwa v108, sext(v100) dst_sel:DWORD dst_unused:UNUSED_PAD src0_sel:WORD_1
    v_cvt_f32_i32_sdwa v100, sext(v100) dst_sel:DWORD dst_unused:UNUSED_PAD src0_sel:WORD_0
    v_cvt_f32_i32_sdwa v109, sext(v101) dst_sel:DWORD dst_unused:UNUSED_PAD src0_sel:WORD_1
    v_cvt_f32_i32_sdwa v101, sext(v101) dst_sel:DWORD dst_unused:UNUSED_PAD src0_sel:WORD_0
    v_cvt_pk_bf16_f32 v100, v100, v108
    v_cvt_pk_bf16_f32 v101, v101, v109
    s_mov_b64 exec, -1
    v_mfma_f32_32x32x16_bf16 v[200:215], v[64:67], v[136:139], v[200:215]
    s_andn2_b64 exec, -1, s[80:81]
    v_lshl_add_u64 v[102:103], v[102:103], 0, v[110:111]
    v_xor_b32 v102, s53, v102
    v_xor_b32 v103, s53, v103
    v_cvt_f32_i32_sdwa v108, sext(v102) dst_sel:DWORD dst_unused:UNUSED_PAD src0_sel:WORD_1
    v_cvt_f32_i32_sdwa v102, sext(v102) dst_sel:DWORD dst_unused:UNUSED_PAD src0_sel:WORD_0
    v_cvt_f32_i32_sdwa v109, sext(v103) dst_sel:DWORD dst_unused:UNUSED_PAD src0_sel:WORD_1
    v_cvt_f32_i32_sdwa v103, sext(v103) dst_sel:DWORD dst_unused:UNUSED_PAD src0_sel:WORD_0
    v_cvt_pk_bf16_f32 v102, v102, v108
    v_cvt_pk_bf16_f32 v103, v103, v109
    s_mov_b64 exec, -1
    ds_read_b32 v144, v155 offset:29120
    ds_read_b64 v[132:133], v244 offset:8192
    ds_read_b64 v[134:135], v244 offset:45728
    ds_read_b64 v[136:137], v245 offset:8192
    ds_read_b64 v[138:139], v245 offset:33216
    ds_read_b128 v[140:143], v92 offset:62560
    v_add_u32 v92, 8192, v92
    s_mov_b32 s50, 0
    v_fmac_f32 v116, v200, v184
    v_fmac_f32 v117, v201, v185
    v_cvt_pk_bf16_f32 v4, v116, v117
    v_fmac_f32 v118, v202, v186
    v_fmac_f32 v119, v203, v187
    v_cvt_pk_bf16_f32 v5, v118, v119
    v_fmac_f32 v120, v204, v188
    v_fmac_f32 v121, v205, v189
    v_cvt_pk_bf16_f32 v6, v120, v121
    v_fmac_f32 v122, v206, v190
    v_fmac_f32 v123, v207, v191
    v_cvt_pk_bf16_f32 v7, v122, v123
    buffer_store_dwordx4 v[4:7], v255, s[36:39], s50 offen nt
    v_fmac_f32 v124, v208, v192
    v_fmac_f32 v125, v209, v193
    v_cvt_pk_bf16_f32 v8, v124, v125
    v_fmac_f32 v126, v210, v194
    v_fmac_f32 v127, v211, v195
    v_cvt_pk_bf16_f32 v9, v126, v127
    v_fmac_f32 v128, v212, v196
    v_fmac_f32 v129, v213, v197
    v_cvt_pk_bf16_f32 v10, v128, v129
    v_fmac_f32 v130, v214, v198
    v_fmac_f32 v131, v215, v199
    v_cvt_pk_bf16_f32 v11, v130, v131
    buffer_store_dwordx4 v[8:11], v255, s[36:39], s50 offen offset:1024 nt
    v_mfma_f32_32x32x16_bf16 v[116:131], v[72:75], v[12:15], 0
    s_waitcnt lgkmcnt(0)
    v_lshrrev_b32 v145, 24, v144
    v_and_b32 v144, 0xffffff, v144
    v_sub_u32 v112, 0x20001, v145
    v_mad_u64_u32 v[146:147], vcc, v112, s53, v[80:81]
    v_cmp_lt_u32 vcc, 127, v145
    v_mul_u32_u24 v145, 64, v145
    s_or_b64 s[68:69], s[68:69], vcc
    v_cmp_lt_u32 vcc, 0x7ffe, v144
    v_add_u32 v147, v147, v146
    s_or_b64 s[68:69], s[68:69], vcc
    v_cmp_lt_u32 vcc, v144, v145
    s_or_b64 s[68:69], s[68:69], vcc
    v_mfma_f32_32x32x16_bf16 v[116:131], v[76:79], v[16:19], v[116:131]
    s_andn2_b64 exec, -1, s[82:83]
    v_lshl_add_u64 v[132:133], v[132:133], 0, v[146:147]
    v_xor_b32 v132, s53, v132
    v_xor_b32 v133, s53, v133
    v_cvt_f32_i32_sdwa v144, sext(v132) dst_sel:DWORD dst_unused:UNUSED_PAD src0_sel:WORD_1
    v_cvt_f32_i32_sdwa v132, sext(v132) dst_sel:DWORD dst_unused:UNUSED_PAD src0_sel:WORD_0
    v_cvt_f32_i32_sdwa v145, sext(v133) dst_sel:DWORD dst_unused:UNUSED_PAD src0_sel:WORD_1
    v_cvt_f32_i32_sdwa v133, sext(v133) dst_sel:DWORD dst_unused:UNUSED_PAD src0_sel:WORD_0
    v_cvt_pk_bf16_f32 v132, v132, v144
    v_cvt_pk_bf16_f32 v133, v133, v145
    s_mov_b64 exec, -1
    v_mfma_f32_32x32x16_f16 v[184:199], v[68:71], v[104:107], 0
    s_andn2_b64 exec, -1, s[82:83]
    v_lshl_add_u64 v[134:135], v[134:135], 0, v[146:147]
    v_xor_b32 v134, s53, v134
    v_xor_b32 v135, s53, v135
    v_cvt_f32_i32_sdwa v144, sext(v134) dst_sel:DWORD dst_unused:UNUSED_PAD src0_sel:WORD_1
    v_cvt_f32_i32_sdwa v134, sext(v134) dst_sel:DWORD dst_unused:UNUSED_PAD src0_sel:WORD_0
    v_cvt_f32_i32_sdwa v145, sext(v135) dst_sel:DWORD dst_unused:UNUSED_PAD src0_sel:WORD_1
    v_cvt_f32_i32_sdwa v135, sext(v135) dst_sel:DWORD dst_unused:UNUSED_PAD src0_sel:WORD_0
    v_cvt_pk_bf16_f32 v134, v134, v144
    v_cvt_pk_bf16_f32 v135, v135, v145
    s_mov_b64 exec, -1
    v_mfma_f32_32x32x16_bf16 v[200:215], v[60:63], v[96:99], 0
    s_andn2_b64 exec, -1, s[82:83]
    v_lshl_add_u64 v[136:137], v[136:137], 0, v[146:147]
    v_xor_b32 v136, s53, v136
    v_xor_b32 v137, s53, v137
    v_cvt_f32_i32_sdwa v144, sext(v136) dst_sel:DWORD dst_unused:UNUSED_PAD src0_sel:WORD_1
    v_cvt_f32_i32_sdwa v136, sext(v136) dst_sel:DWORD dst_unused:UNUSED_PAD src0_sel:WORD_0
    v_cvt_f32_i32_sdwa v145, sext(v137) dst_sel:DWORD dst_unused:UNUSED_PAD src0_sel:WORD_1
    v_cvt_f32_i32_sdwa v137, sext(v137) dst_sel:DWORD dst_unused:UNUSED_PAD src0_sel:WORD_0
    v_cvt_pk_bf16_f32 v136, v136, v144
    v_cvt_pk_bf16_f32 v137, v137, v145
    s_mov_b64 exec, -1
    v_mfma_f32_32x32x16_bf16 v[200:215], v[64:67], v[100:103], v[200:215]
    s_andn2_b64 exec, -1, s[82:83]
    v_lshl_add_u64 v[138:139], v[138:139], 0, v[146:147]
    v_xor_b32 v138, s53, v138
    v_xor_b32 v139, s53, v139
    v_cvt_f32_i32_sdwa v144, sext(v138) dst_sel:DWORD dst_unused:UNUSED_PAD src0_sel:WORD_1
    v_cvt_f32_i32_sdwa v138, sext(v138) dst_sel:DWORD dst_unused:UNUSED_PAD src0_sel:WORD_0
    v_cvt_f32_i32_sdwa v145, sext(v139) dst_sel:DWORD dst_unused:UNUSED_PAD src0_sel:WORD_1
    v_cvt_f32_i32_sdwa v139, sext(v139) dst_sel:DWORD dst_unused:UNUSED_PAD src0_sel:WORD_0
    v_cvt_pk_bf16_f32 v138, v138, v144
    v_cvt_pk_bf16_f32 v139, v139, v145
    s_mov_b64 exec, -1
    ds_read_b32 v108, v155 offset:31168
    ds_read_b64 v[96:97], v244 offset:12288
    ds_read_b64 v[98:99], v244 offset:49824
    ds_read_b64 v[100:101], v245 offset:12288
    ds_read_b64 v[102:103], v245 offset:37312
    ds_read_b128 v[104:107], v92 offset:62560
    v_add_u32 v92, 8192, v92
    s_mov_b32 s50, 16384
    v_fmac_f32 v116, v200, v184
    v_fmac_f32 v117, v201, v185
    v_cvt_pk_bf16_f32 v12, v116, v117
    v_fmac_f32 v118, v202, v186
    v_fmac_f32 v119, v203, v187
    v_cvt_pk_bf16_f32 v13, v118, v119
    v_fmac_f32 v120, v204, v188
    v_fmac_f32 v121, v205, v189
    v_cvt_pk_bf16_f32 v14, v120, v121
    v_fmac_f32 v122, v206, v190
    v_fmac_f32 v123, v207, v191
    v_cvt_pk_bf16_f32 v15, v122, v123
    buffer_store_dwordx4 v[12:15], v255, s[36:39], s50 offen nt
    v_fmac_f32 v124, v208, v192
    v_fmac_f32 v125, v209, v193
    v_cvt_pk_bf16_f32 v16, v124, v125
    v_fmac_f32 v126, v210, v194
    v_fmac_f32 v127, v211, v195
    v_cvt_pk_bf16_f32 v17, v126, v127
    v_fmac_f32 v128, v212, v196
    v_fmac_f32 v129, v213, v197
    v_cvt_pk_bf16_f32 v18, v128, v129
    v_fmac_f32 v130, v214, v198
    v_fmac_f32 v131, v215, v199
    v_cvt_pk_bf16_f32 v19, v130, v131
    buffer_store_dwordx4 v[16:19], v255, s[36:39], s50 offen offset:1024 nt
    v_mfma_f32_32x32x16_bf16 v[116:131], v[72:75], v[20:23], 0
    s_waitcnt lgkmcnt(0)
    v_lshrrev_b32 v109, 24, v108
    v_and_b32 v108, 0xffffff, v108
    v_sub_u32 v112, 0x20001, v109
    v_mad_u64_u32 v[110:111], vcc, v112, s53, v[80:81]
    v_cmp_lt_u32 vcc, 127, v109
    v_mul_u32_u24 v109, 64, v109
    s_or_b64 s[70:71], s[70:71], vcc
    v_cmp_lt_u32 vcc, 0x7ffe, v108
    v_add_u32 v111, v111, v110
    s_or_b64 s[70:71], s[70:71], vcc
    v_cmp_lt_u32 vcc, v108, v109
    s_or_b64 s[70:71], s[70:71], vcc
    v_mfma_f32_32x32x16_bf16 v[116:131], v[76:79], v[24:27], v[116:131]
    s_andn2_b64 exec, -1, s[84:85]
    v_lshl_add_u64 v[96:97], v[96:97], 0, v[110:111]
    v_xor_b32 v96, s53, v96
    v_xor_b32 v97, s53, v97
    v_cvt_f32_i32_sdwa v108, sext(v96) dst_sel:DWORD dst_unused:UNUSED_PAD src0_sel:WORD_1
    v_cvt_f32_i32_sdwa v96, sext(v96) dst_sel:DWORD dst_unused:UNUSED_PAD src0_sel:WORD_0
    v_cvt_f32_i32_sdwa v109, sext(v97) dst_sel:DWORD dst_unused:UNUSED_PAD src0_sel:WORD_1
    v_cvt_f32_i32_sdwa v97, sext(v97) dst_sel:DWORD dst_unused:UNUSED_PAD src0_sel:WORD_0
    v_cvt_pk_bf16_f32 v96, v96, v108
    v_cvt_pk_bf16_f32 v97, v97, v109
    s_mov_b64 exec, -1
    v_mfma_f32_32x32x16_f16 v[184:199], v[68:71], v[140:143], 0
    s_andn2_b64 exec, -1, s[84:85]
    v_lshl_add_u64 v[98:99], v[98:99], 0, v[110:111]
    v_xor_b32 v98, s53, v98
    v_xor_b32 v99, s53, v99
    v_cvt_f32_i32_sdwa v108, sext(v98) dst_sel:DWORD dst_unused:UNUSED_PAD src0_sel:WORD_1
    v_cvt_f32_i32_sdwa v98, sext(v98) dst_sel:DWORD dst_unused:UNUSED_PAD src0_sel:WORD_0
    v_cvt_f32_i32_sdwa v109, sext(v99) dst_sel:DWORD dst_unused:UNUSED_PAD src0_sel:WORD_1
    v_cvt_f32_i32_sdwa v99, sext(v99) dst_sel:DWORD dst_unused:UNUSED_PAD src0_sel:WORD_0
    v_cvt_pk_bf16_f32 v98, v98, v108
    v_cvt_pk_bf16_f32 v99, v99, v109
    s_mov_b64 exec, -1
    v_mfma_f32_32x32x16_bf16 v[200:215], v[60:63], v[132:135], 0
    s_andn2_b64 exec, -1, s[84:85]
    v_lshl_add_u64 v[100:101], v[100:101], 0, v[110:111]
    v_xor_b32 v100, s53, v100
    v_xor_b32 v101, s53, v101
    v_cvt_f32_i32_sdwa v108, sext(v100) dst_sel:DWORD dst_unused:UNUSED_PAD src0_sel:WORD_1
    v_cvt_f32_i32_sdwa v100, sext(v100) dst_sel:DWORD dst_unused:UNUSED_PAD src0_sel:WORD_0
    v_cvt_f32_i32_sdwa v109, sext(v101) dst_sel:DWORD dst_unused:UNUSED_PAD src0_sel:WORD_1
    v_cvt_f32_i32_sdwa v101, sext(v101) dst_sel:DWORD dst_unused:UNUSED_PAD src0_sel:WORD_0
    v_cvt_pk_bf16_f32 v100, v100, v108
    v_cvt_pk_bf16_f32 v101, v101, v109
    s_mov_b64 exec, -1
    v_mfma_f32_32x32x16_bf16 v[200:215], v[64:67], v[136:139], v[200:215]
    s_andn2_b64 exec, -1, s[84:85]
    v_lshl_add_u64 v[102:103], v[102:103], 0, v[110:111]
    v_xor_b32 v102, s53, v102
    v_xor_b32 v103, s53, v103
    v_cvt_f32_i32_sdwa v108, sext(v102) dst_sel:DWORD dst_unused:UNUSED_PAD src0_sel:WORD_1
    v_cvt_f32_i32_sdwa v102, sext(v102) dst_sel:DWORD dst_unused:UNUSED_PAD src0_sel:WORD_0
    v_cvt_f32_i32_sdwa v109, sext(v103) dst_sel:DWORD dst_unused:UNUSED_PAD src0_sel:WORD_1
    v_cvt_f32_i32_sdwa v103, sext(v103) dst_sel:DWORD dst_unused:UNUSED_PAD src0_sel:WORD_0
    v_cvt_pk_bf16_f32 v102, v102, v108
    v_cvt_pk_bf16_f32 v103, v103, v109
    s_mov_b64 exec, -1
    ds_read_b32 v144, v155 offset:33216
    ds_read_b64 v[132:133], v244 offset:16384
    ds_read_b64 v[134:135], v244 offset:53920
    ds_read_b64 v[136:137], v245 offset:16384
    ds_read_b64 v[138:139], v245 offset:41408
    ds_read_b128 v[140:143], v92 offset:62560
    v_add_u32 v92, 8192, v92
    s_mov_b32 s50, 32768
    v_fmac_f32 v116, v200, v184
    v_fmac_f32 v117, v201, v185
    v_cvt_pk_bf16_f32 v20, v116, v117
    v_fmac_f32 v118, v202, v186
    v_fmac_f32 v119, v203, v187
    v_cvt_pk_bf16_f32 v21, v118, v119
    v_fmac_f32 v120, v204, v188
    v_fmac_f32 v121, v205, v189
    v_cvt_pk_bf16_f32 v22, v120, v121
    v_fmac_f32 v122, v206, v190
    v_fmac_f32 v123, v207, v191
    v_cvt_pk_bf16_f32 v23, v122, v123
    buffer_store_dwordx4 v[20:23], v255, s[36:39], s50 offen nt
    v_fmac_f32 v124, v208, v192
    v_fmac_f32 v125, v209, v193
    v_cvt_pk_bf16_f32 v24, v124, v125
    v_fmac_f32 v126, v210, v194
    v_fmac_f32 v127, v211, v195
    v_cvt_pk_bf16_f32 v25, v126, v127
    v_fmac_f32 v128, v212, v196
    v_fmac_f32 v129, v213, v197
    v_cvt_pk_bf16_f32 v26, v128, v129
    v_fmac_f32 v130, v214, v198
    v_fmac_f32 v131, v215, v199
    v_cvt_pk_bf16_f32 v27, v130, v131
    buffer_store_dwordx4 v[24:27], v255, s[36:39], s50 offen offset:1024 nt
    v_mfma_f32_32x32x16_bf16 v[116:131], v[72:75], v[28:31], 0
    s_waitcnt lgkmcnt(0)
    v_lshrrev_b32 v145, 24, v144
    v_and_b32 v144, 0xffffff, v144
    v_sub_u32 v112, 0x20001, v145
    v_mad_u64_u32 v[146:147], vcc, v112, s53, v[80:81]
    v_cmp_lt_u32 vcc, 127, v145
    v_mul_u32_u24 v145, 64, v145
    s_or_b64 s[72:73], s[72:73], vcc
    v_cmp_lt_u32 vcc, 0x7ffe, v144
    v_add_u32 v147, v147, v146
    s_or_b64 s[72:73], s[72:73], vcc
    v_cmp_lt_u32 vcc, v144, v145
    s_or_b64 s[72:73], s[72:73], vcc
    v_mfma_f32_32x32x16_bf16 v[116:131], v[76:79], v[32:35], v[116:131]
    s_andn2_b64 exec, -1, s[86:87]
    v_lshl_add_u64 v[132:133], v[132:133], 0, v[146:147]
    v_xor_b32 v132, s53, v132
    v_xor_b32 v133, s53, v133
    v_cvt_f32_i32_sdwa v144, sext(v132) dst_sel:DWORD dst_unused:UNUSED_PAD src0_sel:WORD_1
    v_cvt_f32_i32_sdwa v132, sext(v132) dst_sel:DWORD dst_unused:UNUSED_PAD src0_sel:WORD_0
    v_cvt_f32_i32_sdwa v145, sext(v133) dst_sel:DWORD dst_unused:UNUSED_PAD src0_sel:WORD_1
    v_cvt_f32_i32_sdwa v133, sext(v133) dst_sel:DWORD dst_unused:UNUSED_PAD src0_sel:WORD_0
    v_cvt_pk_bf16_f32 v132, v132, v144
    v_cvt_pk_bf16_f32 v133, v133, v145
    s_mov_b64 exec, -1
    v_mfma_f32_32x32x16_f16 v[184:199], v[68:71], v[104:107], 0
    s_andn2_b64 exec, -1, s[86:87]
    v_lshl_add_u64 v[134:135], v[134:135], 0, v[146:147]
    v_xor_b32 v134, s53, v134
    v_xor_b32 v135, s53, v135
    v_cvt_f32_i32_sdwa v144, sext(v134) dst_sel:DWORD dst_unused:UNUSED_PAD src0_sel:WORD_1
    v_cvt_f32_i32_sdwa v134, sext(v134) dst_sel:DWORD dst_unused:UNUSED_PAD src0_sel:WORD_0
    v_cvt_f32_i32_sdwa v145, sext(v135) dst_sel:DWORD dst_unused:UNUSED_PAD src0_sel:WORD_1
    v_cvt_f32_i32_sdwa v135, sext(v135) dst_sel:DWORD dst_unused:UNUSED_PAD src0_sel:WORD_0
    v_cvt_pk_bf16_f32 v134, v134, v144
    v_cvt_pk_bf16_f32 v135, v135, v145
    s_mov_b64 exec, -1
    v_mfma_f32_32x32x16_bf16 v[200:215], v[60:63], v[96:99], 0
    s_andn2_b64 exec, -1, s[86:87]
    v_lshl_add_u64 v[136:137], v[136:137], 0, v[146:147]
    v_xor_b32 v136, s53, v136
    v_xor_b32 v137, s53, v137
    v_cvt_f32_i32_sdwa v144, sext(v136) dst_sel:DWORD dst_unused:UNUSED_PAD src0_sel:WORD_1
    v_cvt_f32_i32_sdwa v136, sext(v136) dst_sel:DWORD dst_unused:UNUSED_PAD src0_sel:WORD_0
    v_cvt_f32_i32_sdwa v145, sext(v137) dst_sel:DWORD dst_unused:UNUSED_PAD src0_sel:WORD_1
    v_cvt_f32_i32_sdwa v137, sext(v137) dst_sel:DWORD dst_unused:UNUSED_PAD src0_sel:WORD_0
    v_cvt_pk_bf16_f32 v136, v136, v144
    v_cvt_pk_bf16_f32 v137, v137, v145
    s_mov_b64 exec, -1
    v_mfma_f32_32x32x16_bf16 v[200:215], v[64:67], v[100:103], v[200:215]
    s_andn2_b64 exec, -1, s[86:87]
    v_lshl_add_u64 v[138:139], v[138:139], 0, v[146:147]
    v_xor_b32 v138, s53, v138
    v_xor_b32 v139, s53, v139
    v_cvt_f32_i32_sdwa v144, sext(v138) dst_sel:DWORD dst_unused:UNUSED_PAD src0_sel:WORD_1
    v_cvt_f32_i32_sdwa v138, sext(v138) dst_sel:DWORD dst_unused:UNUSED_PAD src0_sel:WORD_0
    v_cvt_f32_i32_sdwa v145, sext(v139) dst_sel:DWORD dst_unused:UNUSED_PAD src0_sel:WORD_1
    v_cvt_f32_i32_sdwa v139, sext(v139) dst_sel:DWORD dst_unused:UNUSED_PAD src0_sel:WORD_0
    v_cvt_pk_bf16_f32 v138, v138, v144
    v_cvt_pk_bf16_f32 v139, v139, v145
    s_mov_b64 exec, -1
    ds_read_b32 v108, v155 offset:35264
    ds_read_b64 v[96:97], v244 offset:20480
    ds_read_b64 v[98:99], v244 offset:58016
    ds_read_b64 v[100:101], v245 offset:20480
    ds_read_b64 v[102:103], v245 offset:45504
    ds_read_b128 v[104:107], v92 offset:62560
    v_add_u32 v92, 8192, v92
    s_mov_b32 s50, 49152
    v_fmac_f32 v116, v200, v184
    v_fmac_f32 v117, v201, v185
    v_cvt_pk_bf16_f32 v28, v116, v117
    v_fmac_f32 v118, v202, v186
    v_fmac_f32 v119, v203, v187
    v_cvt_pk_bf16_f32 v29, v118, v119
    v_fmac_f32 v120, v204, v188
    v_fmac_f32 v121, v205, v189
    v_cvt_pk_bf16_f32 v30, v120, v121
    v_fmac_f32 v122, v206, v190
    v_fmac_f32 v123, v207, v191
    v_cvt_pk_bf16_f32 v31, v122, v123
    buffer_store_dwordx4 v[28:31], v255, s[36:39], s50 offen nt
    v_fmac_f32 v124, v208, v192
    v_fmac_f32 v125, v209, v193
    v_cvt_pk_bf16_f32 v32, v124, v125
    v_fmac_f32 v126, v210, v194
    v_fmac_f32 v127, v211, v195
    v_cvt_pk_bf16_f32 v33, v126, v127
    v_fmac_f32 v128, v212, v196
    v_fmac_f32 v129, v213, v197
    v_cvt_pk_bf16_f32 v34, v128, v129
    v_fmac_f32 v130, v214, v198
    v_fmac_f32 v131, v215, v199
    v_cvt_pk_bf16_f32 v35, v130, v131
    buffer_store_dwordx4 v[32:35], v255, s[36:39], s50 offen offset:1024 nt
    v_mfma_f32_32x32x16_bf16 v[116:131], v[72:75], v[36:39], 0
    s_waitcnt lgkmcnt(0)
    v_lshrrev_b32 v109, 24, v108
    v_and_b32 v108, 0xffffff, v108
    v_sub_u32 v112, 0x20001, v109
    v_mad_u64_u32 v[110:111], vcc, v112, s53, v[80:81]
    v_cmp_lt_u32 vcc, 127, v109
    v_mul_u32_u24 v109, 64, v109
    s_or_b64 s[74:75], s[74:75], vcc
    v_cmp_lt_u32 vcc, 0x7ffe, v108
    v_add_u32 v111, v111, v110
    s_or_b64 s[74:75], s[74:75], vcc
    v_cmp_lt_u32 vcc, v108, v109
    s_or_b64 s[74:75], s[74:75], vcc
    v_mfma_f32_32x32x16_bf16 v[116:131], v[76:79], v[40:43], v[116:131]
    s_andn2_b64 exec, -1, s[88:89]
    v_lshl_add_u64 v[96:97], v[96:97], 0, v[110:111]
    v_xor_b32 v96, s53, v96
    v_xor_b32 v97, s53, v97
    v_cvt_f32_i32_sdwa v108, sext(v96) dst_sel:DWORD dst_unused:UNUSED_PAD src0_sel:WORD_1
    v_cvt_f32_i32_sdwa v96, sext(v96) dst_sel:DWORD dst_unused:UNUSED_PAD src0_sel:WORD_0
    v_cvt_f32_i32_sdwa v109, sext(v97) dst_sel:DWORD dst_unused:UNUSED_PAD src0_sel:WORD_1
    v_cvt_f32_i32_sdwa v97, sext(v97) dst_sel:DWORD dst_unused:UNUSED_PAD src0_sel:WORD_0
    v_cvt_pk_bf16_f32 v96, v96, v108
    v_cvt_pk_bf16_f32 v97, v97, v109
    s_mov_b64 exec, -1
    v_mfma_f32_32x32x16_f16 v[184:199], v[68:71], v[140:143], 0
    s_andn2_b64 exec, -1, s[88:89]
    v_lshl_add_u64 v[98:99], v[98:99], 0, v[110:111]
    v_xor_b32 v98, s53, v98
    v_xor_b32 v99, s53, v99
    v_cvt_f32_i32_sdwa v108, sext(v98) dst_sel:DWORD dst_unused:UNUSED_PAD src0_sel:WORD_1
    v_cvt_f32_i32_sdwa v98, sext(v98) dst_sel:DWORD dst_unused:UNUSED_PAD src0_sel:WORD_0
    v_cvt_f32_i32_sdwa v109, sext(v99) dst_sel:DWORD dst_unused:UNUSED_PAD src0_sel:WORD_1
    v_cvt_f32_i32_sdwa v99, sext(v99) dst_sel:DWORD dst_unused:UNUSED_PAD src0_sel:WORD_0
    v_cvt_pk_bf16_f32 v98, v98, v108
    v_cvt_pk_bf16_f32 v99, v99, v109
    s_mov_b64 exec, -1
    v_mfma_f32_32x32x16_bf16 v[200:215], v[60:63], v[132:135], 0
    s_andn2_b64 exec, -1, s[88:89]
    v_lshl_add_u64 v[100:101], v[100:101], 0, v[110:111]
    v_xor_b32 v100, s53, v100
    v_xor_b32 v101, s53, v101
    v_cvt_f32_i32_sdwa v108, sext(v100) dst_sel:DWORD dst_unused:UNUSED_PAD src0_sel:WORD_1
    v_cvt_f32_i32_sdwa v100, sext(v100) dst_sel:DWORD dst_unused:UNUSED_PAD src0_sel:WORD_0
    v_cvt_f32_i32_sdwa v109, sext(v101) dst_sel:DWORD dst_unused:UNUSED_PAD src0_sel:WORD_1
    v_cvt_f32_i32_sdwa v101, sext(v101) dst_sel:DWORD dst_unused:UNUSED_PAD src0_sel:WORD_0
    v_cvt_pk_bf16_f32 v100, v100, v108
    v_cvt_pk_bf16_f32 v101, v101, v109
    s_mov_b64 exec, -1
    v_mfma_f32_32x32x16_bf16 v[200:215], v[64:67], v[136:139], v[200:215]
    s_andn2_b64 exec, -1, s[88:89]
    v_lshl_add_u64 v[102:103], v[102:103], 0, v[110:111]
    v_xor_b32 v102, s53, v102
    v_xor_b32 v103, s53, v103
    v_cvt_f32_i32_sdwa v108, sext(v102) dst_sel:DWORD dst_unused:UNUSED_PAD src0_sel:WORD_1
    v_cvt_f32_i32_sdwa v102, sext(v102) dst_sel:DWORD dst_unused:UNUSED_PAD src0_sel:WORD_0
    v_cvt_f32_i32_sdwa v109, sext(v103) dst_sel:DWORD dst_unused:UNUSED_PAD src0_sel:WORD_1
    v_cvt_f32_i32_sdwa v103, sext(v103) dst_sel:DWORD dst_unused:UNUSED_PAD src0_sel:WORD_0
    v_cvt_pk_bf16_f32 v102, v102, v108
    v_cvt_pk_bf16_f32 v103, v103, v109
    s_mov_b64 exec, -1
    v_mov_b32 v140, 0
    v_mov_b32 v141, 0
    v_mov_b32 v142, 0
    v_mov_b32 v143, 0
    v_mov_b32 v132, 0
    v_mov_b32 v133, 0
    v_mov_b32 v134, 0
    v_mov_b32 v135, 0
    v_mov_b32 v136, 0
    v_mov_b32 v137, 0
    v_mov_b32 v138, 0
    v_mov_b32 v139, 0
    v_mov_b32 v144, 0
    s_mov_b64 exec, s[60:61]
    ds_read_b32 v144, v155 offset:37312
    ds_read_b64 v[132:133], v244 offset:24576
    ds_read_b64 v[134:135], v244 offset:62112
    ds_read_b64 v[136:137], v245 offset:24576
    ds_read_b64 v[138:139], v245 offset:49600
    ds_read_b128 v[140:143], v92 offset:62560
    s_mov_b64 exec, -1
    s_mov_b32 s50, 65536
    v_fmac_f32 v116, v200, v184
    v_fmac_f32 v117, v201, v185
    v_cvt_pk_bf16_f32 v36, v116, v117
    v_fmac_f32 v118, v202, v186
    v_fmac_f32 v119, v203, v187
    v_cvt_pk_bf16_f32 v37, v118, v119
    v_fmac_f32 v120, v204, v188
    v_fmac_f32 v121, v205, v189
    v_cvt_pk_bf16_f32 v38, v120, v121
    v_fmac_f32 v122, v206, v190
    v_fmac_f32 v123, v207, v191
    v_cvt_pk_bf16_f32 v39, v122, v123
    buffer_store_dwordx4 v[36:39], v255, s[36:39], s50 offen nt
    v_fmac_f32 v124, v208, v192
    v_fmac_f32 v125, v209, v193
    v_cvt_pk_bf16_f32 v40, v124, v125
    v_fmac_f32 v126, v210, v194
    v_fmac_f32 v127, v211, v195
    v_cvt_pk_bf16_f32 v41, v126, v127
    v_fmac_f32 v128, v212, v196
    v_fmac_f32 v129, v213, v197
    v_cvt_pk_bf16_f32 v42, v128, v129
    v_fmac_f32 v130, v214, v198
    v_fmac_f32 v131, v215, v199
    v_cvt_pk_bf16_f32 v43, v130, v131
    buffer_store_dwordx4 v[40:43], v255, s[36:39], s50 offen offset:1024 nt
    s_waitcnt vmcnt(12)
    v_mfma_f32_32x32x16_bf16 v[116:131], v[72:75], v[44:47], 0
    v_mfma_f32_32x32x16_bf16 v[116:131], v[76:79], v[48:51], v[116:131]
    v_mfma_f32_32x32x16_f16 v[184:199], v[68:71], v[104:107], 0
    v_mfma_f32_32x32x16_bf16 v[200:215], v[60:63], v[96:99], 0
    v_mfma_f32_32x32x16_bf16 v[200:215], v[64:67], v[100:103], v[200:215]
    s_mov_b32 s50, 81920
    s_nop 10
    v_fmac_f32 v116, v200, v184
    v_fmac_f32 v117, v201, v185
    v_cvt_pk_bf16_f32 v44, v116, v117
    v_fmac_f32 v118, v202, v186
    v_fmac_f32 v119, v203, v187
    v_cvt_pk_bf16_f32 v45, v118, v119
    v_fmac_f32 v120, v204, v188
    v_fmac_f32 v121, v205, v189
    v_cvt_pk_bf16_f32 v46, v120, v121
    v_fmac_f32 v122, v206, v190
    v_fmac_f32 v123, v207, v191
    v_cvt_pk_bf16_f32 v47, v122, v123
    buffer_store_dwordx4 v[44:47], v255, s[36:39], s50 offen nt
    v_fmac_f32 v124, v208, v192
    v_fmac_f32 v125, v209, v193
    v_cvt_pk_bf16_f32 v48, v124, v125
    v_fmac_f32 v126, v210, v194
    v_fmac_f32 v127, v211, v195
    v_cvt_pk_bf16_f32 v49, v126, v127
    v_fmac_f32 v128, v212, v196
    v_fmac_f32 v129, v213, v197
    v_cvt_pk_bf16_f32 v50, v128, v129
    v_fmac_f32 v130, v214, v198
    v_fmac_f32 v131, v215, v199
    v_cvt_pk_bf16_f32 v51, v130, v131
    buffer_store_dwordx4 v[48:51], v255, s[36:39], s50 offen offset:1024 nt
    s_cmp_lg_u32 s48, 0
    s_cbranch_scc1 Lk2_e6
    s_waitcnt lgkmcnt(0)
    v_lshrrev_b32 v145, 24, v144
    v_and_b32 v144, 0xffffff, v144
    v_sub_u32 v112, 0x20001, v145
    v_mad_u64_u32 v[146:147], vcc, v112, s53, v[80:81]
    v_cmp_lt_u32 vcc, 127, v145
    v_mul_u32_u24 v145, 64, v145
    s_or_b64 s[76:77], s[76:77], vcc
    v_cmp_lt_u32 vcc, 0x7ffe, v144
    v_add_u32 v147, v147, v146
    s_or_b64 s[76:77], s[76:77], vcc
    v_cmp_lt_u32 vcc, v144, v145
    s_or_b64 s[76:77], s[76:77], vcc
    s_andn2_b64 exec, -1, s[90:91]
    v_lshl_add_u64 v[132:133], v[132:133], 0, v[146:147]
    v_xor_b32 v132, s53, v132
    v_xor_b32 v133, s53, v133
    v_cvt_f32_i32_sdwa v144, sext(v132) dst_sel:DWORD dst_unused:UNUSED_PAD src0_sel:WORD_1
    v_cvt_f32_i32_sdwa v132, sext(v132) dst_sel:DWORD dst_unused:UNUSED_PAD src0_sel:WORD_0
    v_cvt_f32_i32_sdwa v145, sext(v133) dst_sel:DWORD dst_unused:UNUSED_PAD src0_sel:WORD_1
    v_cvt_f32_i32_sdwa v133, sext(v133) dst_sel:DWORD dst_unused:UNUSED_PAD src0_sel:WORD_0
    v_cvt_pk_bf16_f32 v132, v132, v144
    v_cvt_pk_bf16_f32 v133, v133, v145
    s_mov_b64 exec, -1
    s_andn2_b64 exec, -1, s[90:91]
    v_lshl_add_u64 v[134:135], v[134:135], 0, v[146:147]
    v_xor_b32 v134, s53, v134
    v_xor_b32 v135, s53, v135
    v_cvt_f32_i32_sdwa v144, sext(v134) dst_sel:DWORD dst_unused:UNUSED_PAD src0_sel:WORD_1
    v_cvt_f32_i32_sdwa v134, sext(v134) dst_sel:DWORD dst_unused:UNUSED_PAD src0_sel:WORD_0
    v_cvt_f32_i32_sdwa v145, sext(v135) dst_sel:DWORD dst_unused:UNUSED_PAD src0_sel:WORD_1
    v_cvt_f32_i32_sdwa v135, sext(v135) dst_sel:DWORD dst_unused:UNUSED_PAD src0_sel:WORD_0
    v_cvt_pk_bf16_f32 v134, v134, v144
    v_cvt_pk_bf16_f32 v135, v135, v145
    s_mov_b64 exec, -1
    s_andn2_b64 exec, -1, s[90:91]
    v_lshl_add_u64 v[136:137], v[136:137], 0, v[146:147]
    v_xor_b32 v136, s53, v136
    v_xor_b32 v137, s53, v137
    v_cvt_f32_i32_sdwa v144, sext(v136) dst_sel:DWORD dst_unused:UNUSED_PAD src0_sel:WORD_1
    v_cvt_f32_i32_sdwa v136, sext(v136) dst_sel:DWORD dst_unused:UNUSED_PAD src0_sel:WORD_0
    v_cvt_f32_i32_sdwa v145, sext(v137) dst_sel:DWORD dst_unused:UNUSED_PAD src0_sel:WORD_1
    v_cvt_f32_i32_sdwa v137, sext(v137) dst_sel:DWORD dst_unused:UNUSED_PAD src0_sel:WORD_0
    v_cvt_pk_bf16_f32 v136, v136, v144
    v_cvt_pk_bf16_f32 v137, v137, v145
    s_mov_b64 exec, -1
    s_andn2_b64 exec, -1, s[90:91]
    v_lshl_add_u64 v[138:139], v[138:139], 0, v[146:147]
    v_xor_b32 v138, s53, v138
    v_xor_b32 v139, s53, v139
    v_cvt_f32_i32_sdwa v144, sext(v138) dst_sel:DWORD dst_unused:UNUSED_PAD src0_sel:WORD_1
    v_cvt_f32_i32_sdwa v138, sext(v138) dst_sel:DWORD dst_unused:UNUSED_PAD src0_sel:WORD_0
    v_cvt_f32_i32_sdwa v145, sext(v139) dst_sel:DWORD dst_unused:UNUSED_PAD src0_sel:WORD_1
    v_cvt_f32_i32_sdwa v139, sext(v139) dst_sel:DWORD dst_unused:UNUSED_PAD src0_sel:WORD_0
    v_cvt_pk_bf16_f32 v138, v138, v144
    v_cvt_pk_bf16_f32 v139, v139, v145
    s_mov_b64 exec, -1
    s_waitcnt vmcnt(12)
    v_mfma_f32_32x32x16_bf16 v[116:131], v[72:75], v[52:55], 0
    v_mfma_f32_32x32x16_bf16 v[116:131], v[76:79], v[56:59], v[116:131]
    v_mfma_f32_32x32x16_f16 v[184:199], v[68:71], v[140:143], 0
    v_mfma_f32_32x32x16_bf16 v[200:215], v[60:63], v[132:135], 0
    v_mfma_f32_32x32x16_bf16 v[200:215], v[64:67], v[136:139], v[200:215]
    s_mov_b32 s50, 98304
    s_nop 10
    v_fmac_f32 v116, v200, v184
    v_fmac_f32 v117, v201, v185
    v_cvt_pk_bf16_f32 v52, v116, v117
    v_fmac_f32 v118, v202, v186
    v_fmac_f32 v119, v203, v187
    v_cvt_pk_bf16_f32 v53, v118, v119
    v_fmac_f32 v120, v204, v188
    v_fmac_f32 v121, v205, v189
    v_cvt_pk_bf16_f32 v54, v120, v121
    v_fmac_f32 v122, v206, v190
    v_fmac_f32 v123, v207, v191
    v_cvt_pk_bf16_f32 v55, v122, v123
    buffer_store_dwordx4 v[52:55], v255, s[36:39], s50 offen nt
    v_fmac_f32 v124, v208, v192
    v_fmac_f32 v125, v209, v193
    v_cvt_pk_bf16_f32 v56, v124, v125
    v_fmac_f32 v126, v210, v194
    v_fmac_f32 v127, v211, v195
    v_cvt_pk_bf16_f32 v57, v126, v127
    v_fmac_f32 v128, v212, v196
    v_fmac_f32 v129, v213, v197
    v_cvt_pk_bf16_f32 v58, v128, v129
    v_fmac_f32 v130, v214, v198
    v_fmac_f32 v131, v215, v199
    v_cvt_pk_bf16_f32 v59, v130, v131
    buffer_store_dwordx4 v[56:59], v255, s[36:39], s50 offen offset:1024 nt
Lk2_e6:
    s_cmp_lg_u32 s57, 0
    s_cbranch_scc1 Lk2_end
    s_or_b64 s[62:63], s[64:65], s[66:67]
    s_or_b64 s[62:63], s[62:63], s[68:69]
    s_or_b64 s[62:63], s[62:63], s[70:71]
    s_or_b64 s[62:63], s[62:63], s[72:73]
    s_or_b64 s[62:63], s[62:63], s[74:75]
    s_or_b64 s[62:63], s[62:63], s[76:77]
    s_cselect_b32 s50, 1, 0
    v_cmp_gt_i32 vcc, 0, v249
    s_cmp_lg_u64 vcc, 0
    s_cselect_b32 s50, 3, s50
    v_mov_b32 v2, s50
    s_lshl_b32 s50, s48, 2
    s_add_u32 s50, s50, 162656
    v_mov_b32 v3, s50
    ds_write_b32 v3, v2
    v_and_b32 v2, 7, v0
    v_lshlrev_b32 v2, 2, v2
    v_add_u32 v2, 162656, v2
    s_waitcnt lgkmcnt(0)
    s_barrier
    ds_read_b32 v3, v2
    s_waitcnt lgkmcnt(0)
    v_cmp_ne_u32 vcc, 0, v3
    s_cmp_eq_u64 vcc, 0
    s_cbranch_scc1 Lk2_end
    v_cmp_lt_u32 vcc, 1, v3
    s_cmp_lg_u64 vcc, 0
Lk2_all:
    s_cselect_b64 s[78:79], -1, s[64:65]
    s_cselect_b64 s[80:81], -1, s[66:67]
    s_cselect_b64 s[82:83], -1, s[68:69]
    s_cselect_b64 s[84:85], -1, s[70:71]
    s_cselect_b64 s[86:87], -1, s[72:73]
    s_cselect_b64 s[88:89], -1, s[74:75]
    s_cselect_b64 s[90:91], -1, s[76:77]
    s_and_b64 s[90:91], s[90:91], s[60:61]
    s_waitcnt vmcnt(0)
    v_lshlrev_b32 v18, 12, v0
    s_lshl_b32 s50, s49, 4
    s_add_u32 s50, s50, 82837504
    buffer_load_dwordx4 v[4:7], v18, s[24:27], s50 offen
    v_lshlrev_b32 v244, 3, v0
    v_lshlrev_b32 v155, 2, v0
    v_add_u32 v245, 112608, v244
    v_mov_b32 v2, 0
    v_mov_b32 v3, 0
    v_mov_b32 v19, -1
    s_mov_b64 exec, s[78:79]
    ds_write_b32 v155, v19 offset:25024
    ds_write_b64 v244, v[2:3] offset:0
    ds_write_b64 v244, v[2:3] offset:37536
    ds_write_b64 v245, v[2:3] offset:0
    ds_write_b64 v245, v[2:3] offset:25024
    s_mov_b64 exec, -1
    s_waitcnt lgkmcnt(0)
    s_mov_b64 exec, s[80:81]
    ds_write_b32 v155, v19 offset:27072
    ds_write_b64 v244, v[2:3] offset:4096
    ds_write_b64 v244, v[2:3] offset:41632
    ds_write_b64 v245, v[2:3] offset:4096
    ds_write_b64 v245, v[2:3] offset:29120
    s_mov_b64 exec, -1
    s_waitcnt lgkmcnt(0)
    s_mov_b64 exec, s[82:83]
    ds_write_b32 v155, v19 offset:29120
    ds_write_b64 v244, v[2:3] offset:8192
    ds_write_b64 v244, v[2:3] offset:45728
    ds_write_b64 v245, v[2:3] offset:8192
    ds_write_b64 v245, v[2:3] offset:33216
    s_mov_b64 exec, -1
    s_waitcnt lgkmcnt(0)
    s_mov_b64 exec, s[84:85]
    ds_write_b32 v155, v19 offset:31168
    ds_write_b64 v244, v[2:3] offset:12288
    ds_write_b64 v244, v[2:3] offset:49824
    ds_write_b64 v245, v[2:3] offset:12288
    ds_write_b64 v245, v[2:3] offset:37312
    s_mov_b64 exec, -1
    s_waitcnt lgkmcnt(0)
    s_mov_b64 exec, s[86:87]
    ds_write_b32 v155, v19 offset:33216
    ds_write_b64 v244, v[2:3] offset:16384
    ds_write_b64 v244, v[2:3] offset:53920
    ds_write_b64 v245, v[2:3] offset:16384
    ds_write_b64 v245, v[2:3] offset:41408
    s_mov_b64 exec, -1
    s_waitcnt lgkmcnt(0)
    s_mov_b64 exec, s[88:89]
    ds_write_b32 v155, v19 offset:35264
    ds_write_b64 v244, v[2:3] offset:20480
    ds_write_b64 v244, v[2:3] offset:58016
    ds_write_b64 v245, v[2:3] offset:20480
    ds_write_b64 v245, v[2:3] offset:45504
    s_mov_b64 exec, -1
    s_waitcnt lgkmcnt(0)
    s_mov_b64 exec, s[90:91]
    ds_write_b32 v155, v19 offset:37312
    ds_write_b64 v244, v[2:3] offset:24576
    ds_write_b64 v244, v[2:3] offset:62112
    ds_write_b64 v245, v[2:3] offset:24576
    ds_write_b64 v245, v[2:3] offset:49600
    s_mov_b64 exec, -1
    s_waitcnt lgkmcnt(0)
    s_barrier
    s_movk_i32 s50, 1024
    v_mov_b32 v17, 13248
    v_mad_u32_u24 v17, v0, v17, s50
    s_waitcnt vmcnt(0)
    v_and_b32 v4, 0x7fffffff, v4
    v_add_u32 v8, 0x10000, v4
    v_and_b32 v4, 0xffff, v4
    v_lshrrev_b32 v8, 17, v8
    v_and_b32 v5, 0x7fffffff, v5
    v_add_u32 v9, 0x10000, v5
    v_and_b32 v5, 0xffff, v5
    v_lshrrev_b32 v9, 17, v9
    v_and_b32 v6, 0x7fffffff, v6
    v_add_u32 v10, 0x10000, v6
    v_and_b32 v6, 0xffff, v6
    v_lshrrev_b32 v10, 17, v10
    v_and_b32 v7, 0x7fffffff, v7
    v_add_u32 v11, 0x10000, v7
    v_and_b32 v7, 0xffff, v7
    v_lshrrev_b32 v11, 17, v11
    v_add_u32_dpp v8, v8, v8 row_shr:1 row_mask:0xf bank_mask:0xf
    v_add_u32_dpp v9, v9, v9 row_shr:1 row_mask:0xf bank_mask:0xf
    v_add_u32_dpp v10, v10, v10 row_shr:1 row_mask:0xf bank_mask:0xf
    v_add_u32_dpp v11, v11, v11 row_shr:1 row_mask:0xf bank_mask:0xf
    v_add_u32_dpp v8, v8, v8 row_shr:2 row_mask:0xf bank_mask:0xf
    v_add_u32_dpp v9, v9, v9 row_shr:2 row_mask:0xf bank_mask:0xf
    v_add_u32_dpp v10, v10, v10 row_shr:2 row_mask:0xf bank_mask:0xf
    v_add_u32_dpp v11, v11, v11 row_shr:2 row_mask:0xf bank_mask:0xf
    v_add_u32_dpp v8, v8, v8 row_shr:4 row_mask:0xf bank_mask:0xf
    v_add_u32_dpp v9, v9, v9 row_shr:4 row_mask:0xf bank_mask:0xf
    v_add_u32_dpp v10, v10, v10 row_shr:4 row_mask:0xf bank_mask:0xf
    v_add_u32_dpp v11, v11, v11 row_shr:4 row_mask:0xf bank_mask:0xf
    v_add_u32_dpp v8, v8, v8 row_shr:8 row_mask:0xf bank_mask:0xf
    v_add_u32_dpp v9, v9, v9 row_shr:8 row_mask:0xf bank_mask:0xf
    v_add_u32_dpp v10, v10, v10 row_shr:8 row_mask:0xf bank_mask:0xf
    v_add_u32_dpp v11, v11, v11 row_shr:8 row_mask:0xf bank_mask:0xf
    v_add_u32_dpp v8, v8, v8 row_bcast:15 row_mask:0xa bank_mask:0xf
    v_add_u32_dpp v9, v9, v9 row_bcast:15 row_mask:0xa bank_mask:0xf
    v_add_u32_dpp v10, v10, v10 row_bcast:15 row_mask:0xa bank_mask:0xf
    v_add_u32_dpp v11, v11, v11 row_bcast:15 row_mask:0xa bank_mask:0xf
    v_add_u32_dpp v8, v8, v8 row_bcast:31 row_mask:0xc bank_mask:0xf
    v_add_u32_dpp v9, v9, v9 row_bcast:31 row_mask:0xc bank_mask:0xf
    v_add_u32_dpp v10, v10, v10 row_bcast:31 row_mask:0xc bank_mask:0xf
    v_add_u32_dpp v11, v11, v11 row_bcast:31 row_mask:0xc bank_mask:0xf
    v_add_u32 v4, v4, v17
    v_readlane_b32 s9, v8, 63
    v_sub_u32 v4, v4, v8
    v_mul_lo_u32 v4, v4, 12
    v_add_u32 v9, s9, v9
    v_add_u32 v5, v5, v17
    v_readlane_b32 s9, v9, 63
    v_sub_u32 v5, v5, v9
    v_mul_lo_u32 v5, v5, 12
    v_add_u32 v10, s9, v10
    v_add_u32 v6, v6, v17
    v_readlane_b32 s9, v10, 63
    v_sub_u32 v6, v6, v10
    v_mul_lo_u32 v6, v6, 12
    v_add_u32 v11, s9, v11
    v_add_u32 v7, v7, v17
    v_readlane_b32 s9, v11, 63
    v_sub_u32 v7, v7, v11
    v_mul_lo_u32 v7, v7, 12
    v_mul_u32_u24 v17, 12, v1
    s_mov_b32 s4, 0
    s_mov_b32 s5, 0
    s_mov_b32 s6, 0
    s_movk_i32 s7, -64
Lk2_sl:
    s_cmp_ge_u32 s4, s9
    s_cbranch_scc1 Lk2_sd
    v_add_u32 v16, s6, v17
    s_sub_u32 s8, s5, s4
    s_cmp_ge_u32 s8, 64
    s_cbranch_scc1 Lfd
Lfl:
    v_readlane_b32 s6, v4, s7
    v_readlane_b32 s5, v8, s7
    s_add_u32 s7, s7, 1
    s_cbranch_scc0 Lfc
    s_mov_b64 exec, -1
    v_mov_b32 v8, v9
    v_mov_b32 v4, v5
    v_mov_b32 v9, v10
    v_mov_b32 v5, v6
    v_mov_b32 v10, v11
    v_mov_b32 v6, v7
    v_mov_b32 v11, -1
    v_bfrev_b32 v7, 1
    s_movk_i32 s7, -64
Lfc:
    s_lshl_b64 exec, -1, s8
    v_add_u32 v16, s6, v17
    s_sub_u32 s8, s5, s4
    s_cmp_lt_u32 s8, 64
    s_cbranch_scc1 Lfl
    s_mov_b64 exec, -1
Lfd:
    s_add_u32 s4, s4, 64
    v_add_u32 v17, 768, v17
    buffer_load_dwordx3 v[12:14], v16, s[24:27], 0 offen
    s_mov_b32 s10, 0
    s_waitcnt vmcnt(0)
Lk2_s2:
    v_cmp_gt_i32 s[62:63], 0, v13
    v_ashrrev_i32 v251, 31, v13
    v_and_b32 v12, v12, v251
    v_and_b32 v236, s54, v12
    v_and_b32 v238, s54, v12
    v_lshrrev_b32 v240, 16, v12
    v_and_b32 v240, s56, v240
    v_and_b32 v242, s55, v13
    v_permlane32_swap_b32 v236, v238
    v_lshrrev_b32 v244, 1, v240
    v_lshrrev_b32 v155, 2, v240
    v_add_u32 v245, 112608, v244
    ds_read_b32 v246, v155 offset:25024
    ds_read_b128 v[232:235], v240 offset:62560
    s_waitcnt lgkmcnt(0)
    v_cmp_gt_i32 vcc, 0, v246
    s_and_b64 s[62:63], s[62:63], vcc
    s_cbranch_scc0 Lk2_s3
    buffer_load_dwordx4 v[156:159], v[236:237], s[16:19], 0 idxen offen
    buffer_load_dwordx4 v[160:163], v[238:239], s[16:19], 0 idxen offen
    v_mul_f32 v252, 0x40400000, v242
    v_mul_f32 v251, 0.15915494, v242
    v_cvt_pk_bf16_f32 v252, 0, v252
    v_fract_f32 v251, v251
    v_mul_f32 v252, 0.15915494, v252
    v_cos_f32 v251, v251
    v_fract_f32 v252, v252
    v_cos_f32 v252, v252
    v_fma_mixlo_f16 v253, v251, v251, -0.5
    v_cvt_pk_f16_f32 v251, v251, v252
    v_pk_mul_f16 v224, v232, v251 op_sel:[0,0] op_sel_hi:[1,0]
    v_pk_mul_f16 v225, v233, v251 op_sel:[0,0] op_sel_hi:[1,0]
    v_pk_mul_f16 v226, v234, v251 op_sel:[0,0] op_sel_hi:[1,0]
    v_pk_mul_f16 v227, v235, v251 op_sel:[0,0] op_sel_hi:[1,0]
    s_nop 1
    v_mfma_f32_32x32x16_f16 v[184:199], v[164:167], v[224:227], 0
    v_pk_mul_f16 v228, v232, v253 op_sel:[0,0] op_sel_hi:[1,0]
    v_pk_mul_f16 v229, v233, v253 op_sel:[0,0] op_sel_hi:[1,0]
    v_pk_mul_f16 v230, v234, v253 op_sel:[0,0] op_sel_hi:[1,0]
    v_pk_mul_f16 v231, v235, v253 op_sel:[0,0] op_sel_hi:[1,0]
    s_nop 1
    v_mfma_f32_32x32x16_f16 v[184:199], v[168:171], v[228:231], v[184:199]
    v_pk_mul_f16 v224, v232, v251 op_sel:[0,1] op_sel_hi:[1,1]
    v_pk_mul_f16 v225, v233, v251 op_sel:[0,1] op_sel_hi:[1,1]
    v_pk_mul_f16 v226, v234, v251 op_sel:[0,1] op_sel_hi:[1,1]
    v_pk_mul_f16 v227, v235, v251 op_sel:[0,1] op_sel_hi:[1,1]
    s_nop 1
    v_mfma_f32_32x32x16_f16 v[184:199], v[172:175], v[224:227], v[184:199]
    s_waitcnt vmcnt(0)
    v_mfma_f32_32x32x16_bf16 v[200:215], v[176:179], v[156:159], 0
    v_mfma_f32_32x32x16_bf16 v[200:215], v[180:183], v[160:163], v[200:215]
    s_nop 8
    v_mul_f32 v184, 0x47800000, v184
    s_nop 1
    v_mul_f32 v200, v200, v184
    v_mul_f32 v185, 0x47800000, v185
    v_mul_f32 v201, v201, v185
    v_mul_f32 v186, 0x47800000, v186
    v_mul_f32 v202, v202, v186
    v_mul_f32 v187, 0x47800000, v187
    v_mul_f32 v203, v203, v187
    v_mul_f32 v188, 0x47800000, v188
    v_mul_f32 v204, v204, v188
    v_mul_f32 v189, 0x47800000, v189
    v_mul_f32 v205, v205, v189
    v_mul_f32 v190, 0x47800000, v190
    v_mul_f32 v206, v206, v190
    v_mul_f32 v191, 0x47800000, v191
    v_mul_f32 v207, v207, v191
    v_mul_f32 v192, 0x47800000, v192
    v_mul_f32 v208, v208, v192
    v_mul_f32 v193, 0x47800000, v193
    v_mul_f32 v209, v209, v193
    v_mul_f32 v194, 0x47800000, v194
    v_mul_f32 v210, v210, v194
    v_mul_f32 v195, 0x47800000, v195
    v_mul_f32 v211, v211, v195
    v_mul_f32 v196, 0x47800000, v196
    v_mul_f32 v212, v212, v196
    v_mul_f32 v197, 0x47800000, v197
    v_mul_f32 v213, v213, v197
    v_mul_f32 v198, 0x47800000, v198
    v_mul_f32 v214, v214, v198
    v_mul_f32 v199, 0x47800000, v199
    v_mul_f32 v215, v215, v199
    s_mov_b64 exec, s[62:63]
    v_cvt_pk_bf16_f32 v200, v200, v201
    ds_pk_add_bf16 v244, v200 offset:0
    v_cvt_pk_bf16_f32 v202, v202, v203
    ds_pk_add_bf16 v244, v202 offset:4
    v_cvt_pk_bf16_f32 v204, v204, v205
    ds_pk_add_bf16 v244, v204 offset:37536
    v_cvt_pk_bf16_f32 v206, v206, v207
    ds_pk_add_bf16 v244, v206 offset:37540
    v_cvt_pk_bf16_f32 v208, v208, v209
    ds_pk_add_bf16 v245, v208 offset:0
    v_cvt_pk_bf16_f32 v210, v210, v211
    ds_pk_add_bf16 v245, v210 offset:4
    v_cvt_pk_bf16_f32 v212, v212, v213
    ds_pk_add_bf16 v245, v212 offset:25024
    v_cvt_pk_bf16_f32 v214, v214, v215
    ds_pk_add_bf16 v245, v214 offset:25028
    s_mov_b64 exec, -1
Lk2_s3:
    v_mov_b32 v12, v14
    v_lshlrev_b32 v13, 16, v13
    s_xor_b32 s10, s10, 1
    s_cbranch_scc1 Lk2_s2
    s_branch Lk2_sl
Lk2_sd:
    s_mov_b32 s57, 1
    v_lshlrev_b32 v2, 4, v1
    s_mov_b32 s50, 85988352
    buffer_load_dwordx4 v[60:63], v2, s[24:27], s50 offen
    s_mov_b32 s50, 85989376
    buffer_load_dwordx4 v[64:67], v2, s[24:27], s50 offen
    s_mov_b32 s50, 85990400
    buffer_load_dwordx4 v[68:71], v2, s[24:27], s50 offen
    s_mov_b32 s50, 0
    buffer_load_dwordx4 v[4:7], v255, s[32:35], s50 offen
    buffer_load_dwordx4 v[8:11], v255, s[32:35], s50 offen offset:1024
    s_mov_b32 s50, 16384
    buffer_load_dwordx4 v[12:15], v255, s[32:35], s50 offen
    buffer_load_dwordx4 v[16:19], v255, s[32:35], s50 offen offset:1024
    s_mov_b32 s50, 32768
    buffer_load_dwordx4 v[20:23], v255, s[32:35], s50 offen
    buffer_load_dwordx4 v[24:27], v255, s[32:35], s50 offen offset:1024
    s_mov_b32 s50, 49152
    buffer_load_dwordx4 v[28:31], v255, s[32:35], s50 offen
    buffer_load_dwordx4 v[32:35], v255, s[32:35], s50 offen offset:1024
    s_mov_b32 s50, 65536
    buffer_load_dwordx4 v[36:39], v255, s[32:35], s50 offen
    buffer_load_dwordx4 v[40:43], v255, s[32:35], s50 offen offset:1024
    v_mov_b32 v80, 0
    v_mov_b32 v81, 0xfffeffff
    v_bfe_u32 v2, v0, 2, 1
    v_bfe_u32 v3, v0, 5, 1
    v_and_b32 v82, 1, v0
    v_lshlrev_b32 v82, 4, v82
    v_mov_b32 v83, 0x3f80
    v_lshlrev_b32 v82, v82, v83
    v_bfe_u32 v83, v0, 3, 2
    v_xor_b32 v2, v2, v3
    v_bfe_u32 v3, v0, 1, 1
    v_lshl_or_b32 v83, v83, 1, v3
    v_lshl_or_b32 v83, v2, 3, v83
    v_mov_b32 v72, 0
    v_cmpx_eq_u32 vcc, 0, v83
    v_mov_b32 v72, v82
    s_mov_b64 exec, -1
    v_mov_b32 v73, 0
    v_cmpx_eq_u32 vcc, 1, v83
    v_mov_b32 v73, v82
    s_mov_b64 exec, -1
    v_mov_b32 v74, 0
    v_cmpx_eq_u32 vcc, 2, v83
    v_mov_b32 v74, v82
    s_mov_b64 exec, -1
    v_mov_b32 v75, 0
    v_cmpx_eq_u32 vcc, 3, v83
    v_mov_b32 v75, v82
    s_mov_b64 exec, -1
    v_mov_b32 v76, 0
    v_cmpx_eq_u32 vcc, 4, v83
    v_mov_b32 v76, v82
    s_mov_b64 exec, -1
    v_mov_b32 v77, 0
    v_cmpx_eq_u32 vcc, 5, v83
    v_mov_b32 v77, v82
    s_mov_b64 exec, -1
    v_mov_b32 v78, 0
    v_cmpx_eq_u32 vcc, 6, v83
    v_mov_b32 v78, v82
    s_mov_b64 exec, -1
    v_mov_b32 v79, 0
    v_cmpx_eq_u32 vcc, 7, v83
    v_mov_b32 v79, v82
    s_mov_b64 exec, -1
    s_waitcnt vmcnt(0)
    s_branch Lk2_epi
Lk2_fb:
    s_mov_b32 s58, 1
    v_lshlrev_b32 v234, 1, v0
    s_movk_i32 s50, 0
    buffer_load_ushort v244, v234, s[28:31], s50 offen
    s_movk_i32 s50, 1024
    buffer_load_ushort v245, v234, s[28:31], s50 offen
    s_movk_i32 s50, 2048
    buffer_load_ushort v248, v234, s[28:31], s50 offen
    s_movk_i32 s50, 3072
    buffer_load_ushort v251, v234, s[28:31], s50 offen
    s_movk_i32 s50, 4096
    buffer_load_ushort v246, v234, s[28:31], s50 offen
    s_movk_i32 s50, 5120
    buffer_load_ushort v247, v234, s[28:31], s50 offen
    s_movk_i32 s50, 6144
    buffer_load_ushort v250, v234, s[28:31], s50 offen
    s_waitcnt vmcnt(0)
    v_lshlrev_b32 v224, 16, v244
    v_mul_f32 v224, s69, v224
    v_subrev_f32 v216, s40, v224
    v_subrev_f32 v217, s41, v224
    v_subrev_f32 v218, s42, v224
    v_subrev_f32 v219, s43, v224
    v_subrev_f32 v220, s44, v224
    v_subrev_f32 v221, s45, v224
    v_subrev_f32 v222, s46, v224
    v_subrev_f32 v223, s47, v224
    v_mul_f32 v216, v216, v216
    v_mul_f32 v217, v217, v217
    v_mul_f32 v218, v218, v218
    v_mul_f32 v219, v219, v219
    v_mul_f32 v220, v220, v220
    v_mul_f32 v221, v221, v221
    v_mul_f32 v222, v222, v222
    v_mul_f32 v223, v223, v223
    v_exp_f32 v216, -v216
    v_exp_f32 v217, -v217
    v_exp_f32 v218, -v218
    v_exp_f32 v219, -v219
    v_exp_f32 v220, -v220
    v_exp_f32 v221, -v221
    v_exp_f32 v222, -v222
    v_exp_f32 v223, -v223
    v_cvt_pk_f16_f32 v164, v216, v217
    v_cvt_pk_f16_f32 v165, v218, v219
    v_cvt_pk_f16_f32 v166, v220, v221
    v_cvt_pk_f16_f32 v167, v222, v223
    v_lshlrev_b32 v224, 16, v245
    v_mul_f32 v224, s69, v224
    v_subrev_f32 v216, s40, v224
    v_subrev_f32 v217, s41, v224
    v_subrev_f32 v218, s42, v224
    v_subrev_f32 v219, s43, v224
    v_subrev_f32 v220, s44, v224
    v_subrev_f32 v221, s45, v224
    v_subrev_f32 v222, s46, v224
    v_subrev_f32 v223, s47, v224
    v_mul_f32 v216, v216, v216
    v_mul_f32 v217, v217, v217
    v_mul_f32 v218, v218, v218
    v_mul_f32 v219, v219, v219
    v_mul_f32 v220, v220, v220
    v_mul_f32 v221, v221, v221
    v_mul_f32 v222, v222, v222
    v_mul_f32 v223, v223, v223
    v_exp_f32 v216, -v216
    v_exp_f32 v217, -v217
    v_exp_f32 v218, -v218
    v_exp_f32 v219, -v219
    v_exp_f32 v220, -v220
    v_exp_f32 v221, -v221
    v_exp_f32 v222, -v222
    v_exp_f32 v223, -v223
    v_cvt_pk_f16_f32 v168, v216, v217
    v_cvt_pk_f16_f32 v169, v218, v219
    v_cvt_pk_f16_f32 v170, v220, v221
    v_cvt_pk_f16_f32 v171, v222, v223
    v_lshlrev_b32 v224, 16, v248
    v_mul_f32 v224, s69, v224
    v_subrev_f32 v216, s40, v224
    v_subrev_f32 v217, s41, v224
    v_subrev_f32 v218, s42, v224
    v_subrev_f32 v219, s43, v224
    v_subrev_f32 v220, s44, v224
    v_subrev_f32 v221, s45, v224
    v_subrev_f32 v222, s46, v224
    v_subrev_f32 v223, s47, v224
    v_mul_f32 v216, v216, v216
    v_mul_f32 v217, v217, v217
    v_mul_f32 v218, v218, v218
    v_mul_f32 v219, v219, v219
    v_mul_f32 v220, v220, v220
    v_mul_f32 v221, v221, v221
    v_mul_f32 v222, v222, v222
    v_mul_f32 v223, v223, v223
    v_exp_f32 v216, -v216
    v_exp_f32 v217, -v217
    v_exp_f32 v218, -v218
    v_exp_f32 v219, -v219
    v_exp_f32 v220, -v220
    v_exp_f32 v221, -v221
    v_exp_f32 v222, -v222
    v_exp_f32 v223, -v223
    v_cvt_pk_f16_f32 v172, v216, v217
    v_cvt_pk_f16_f32 v173, v218, v219
    v_cvt_pk_f16_f32 v174, v220, v221
    v_cvt_pk_f16_f32 v175, v222, v223
    v_lshlrev_b32 v224, 16, v251
    v_mul_f32 v224, s69, v224
    v_subrev_f32 v216, s40, v224
    v_subrev_f32 v217, s41, v224
    v_subrev_f32 v218, s42, v224
    v_subrev_f32 v219, s43, v224
    v_subrev_f32 v220, s44, v224
    v_subrev_f32 v221, s45, v224
    v_subrev_f32 v222, s46, v224
    v_subrev_f32 v223, s47, v224
    v_mul_f32 v216, v216, v216
    v_mul_f32 v217, v217, v217
    v_mul_f32 v218, v218, v218
    v_mul_f32 v219, v219, v219
    v_mul_f32 v220, v220, v220
    v_mul_f32 v221, v221, v221
    v_mul_f32 v222, v222, v222
    v_mul_f32 v223, v223, v223
    v_exp_f32 v216, -v216
    v_exp_f32 v217, -v217
    v_exp_f32 v218, -v218
    v_exp_f32 v219, -v219
    v_exp_f32 v220, -v220
    v_exp_f32 v221, -v221
    v_exp_f32 v222, -v222
    v_exp_f32 v223, -v223
    v_cvt_pk_f16_f32 v176, v216, v217
    v_cvt_pk_f16_f32 v177, v218, v219
    v_cvt_pk_f16_f32 v178, v220, v221
    v_cvt_pk_f16_f32 v179, v222, v223
    v_lshlrev_b32 v224, 16, v246
    v_mul_f32 v224, s69, v224
    v_subrev_f32 v216, s40, v224
    v_subrev_f32 v217, s41, v224
    v_subrev_f32 v218, s42, v224
    v_subrev_f32 v219, s43, v224
    v_subrev_f32 v220, s44, v224
    v_subrev_f32 v221, s45, v224
    v_subrev_f32 v222, s46, v224
    v_subrev_f32 v223, s47, v224
    v_mul_f32 v216, v216, v216
    v_mul_f32 v217, v217, v217
    v_mul_f32 v218, v218, v218
    v_mul_f32 v219, v219, v219
    v_mul_f32 v220, v220, v220
    v_mul_f32 v221, v221, v221
    v_mul_f32 v222, v222, v222
    v_mul_f32 v223, v223, v223
    v_exp_f32 v216, -v216
    v_exp_f32 v217, -v217
    v_exp_f32 v218, -v218
    v_exp_f32 v219, -v219
    v_exp_f32 v220, -v220
    v_exp_f32 v221, -v221
    v_exp_f32 v222, -v222
    v_exp_f32 v223, -v223
    v_cvt_pk_f16_f32 v180, v216, v217
    v_cvt_pk_f16_f32 v181, v218, v219
    v_cvt_pk_f16_f32 v182, v220, v221
    v_cvt_pk_f16_f32 v183, v222, v223
    v_lshlrev_b32 v224, 16, v247
    v_mul_f32 v224, s69, v224
    v_subrev_f32 v216, s40, v224
    v_subrev_f32 v217, s41, v224
    v_subrev_f32 v218, s42, v224
    v_subrev_f32 v219, s43, v224
    v_subrev_f32 v220, s44, v224
    v_subrev_f32 v221, s45, v224
    v_subrev_f32 v222, s46, v224
    v_subrev_f32 v223, s47, v224
    v_mul_f32 v216, v216, v216
    v_mul_f32 v217, v217, v217
    v_mul_f32 v218, v218, v218
    v_mul_f32 v219, v219, v219
    v_mul_f32 v220, v220, v220
    v_mul_f32 v221, v221, v221
    v_mul_f32 v222, v222, v222
    v_mul_f32 v223, v223, v223
    v_exp_f32 v216, -v216
    v_exp_f32 v217, -v217
    v_exp_f32 v218, -v218
    v_exp_f32 v219, -v219
    v_exp_f32 v220, -v220
    v_exp_f32 v221, -v221
    v_exp_f32 v222, -v222
    v_exp_f32 v223, -v223
    v_cvt_pk_f16_f32 v184, v216, v217
    v_cvt_pk_f16_f32 v185, v218, v219
    v_cvt_pk_f16_f32 v186, v220, v221
    v_cvt_pk_f16_f32 v187, v222, v223
    v_lshlrev_b32 v224, 16, v250
    v_mul_f32 v224, s69, v224
    v_subrev_f32 v216, s40, v224
    v_subrev_f32 v217, s41, v224
    v_subrev_f32 v218, s42, v224
    v_subrev_f32 v219, s43, v224
    v_subrev_f32 v220, s44, v224
    v_subrev_f32 v221, s45, v224
    v_subrev_f32 v222, s46, v224
    v_subrev_f32 v223, s47, v224
    v_mul_f32 v216, v216, v216
    v_mul_f32 v217, v217, v217
    v_mul_f32 v218, v218, v218
    v_mul_f32 v219, v219, v219
    v_mul_f32 v220, v220, v220
    v_mul_f32 v221, v221, v221
    v_mul_f32 v222, v222, v222
    v_mul_f32 v223, v223, v223
    v_exp_f32 v216, -v216
    v_exp_f32 v217, -v217
    v_exp_f32 v218, -v218
    v_exp_f32 v219, -v219
    v_exp_f32 v220, -v220
    v_exp_f32 v221, -v221
    v_exp_f32 v222, -v222
    v_exp_f32 v223, -v223
    v_cvt_pk_f16_f32 v188, v216, v217
    v_cvt_pk_f16_f32 v189, v218, v219
    v_cvt_pk_f16_f32 v190, v220, v221
    v_cvt_pk_f16_f32 v191, v222, v223
    s_branch Lk2_init
Lk2_el:
    v_lshlrev_b32 v2, 4, v1
    s_mov_b32 s50, 85988352
    buffer_load_dwordx4 v[60:63], v2, s[24:27], s50 offen
    s_mov_b32 s50, 85989376
    buffer_load_dwordx4 v[64:67], v2, s[24:27], s50 offen
    s_mov_b32 s50, 85990400
    buffer_load_dwordx4 v[68:71], v2, s[24:27], s50 offen
    s_mov_b32 s50, 0
    buffer_load_dwordx4 v[4:7], v255, s[32:35], s50 offen
    buffer_load_dwordx4 v[8:11], v255, s[32:35], s50 offen offset:1024
    s_mov_b32 s50, 16384
    buffer_load_dwordx4 v[12:15], v255, s[32:35], s50 offen
    buffer_load_dwordx4 v[16:19], v255, s[32:35], s50 offen offset:1024
    s_mov_b32 s50, 32768
    buffer_load_dwordx4 v[20:23], v255, s[32:35], s50 offen
    buffer_load_dwordx4 v[24:27], v255, s[32:35], s50 offen offset:1024
    s_mov_b32 s50, 49152
    buffer_load_dwordx4 v[28:31], v255, s[32:35], s50 offen
    buffer_load_dwordx4 v[32:35], v255, s[32:35], s50 offen offset:1024
    s_mov_b32 s50, 65536
    buffer_load_dwordx4 v[36:39], v255, s[32:35], s50 offen
    buffer_load_dwordx4 v[40:43], v255, s[32:35], s50 offen offset:1024
    v_mov_b32 v80, 0
    v_mov_b32 v81, 0xfffeffff
    v_bfe_u32 v2, v0, 2, 1
    v_bfe_u32 v3, v0, 5, 1
    v_and_b32 v82, 1, v0
    v_lshlrev_b32 v82, 4, v82
    v_mov_b32 v83, 0x3f80
    v_lshlrev_b32 v82, v82, v83
    v_bfe_u32 v83, v0, 3, 2
    v_xor_b32 v2, v2, v3
    v_bfe_u32 v3, v0, 1, 1
    v_lshl_or_b32 v83, v83, 1, v3
    v_lshl_or_b32 v83, v2, 3, v83
    v_mov_b32 v72, 0
    v_cmpx_eq_u32 vcc, 0, v83
    v_mov_b32 v72, v82
    s_mov_b64 exec, -1
    v_mov_b32 v73, 0
    v_cmpx_eq_u32 vcc, 1, v83
    v_mov_b32 v73, v82
    s_mov_b64 exec, -1
    v_mov_b32 v74, 0
    v_cmpx_eq_u32 vcc, 2, v83
    v_mov_b32 v74, v82
    s_mov_b64 exec, -1
    v_mov_b32 v75, 0
    v_cmpx_eq_u32 vcc, 3, v83
    v_mov_b32 v75, v82
    s_mov_b64 exec, -1
    v_mov_b32 v76, 0
    v_cmpx_eq_u32 vcc, 4, v83
    v_mov_b32 v76, v82
    s_mov_b64 exec, -1
    v_mov_b32 v77, 0
    v_cmpx_eq_u32 vcc, 5, v83
    v_mov_b32 v77, v82
    s_mov_b64 exec, -1
    v_mov_b32 v78, 0
    v_cmpx_eq_u32 vcc, 6, v83
    v_mov_b32 v78, v82
    s_mov_b64 exec, -1
    v_mov_b32 v79, 0
    v_cmpx_eq_u32 vcc, 7, v83
    v_mov_b32 v79, v82
    s_mov_b64 exec, -1
    s_branch Lk2_lc
Lk2_end:
    s_endpgm

.section .rodata,"a"
.p2align 6
.amdhsa_kernel bin_kernel
  .amdhsa_next_free_vgpr 128
  .amdhsa_next_free_sgpr 102
  .amdhsa_accum_offset 128
  .amdhsa_group_segment_fixed_size 0
  .amdhsa_kernarg_size 112
  .amdhsa_user_sgpr_count 2
  .amdhsa_user_sgpr_kernarg_segment_ptr 1
  .amdhsa_system_sgpr_workgroup_id_x 1
.end_amdhsa_kernel
.p2align 6
.amdhsa_kernel acc_kernel
  .amdhsa_next_free_vgpr 256
  .amdhsa_next_free_sgpr 102
  .amdhsa_accum_offset 256
  .amdhsa_group_segment_fixed_size 0
  .amdhsa_kernarg_size 112
  .amdhsa_user_sgpr_count 2
  .amdhsa_user_sgpr_kernarg_segment_ptr 1
  .amdhsa_system_sgpr_workgroup_id_x 1
.end_amdhsa_kernel
```
